```python
import torch

def _softmax(x, axis=-1):
    return torch.softmax(x, dim=axis)
def _gelu(x):
    return torch.nn.functional.gelu(x, approximate="tanh")
def _silu(x):
    return torch.nn.functional.silu(x)
def _sigmoid(x):
    return torch.sigmoid(x)
def _layernorm(x, axis=-1, eps=1e-5):
    m = x.mean(dim=axis, keepdim=True)
    v = x.var(dim=axis, keepdim=True, unbiased=False)
    return (x - m) / torch.sqrt(v + eps)
def _scatter_add(tgt, idx, src, axis=0):
    return tgt.clone().index_add_(axis, idx, src)
def _segment_sum(src, seg, n):
    out = torch.zeros((n,) + src.shape[1:], dtype=src.dtype)
    return out.index_add_(0, seg, src)
def _pad(x, pw):
    flat = tuple(v for pair in reversed(pw) for v in pair)
    return torch.nn.functional.pad(x, flat)

kernel_name = 'standalone__geglu_ffn__prompt'

def setup_inputs():

    _w = (lambda a: (lambda t: t.to(torch.bfloat16) if t.is_floating_point() else t)(torch.as_tensor(a)))
    B, S, D, F = 1, 2048, 576, 4608
    return {
        "x": _w((lambda *s: torch.randn(*s, dtype=torch.bfloat16) * 0.05)(B, S, D)),
        "w_gate": _w((lambda *s: torch.randn(*s, dtype=torch.bfloat16) * 0.05)(D, F)),
        "w_up": _w((lambda *s: torch.randn(*s, dtype=torch.bfloat16) * 0.05)(D, F)),
        "w_down": _w((lambda *s: torch.randn(*s, dtype=torch.bfloat16) * 0.05)(F, D)),
    }

def reference(x, w_gate, w_up, w_down):
    return (_gelu(x @ w_gate) * (x @ w_up)) @ w_down
```

```asm
; @launch grid=(256,1,1) block=(256,1,1) lds=163840
.amdgcn_target "amdgcn-amd-amdhsa--gfx950"
.text
.globl standalone__geglu_ffn__prompt_kernel
.p2align 8
.type standalone__geglu_ffn__prompt_kernel,@function
standalone__geglu_ffn__prompt_kernel:
    s_cmp_ge_u32 s2, 256
    s_cbranch_scc1 L_end
    s_load_dwordx4 s[8:11], s[0:1], 0
    s_load_dwordx4 s[16:19], s[0:1], 16
    s_load_dwordx2 s[60:61], s[0:1], 32
    s_load_dwordx2 s[24:25], s[0:1], 48
    s_getpc_b64 s[46:47]
L_pc:
    v_and_b32 v219, 63, v0
    v_lshlrev_b32 v220, 6, v219
    global_load_dword v213, v220, s[46:47]
    v_lshrrev_b32 v221, 6, v0
    s_lshr_b32 s44, s2, 3
    s_lshl_b32 s44, s44, 2
    v_add_u32 v221, s44, v221
    v_lshlrev_b32 v221, 9, v221
    v_and_b32 v222, 7, v219
    v_lshl_add_u32 v221, v222, 6, v221
    v_add_u32 v221, 4096, v221
    v_min_u32 v221, L_code_end-L_pc, v221
    global_load_dword v213, v221, s[46:47]
    v_lshrrev_b32 v220, 6, v0
    v_and_b32 v219, 63, v0
    v_readfirstlane_b32 s28, v220
    s_and_b32 s40, s2, 7
    s_lshr_b32 s3, s40, 1
    s_and_b32 s4, s40, 1
    s_lshr_b32 s41, s2, 3
    s_and_b32 s39, s41, 3
    s_lshr_b32 s5, s41, 2
    s_lshl_b32 s40, s4, 2
    s_add_u32 s40, s40, s39
    s_lshl_b32 s82, s40, 8
    s_mul_i32 s42, s3, 18
    s_lshl_b32 s43, s5, 1
    s_add_u32 s42, s42, s43
    s_lshl_b32 s42, s42, 7
    v_mov_b32 v251, 0
    s_mov_b32 s85, 0
    s_mov_b32 s86, 0
    s_mov_b32 s87, 0
    s_mov_b32 s88, 0
    s_mov_b32 s89, 0
    v_lshrrev_b32 v220, 3, v219
    v_and_b32 v221, 7, v219
    v_lshrrev_b32 v222, 1, v220
    v_xor_b32 v223, v221, v222
    v_lshlrev_b32 v223, 4, v223
    v_mul_u32_u24 v240, 1152, v220
    v_add_u32 v240, v240, v223
    v_xor_b32 v241, 64, v240
    v_and_b32 v223, 1, v220
    v_lshl_add_u32 v223, v222, 2, v223
    v_mul_u32_u24 v242, 9216, v223
    v_lshl_add_u32 v242, v221, 4, v242
    s_waitcnt lgkmcnt(0)
    s_mov_b32 s12, s10
    s_and_b32 s13, s11, 0xffff
    s_mov_b32 s52, s18
    s_and_b32 s53, s19, 0xffff
    s_and_b32 s9, s9, 0xffff
    s_mov_b32 s10, 2359296
    s_mov_b32 s11, 0x00020000
    s_mov_b32 s14, 5308416
    s_mov_b32 s15, 0x00020000
    s_and_b32 s17, s17, 0xffff
    s_mov_b32 s18, 5308416
    s_mov_b32 s19, 0x00020000
    s_lshr_b32 s40, s2, 3
    s_lshl_b32 s40, s40, 2
    s_add_u32 s40, s40, s28
    s_lshl_b32 s41, s4, 2
    s_add_u32 s41, s41, s3
    s_lshl_b32 s41, s41, 7
    s_add_u32 s41, s41, s40
    s_mul_i32 s86, s41, 2304
    v_and_b32 v220, 1, v219
    v_mul_u32_u24 v220, 1152, v220
    v_lshrrev_b32 v221, 1, v219
    v_min_u32 v222, 3, v221
    v_lshl_add_u32 v222, v222, 7, v220
    buffer_load_dword v228, v222, s[8:11], s86 offen
    v_add_u32 v221, 4, v221
    v_min_u32 v221, 8, v221
    v_lshl_add_u32 v229, v221, 7, v220
    s_and_b32 s43, s40, 15
    s_mul_i32 s43, s43, 36864
    s_lshr_b32 s44, s40, 4
    s_lshl_b32 s44, s44, 1
    s_mul_i32 s45, s3, 18
    s_add_u32 s44, s44, s45
    s_lshl_b32 s44, s44, 7
    s_add_u32 s85, s43, s44
    s_cmp_eq_u32 s4, 0
    s_cselect_b32 s64, s12, s16
    s_cselect_b32 s65, s13, s17
    s_mov_b32 s66, 5308416
    s_mov_b32 s67, 0x00020000
    v_and_b32 v220, 3, v219
    v_lshrrev_b32 v221, 2, v219
    v_min_u32 v222, 3, v221
    v_lshl_add_u32 v222, v222, 6, v220
    v_mul_u32_u24 v222, 9216, v222
    s_waitcnt vmcnt(0)
    buffer_load_dword v228, v222, s[64:67], s85 offen
    v_min_u32 v221, 8, v221
    v_lshl_add_u32 v221, v221, 6, v220
    v_mul_u32_u24 v230, 9216, v221
    s_lshl_b32 s41, s28, 6
    s_add_u32 s41, s82, s41
    s_mul_i32 s29, s41, 1152
    s_lshl_b32 s30, s28, 13
    s_mul_i32 s43, s28, 147456
    s_add_u32 s31, s42, s43
    s_mul_i32 s43, s28, 4224
    s_add_u32 s32, s43, 32768
    s_add_u32 m0, s32, 0
    s_add_u32 s42, s31, 0
    buffer_load_dwordx4 v242, s[12:15], s42 offen lds
    s_add_u32 m0, s30, 0
    s_add_u32 s40, s29, 0
    buffer_load_dwordx4 v240, s[8:11], s40 offen lds
    s_add_u32 m0, s30, 1024
    s_add_u32 s41, s29, 9216
    buffer_load_dwordx4 v241, s[8:11], s41 offen lds
    s_add_u32 m0, s32, 1056
    s_add_u32 s43, s31, 18432
    buffer_load_dwordx4 v242, s[12:15], s43 offen lds
    s_add_u32 m0, s30, 2048
    s_add_u32 s40, s29, 18432
    buffer_load_dwordx4 v240, s[8:11], s40 offen lds
    s_add_u32 m0, s30, 3072
    s_add_u32 s41, s29, 27648
    buffer_load_dwordx4 v241, s[8:11], s41 offen lds
    s_add_u32 m0, s32, 2112
    s_add_u32 s42, s31, 0
    buffer_load_dwordx4 v242, s[16:19], s42 offen lds
    s_add_u32 m0, s30, 4096
    s_add_u32 s40, s29, 36864
    buffer_load_dwordx4 v240, s[8:11], s40 offen lds
    s_add_u32 m0, s30, 5120
    s_add_u32 s41, s29, 46080
    buffer_load_dwordx4 v241, s[8:11], s41 offen lds
    s_add_u32 m0, s32, 3168
    s_add_u32 s43, s31, 18432
    buffer_load_dwordx4 v242, s[16:19], s43 offen lds
    s_add_u32 m0, s30, 6144
    s_add_u32 s40, s29, 55296
    buffer_load_dwordx4 v240, s[8:11], s40 offen lds
    s_add_u32 m0, s30, 7168
    s_add_u32 s41, s29, 64512
    buffer_load_dwordx4 v241, s[8:11], s41 offen lds
    s_lshr_b32 s40, s2, 3
    s_lshl_b32 s41, s4, 5
    s_add_u32 s40, s40, s41
    s_lshl_b32 s40, s40, 1
    s_and_b32 s41, s28, 1
    s_add_u32 s40, s40, s41
    s_and_b32 s41, s40, 1
    s_bfe_u32 s42, s40, 0x10001
    s_lshr_b32 s43, s40, 2
    s_mul_i32 s44, s3, 18
    s_add_u32 s44, s44, s41
    s_add_u32 s44, s44, 16
    s_lshl_b32 s44, s44, 7
    s_mul_i32 s45, s43, 73728
    s_add_u32 s90, s44, s45
    s_lshl_b32 s44, s3, 3
    s_lshl_b32 s45, s41, 2
    s_add_u32 s44, s44, s45
    s_mul_i32 s44, s44, 36864
    s_lshr_b32 s45, s43, 1
    s_lshl_b32 s45, s45, 10
    s_add_u32 s44, s44, s45
    s_and_b32 s45, s43, 1
    s_lshl_b32 s45, s45, 9
    s_add_u32 s44, s44, s45
    s_lshl_b32 s45, s42, 7
    s_add_u32 s44, s44, s45
    s_add_u32 s100, s44, 10485760
    s_cmp_eq_u32 s42, 0
    s_cselect_b32 s68, s12, s16
    s_cselect_b32 s69, s13, s17
    s_mul_i32 s44, s3, 1152
    s_lshl_b32 s45, s40, 3
    s_add_u32 s44, s44, s45
    s_mul_i32 s44, s44, 1152
    s_add_u32 s44, s44, 1024
    s_mul_i32 s45, s3, 147456
    s_lshl_b32 s46, s40, 8
    s_add_u32 s45, s45, s46
    s_add_u32 s45, s45, 12582912
    s_cmp_lt_u32 s28, 2
    s_cselect_b32 s68, s68, s52
    s_cselect_b32 s69, s69, s53
    s_cselect_b32 s87, s43, s40
    s_mov_b32 s88, 128
    s_cselect_b32 s88, 32, s88
    s_mov_b32 s89, 144
    s_cselect_b32 s89, 72, s89
    s_cselect_b32 s90, s90, s44
    s_mov_b32 s91, 1179648
    s_cselect_b32 s91, 2359296, s91
    s_cselect_b32 s100, s100, s45
    s_mov_b32 s101, 32768
    s_cselect_b32 s101, 16384, s101
    s_mov_b32 s44, 1152
    s_cselect_b32 s44, 9216, s44
    s_cselect_b32 s45, 8, 7
    s_mov_b32 s70, 5308416
    s_mov_b32 s71, 0x00020000
    v_lshrrev_b32 v220, 3, v219
    v_and_b32 v221, 7, v219
    v_mul_lo_u32 v222, v220, s44
    v_lshl_add_u32 v231, v221, 4, v222
    v_lshrrev_b32 v223, 1, v221
    v_mul_u32_u24 v223, 36864, v223
    v_lshrrev_b32 v251, 2, v220
    v_lshlrev_b32 v251, s45, v251
    v_add_u32 v223, v223, v251
    v_and_b32 v251, 3, v220
    v_lshl_add_u32 v223, v251, 5, v223
    v_and_b32 v251, 1, v221
    v_lshl_add_u32 v251, v251, 4, v223
    s_mul_i32 s40, s88, 0
    s_add_u32 s40, s40, s87
    s_mul_i32 s41, s91, 0
    s_add_u32 s41, s41, s90
    s_cmp_lt_u32 s40, s89
    s_cselect_b32 s41, s41, 2146435072
    buffer_load_dwordx4 v[192:195], v231, s[68:71], s41 offen
    s_mul_i32 s40, s88, 1
    s_add_u32 s40, s40, s87
    s_mul_i32 s41, s91, 1
    s_add_u32 s41, s41, s90
    s_cmp_lt_u32 s40, s89
    s_cselect_b32 s41, s41, 2146435072
    buffer_load_dwordx4 v[196:199], v231, s[68:71], s41 offen
    s_mul_i32 s40, s88, 2
    s_add_u32 s40, s40, s87
    s_mul_i32 s41, s91, 2
    s_add_u32 s41, s41, s90
    s_cmp_lt_u32 s40, s89
    s_cselect_b32 s41, s41, 2146435072
    buffer_load_dwordx4 v[200:203], v231, s[68:71], s41 offen
    s_add_u32 s56, s24, 33554432
    s_addc_u32 s57, s25, 0
    s_and_b32 s25, s25, 0xffff
    s_mov_b32 s26, 18874368
    s_mov_b32 s27, 0x00020000
    s_and_b32 s53, s53, 0xffff
    s_mov_b32 s54, 5308416
    s_mov_b32 s55, 0x00020000
    s_and_b32 s57, s57, 0xffff
    s_mov_b32 s58, 33554432
    s_mov_b32 s59, 0x00020000
    s_and_b32 s61, s61, 0xffff
    s_mov_b32 s62, 2359296
    s_mov_b32 s63, 0x00020000
    v_and_b32 v214, 31, v219
    v_lshrrev_b32 v215, 5, v219
    v_bfe_u32 v220, v214, 1, 3
    v_lshlrev_b32 v221, 7, v214
    s_lshl_b32 s45, s28, 13
    v_add_u32 v221, s45, v221
    v_add_u32 v222, 0, v215
    v_xor_b32 v222, v222, v220
    v_lshl_add_u32 v232, v222, 4, v221
    v_add_u32 v222, 2, v215
    v_xor_b32 v222, v222, v220
    v_lshl_add_u32 v233, v222, 4, v221
    v_add_u32 v222, 4, v215
    v_xor_b32 v222, v222, v220
    v_lshl_add_u32 v234, v222, 4, v221
    v_add_u32 v222, 6, v215
    v_xor_b32 v222, v222, v220
    v_lshl_add_u32 v235, v222, 4, v221
    v_bfe_u32 v216, v219, 4, 1
    v_bfe_u32 v217, v219, 2, 2
    v_and_b32 v218, 3, v219
    v_lshlrev_b32 v218, 3, v218
    v_lshrrev_b32 v220, 1, v217
    v_lshl_add_u32 v220, v216, 1, v220
    v_mul_u32_u24 v220, 1056, v220
    v_and_b32 v221, 1, v217
    v_lshl_add_u32 v221, v215, 2, v221
    v_lshl_add_u32 v220, v221, 7, v220
    v_add_u32 v237, v220, v218
    v_add_u32 v236, 32768, v237
    v_add_u32 v208, 65536, v232
    v_add_u32 v209, 65536, v233
    v_add_u32 v210, 65536, v234
    v_add_u32 v211, 65536, v235
    v_add_u32 v212, 65536, v236
    s_lshr_b32 s45, s28, 1
    s_cmp_eq_u32 s45, 0
    s_cselect_b32 s20, s12, s16
    s_cselect_b32 s21, s13, s17
    s_mov_b32 s22, 5308416
    s_mov_b32 s23, 0x00020000
    s_mul_i32 s45, s3, 18
    s_lshl_b32 s46, s5, 1
    s_add_u32 s45, s45, s46
    s_add_u32 s45, s45, 1
    s_lshl_b32 s45, s45, 7
    s_and_b32 s46, s28, 1
    s_mul_i32 s46, s46, 18432
    s_add_u32 s33, s45, s46
    s_mul_i32 s34, s28, 1056
    s_and_b32 s46, s28, 1
    s_lshl_b32 s47, s39, 1
    s_add_u32 s46, s46, s47
    s_mul_i32 s46, s46, 663552
    s_add_u32 s75, s45, s46
    s_lshl_b32 s45, s3, 3
    s_add_u32 s45, s45, s5
    s_mul_i32 s45, s45, 36864
    s_lshl_b32 s80, s28, 10
    s_add_u32 s45, s45, s80
    s_add_u32 s35, s45, 10485760
    s_lshr_b32 s45, s82, 4
    s_lshl_b32 s46, s28, 2
    s_add_u32 s45, s45, s46
    s_mul_i32 s45, s45, 147456
    s_mul_i32 s46, s3, 72
    s_add_u32 s47, s46, s5
    s_add_u32 s47, s47, 64
    s_lshl_b32 s47, s47, 9
    s_add_u32 s38, s45, s47
    s_lshl_b32 s47, s5, 3
    s_add_u32 s46, s46, s47
    s_lshl_b32 s46, s46, 9
    s_add_u32 s37, s45, s46
    s_and_b32 s45, s5, 1
    s_lshl_b32 s45, s45, 7
    s_add_u32 s82, s82, s45
    s_lshl_b32 s45, s28, 5
    s_add_u32 s82, s82, s45
    s_lshr_b32 s45, s82, 4
    s_mul_i32 s45, s45, 147456
    s_mul_i32 s46, s3, 36864
    s_add_u32 s7, s45, s46
    s_lshr_b32 s47, s5, 1
    s_mul_i32 s45, s3, 1327104
    s_lshl_b32 s46, s47, 8
    s_add_u32 s45, s45, s46
    s_mul_i32 s46, s28, 147456
    s_add_u32 s48, s45, s46
    s_mul_i32 s46, s28, 36864
    s_add_u32 s49, s45, s46
    s_lshl_b32 s45, s3, 2
    s_add_u32 s45, s45, s47
    s_mul_i32 s45, s45, 36864
    s_add_u32 s45, s45, 12582912
    s_lshl_b32 s46, s28, 12
    s_add_u32 s50, s45, s46
    s_lshl_b32 s46, s28, 10
    s_add_u32 s51, s45, s46
    s_mul_i32 s6, s28, 9472
    s_add_u32 s45, s6, 37888
    s_add_u32 s46, s6, 40192
    s_cmp_lt_u32 s28, 1
    s_cselect_b32 s72, s45, s46
    s_add_u32 s45, s6, 153856
    s_add_u32 s46, s6, 4294957824
    s_cmp_lt_u32 s28, 1
    s_cselect_b32 s73, s45, s46
    s_add_u32 s45, s6, 28416
    s_add_u32 s46, s6, 30720
    s_cmp_lt_u32 s28, 2
    s_cselect_b32 s74, s45, s46
    s_and_b32 s45, s2, 7
    s_lshl_b32 s45, s45, 2
    s_add_u32 s45, s45, s39
    s_lshl_b32 s45, s45, 2
    s_add_u32 s46, s45, s28
    s_lshl_b32 s46, s46, 7
    s_lshl_b32 s47, s5, 2
    s_add_u32 s46, s46, s47
    s_add_u32 s76, s46, 16777216
    s_and_b32 s46, s5, 1
    s_lshl_b32 s46, s46, 1
    s_lshr_b32 s47, s28, 1
    s_add_u32 s46, s46, s47
    s_add_u32 s46, s46, s45
    s_lshl_b32 s46, s46, 7
    s_add_u32 s77, s46, 16777216
    s_lshl_b32 s45, s4, 2
    s_add_u32 s45, s45, s39
    s_lshl_b32 s45, s45, 3
    s_add_u32 s45, s45, s5
    s_lshl_b32 s45, s45, 2
    s_add_u32 s45, s45, s28
    s_lshl_b32 s46, s45, 7
    s_add_u32 s78, s46, 16842752
    s_mul_i32 s46, s45, 36864
    s_mul_i32 s47, s3, 9216
    s_add_u32 s79, s46, s47
    s_lshl_b32 s47, s3, 10
    s_add_u32 s81, s46, s47
    s_lshl_b32 s45, s3, 8
    s_add_u32 s84, s45, 16973824
    s_lshr_b32 s45, s2, 3
    s_lshl_b32 s46, s4, 5
    s_add_u32 s45, s45, s46
    s_lshl_b32 s45, s45, 2
    s_add_u32 s83, s84, s45
    v_add_u32 v238, 65536, v237
    v_add_u32 v239, 131072, v237
    v_lshlrev_b32 v220, 9, v215
    v_lshl_add_u32 v220, v216, 7, v220
    v_lshl_add_u32 v220, v217, 5, v220
    v_add_u32 v243, v220, v218
    v_lshrrev_b32 v220, 4, v214
    v_mul_u32_u24 v220, 147456, v220
    v_lshl_add_u32 v220, v215, 8, v220
    v_and_b32 v221, 15, v214
    v_lshl_add_u32 v244, v221, 4, v220
    v_mov_b32 v245, 0xc0135761
    v_mov_b32 v246, 0xbdd2d3e8
    v_lshlrev_b32 v255, 4, v219
    v_lshrrev_b32 v220, 4, v219
    v_mul_u32_u24 v220, 9216, v220
    v_and_b32 v221, 15, v219
    v_lshl_add_u32 v247, v221, 4, v220
    v_lshl_add_u32 v220, v216, 2, v217
    v_mul_u32_u24 v220, 1056, v220
    v_lshl_add_u32 v220, v215, 9, v220
    v_add_u32 v252, v220, v218
    v_lshlrev_b32 v220, 4, v215
    v_lshl_add_u32 v220, v216, 2, v220
    v_add_u32 v220, v220, v217
    v_lshl_add_u32 v220, v220, 5, v218
    v_add_u32 v253, 8448, v220
    v_and_b32 v220, 7, v219
    v_lshlrev_b32 v250, 2, v220
    s_waitcnt vmcnt(3)
    s_barrier
    ds_read_b64_tr_b16 v[128:129], v236
    ds_read_b64_tr_b16 v[130:131], v236 offset:256
    ds_read_b128 a[0:3], v232
    ds_read_b128 a[4:7], v232 offset:4096
    ds_read_b64_tr_b16 v[132:133], v236 offset:32
    ds_read_b64_tr_b16 v[134:135], v236 offset:288
    ds_read_b64_tr_b16 v[136:137], v236 offset:64
    ds_read_b64_tr_b16 v[138:139], v236 offset:320
    ds_read_b64_tr_b16 v[140:141], v236 offset:96
    ds_read_b64_tr_b16 v[142:143], v236 offset:352
    s_waitcnt lgkmcnt(7)
    v_mfma_f32_32x32x16_bf16 v[0:15], v[128:131], a[0:3], 0
    ds_read_b64_tr_b16 v[144:145], v236 offset:4224
    ds_read_b64_tr_b16 v[146:147], v236 offset:4480
    s_add_u32 m0, s32, 49664
    s_add_u32 s42, s31, 589824
    buffer_load_dwordx4 v242, s[12:15], s42 offen lds
    s_waitcnt lgkmcnt(8)
    v_mfma_f32_32x32x16_bf16 v[16:31], v[128:131], a[4:7], 0
    ds_read_b128 a[8:11], v233
    ds_read_b128 a[12:15], v233 offset:4096
    s_add_u32 m0, s30, 49664
    s_add_u32 s40, s29, 128
    buffer_load_dwordx4 v240, s[8:11], s40 offen lds
    s_waitcnt lgkmcnt(8)
    v_mfma_f32_32x32x16_bf16 v[32:47], v[132:135], a[0:3], 0
    ds_read_b64_tr_b16 v[148:149], v236 offset:4256
    ds_read_b64_tr_b16 v[150:151], v236 offset:4512
    s_add_u32 m0, s30, 50688
    s_add_u32 s41, s29, 9344
    buffer_load_dwordx4 v241, s[8:11], s41 offen lds
    v_mfma_f32_32x32x16_bf16 v[48:63], v[132:135], a[4:7], 0
    ds_read_b64_tr_b16 v[152:153], v236 offset:4288
    ds_read_b64_tr_b16 v[154:155], v236 offset:4544
    s_add_u32 m0, s32, 50720
    s_add_u32 s43, s31, 608256
    buffer_load_dwordx4 v242, s[12:15], s43 offen lds
    s_waitcnt lgkmcnt(8)
    v_mfma_f32_32x32x16_bf16 v[64:79], v[136:139], a[0:3], 0
    ds_read_b64_tr_b16 v[156:157], v236 offset:4320
    ds_read_b64_tr_b16 v[158:159], v236 offset:4576
    s_add_u32 m0, s30, 51712
    s_add_u32 s40, s29, 18560
    buffer_load_dwordx4 v240, s[8:11], s40 offen lds
    v_mfma_f32_32x32x16_bf16 v[80:95], v[136:139], a[4:7], 0
    s_add_u32 m0, s30, 52736
    s_add_u32 s41, s29, 27776
    buffer_load_dwordx4 v241, s[8:11], s41 offen lds
    v_mfma_f32_32x32x16_bf16 v[96:111], v[140:143], a[0:3], 0
    s_add_u32 m0, s32, 51776
    s_add_u32 s42, s31, 589824
    buffer_load_dwordx4 v242, s[16:19], s42 offen lds
    v_mfma_f32_32x32x16_bf16 v[112:127], v[140:143], a[4:7], 0
    s_add_u32 m0, s30, 53760
    s_add_u32 s40, s29, 36992
    buffer_load_dwordx4 v240, s[8:11], s40 offen lds
    s_waitcnt lgkmcnt(4)
    v_mfma_f32_32x32x16_bf16 v[0:15], v[144:147], a[8:11], v[0:15]
    ds_read_b64_tr_b16 v[128:129], v236 offset:8448
    ds_read_b64_tr_b16 v[130:131], v236 offset:8704
    s_add_u32 m0, s30, 54784
    s_add_u32 s41, s29, 46208
    buffer_load_dwordx4 v241, s[8:11], s41 offen lds
    v_mfma_f32_32x32x16_bf16 v[16:31], v[144:147], a[12:15], v[16:31]
    ds_read_b128 a[16:19], v234
    ds_read_b128 a[20:23], v234 offset:4096
    s_add_u32 m0, s32, 52832
    s_add_u32 s43, s31, 608256
    buffer_load_dwordx4 v242, s[16:19], s43 offen lds
    v_mfma_f32_32x32x16_bf16 v[32:47], v[148:151], a[8:11], v[32:47]
    ds_read_b64_tr_b16 v[132:133], v236 offset:8480
    ds_read_b64_tr_b16 v[134:135], v236 offset:8736
    s_add_u32 m0, s30, 55808
    s_add_u32 s40, s29, 55424
    buffer_load_dwordx4 v240, s[8:11], s40 offen lds
    v_mfma_f32_32x32x16_bf16 v[48:63], v[148:151], a[12:15], v[48:63]
    ds_read_b64_tr_b16 v[136:137], v236 offset:8512
    ds_read_b64_tr_b16 v[138:139], v236 offset:8768
    s_add_u32 m0, s30, 56832
    s_add_u32 s41, s29, 64640
    buffer_load_dwordx4 v241, s[8:11], s41 offen lds
    s_waitcnt lgkmcnt(8)
    v_mfma_f32_32x32x16_bf16 v[64:79], v[152:155], a[8:11], v[64:79]
    ds_read_b64_tr_b16 v[140:141], v236 offset:8544
    ds_read_b64_tr_b16 v[142:143], v236 offset:8800
    s_add_u32 m0, s32, 99328
    s_add_u32 s42, s31, 1179648
    buffer_load_dwordx4 v242, s[12:15], s42 offen lds
    v_mfma_f32_32x32x16_bf16 v[80:95], v[152:155], a[12:15], v[80:95]
    s_add_u32 m0, s30, 99328
    s_add_u32 s40, s29, 256
    buffer_load_dwordx4 v240, s[8:11], s40 offen lds
    v_mfma_f32_32x32x16_bf16 v[96:111], v[156:159], a[8:11], v[96:111]
    s_add_u32 m0, s30, 100352
    s_add_u32 s41, s29, 9472
    buffer_load_dwordx4 v241, s[8:11], s41 offen lds
    v_mfma_f32_32x32x16_bf16 v[112:127], v[156:159], a[12:15], v[112:127]
    s_add_u32 m0, s32, 100384
    s_add_u32 s43, s31, 1198080
    buffer_load_dwordx4 v242, s[12:15], s43 offen lds
    s_waitcnt lgkmcnt(4)
    v_mfma_f32_32x32x16_bf16 v[0:15], v[128:131], a[16:19], v[0:15]
    ds_read_b64_tr_b16 v[144:145], v236 offset:12672
    ds_read_b64_tr_b16 v[146:147], v236 offset:12928
    s_add_u32 m0, s30, 101376
    s_add_u32 s40, s29, 18688
    buffer_load_dwordx4 v240, s[8:11], s40 offen lds
    v_mfma_f32_32x32x16_bf16 v[16:31], v[128:131], a[20:23], v[16:31]
    ds_read_b128 a[24:27], v235
    ds_read_b128 a[28:31], v235 offset:4096
    s_add_u32 m0, s30, 102400
    s_add_u32 s41, s29, 27904
    buffer_load_dwordx4 v241, s[8:11], s41 offen lds
    v_mfma_f32_32x32x16_bf16 v[32:47], v[132:135], a[16:19], v[32:47]
    ds_read_b64_tr_b16 v[148:149], v236 offset:12704
    ds_read_b64_tr_b16 v[150:151], v236 offset:12960
    s_add_u32 m0, s32, 101440
    s_add_u32 s42, s31, 1179648
    buffer_load_dwordx4 v242, s[16:19], s42 offen lds
    v_mfma_f32_32x32x16_bf16 v[48:63], v[132:135], a[20:23], v[48:63]
    ds_read_b64_tr_b16 v[152:153], v236 offset:12736
    ds_read_b64_tr_b16 v[154:155], v236 offset:12992
    s_add_u32 m0, s30, 103424
    s_add_u32 s40, s29, 37120
    buffer_load_dwordx4 v240, s[8:11], s40 offen lds
    s_waitcnt lgkmcnt(8)
    v_mfma_f32_32x32x16_bf16 v[64:79], v[136:139], a[16:19], v[64:79]
    ds_read_b64_tr_b16 v[156:157], v236 offset:12768
    ds_read_b64_tr_b16 v[158:159], v236 offset:13024
    s_add_u32 m0, s30, 104448
    s_add_u32 s41, s29, 46336
    buffer_load_dwordx4 v241, s[8:11], s41 offen lds
    v_mfma_f32_32x32x16_bf16 v[80:95], v[136:139], a[20:23], v[80:95]
    s_add_u32 m0, s32, 102496
    s_add_u32 s43, s31, 1198080
    buffer_load_dwordx4 v242, s[16:19], s43 offen lds
    v_mfma_f32_32x32x16_bf16 v[96:111], v[140:143], a[16:19], v[96:111]
    s_add_u32 m0, s30, 105472
    s_add_u32 s40, s29, 55552
    buffer_load_dwordx4 v240, s[8:11], s40 offen lds
    v_mfma_f32_32x32x16_bf16 v[112:127], v[140:143], a[20:23], v[112:127]
    s_add_u32 m0, s30, 106496
    s_add_u32 s41, s29, 64768
    buffer_load_dwordx4 v241, s[8:11], s41 offen lds
    s_waitcnt lgkmcnt(0)
    v_mfma_f32_32x32x16_bf16 v[0:15], v[144:147], a[24:27], v[0:15]
    s_waitcnt vmcnt(12)
    s_barrier
    v_mov_b32 v226, 0
    s_mov_b32 s40, 16908288
    buffer_load_dword v249, v226, s[56:59], s40 offen sc1
    v_mfma_f32_32x32x16_bf16 v[16:31], v[144:147], a[28:31], v[16:31]
    ds_read_b64_tr_b16 v[128:129], v236 offset:49664
    ds_read_b64_tr_b16 v[130:131], v236 offset:49920
    s_add_u32 m0, s32, 0
    s_add_u32 s42, s31, 1769472
    buffer_load_dwordx4 v242, s[12:15], s42 offen lds
    v_mfma_f32_32x32x16_bf16 v[32:47], v[148:151], a[24:27], v[32:47]
    ds_read_b128 a[32:35], v232 offset:49664
    ds_read_b128 a[36:39], v232 offset:53760
    v_mfma_f32_32x32x16_bf16 v[48:63], v[148:151], a[28:31], v[48:63]
    ds_read_b64_tr_b16 v[132:133], v236 offset:49696
    ds_read_b64_tr_b16 v[134:135], v236 offset:49952
    s_add_u32 m0, s30, 0
    s_add_u32 s40, s29, 384
    buffer_load_dwordx4 v240, s[8:11], s40 offen lds
    v_mfma_f32_32x32x16_bf16 v[64:79], v[152:155], a[24:27], v[64:79]
    ds_read_b64_tr_b16 v[136:137], v236 offset:49728
    ds_read_b64_tr_b16 v[138:139], v236 offset:49984
    v_mfma_f32_32x32x16_bf16 v[80:95], v[152:155], a[28:31], v[80:95]
    ds_read_b64_tr_b16 v[140:141], v236 offset:49760
    ds_read_b64_tr_b16 v[142:143], v236 offset:50016
    s_add_u32 m0, s30, 1024
    s_add_u32 s41, s29, 9600
    buffer_load_dwordx4 v241, s[8:11], s41 offen lds
    v_mfma_f32_32x32x16_bf16 v[96:111], v[156:159], a[24:27], v[96:111]
    v_mfma_f32_32x32x16_bf16 v[112:127], v[156:159], a[28:31], v[112:127]
    s_add_u32 m0, s32, 1056
    s_add_u32 s43, s31, 1787904
    buffer_load_dwordx4 v242, s[12:15], s43 offen lds
    s_waitcnt lgkmcnt(4)
    v_mfma_f32_32x32x16_bf16 v[0:15], v[128:131], a[32:35], v[0:15]
    ds_read_b64_tr_b16 v[144:145], v236 offset:53888
    ds_read_b64_tr_b16 v[146:147], v236 offset:54144
    v_mfma_f32_32x32x16_bf16 v[16:31], v[128:131], a[36:39], v[16:31]
    ds_read_b128 a[40:43], v233 offset:49664
    ds_read_b128 a[44:47], v233 offset:53760
    s_add_u32 m0, s30, 2048
    s_add_u32 s40, s29, 18816
    buffer_load_dwordx4 v240, s[8:11], s40 offen lds
    v_mfma_f32_32x32x16_bf16 v[32:47], v[132:135], a[32:35], v[32:47]
    ds_read_b64_tr_b16 v[148:149], v236 offset:53920
    ds_read_b64_tr_b16 v[150:151], v236 offset:54176
    v_mfma_f32_32x32x16_bf16 v[48:63], v[132:135], a[36:39], v[48:63]
    ds_read_b64_tr_b16 v[152:153], v236 offset:53952
    ds_read_b64_tr_b16 v[154:155], v236 offset:54208
    s_add_u32 m0, s30, 3072
    s_add_u32 s41, s29, 28032
    buffer_load_dwordx4 v241, s[8:11], s41 offen lds
    s_waitcnt lgkmcnt(8)
    v_mfma_f32_32x32x16_bf16 v[64:79], v[136:139], a[32:35], v[64:79]
    ds_read_b64_tr_b16 v[156:157], v236 offset:53984
    ds_read_b64_tr_b16 v[158:159], v236 offset:54240
    v_mfma_f32_32x32x16_bf16 v[80:95], v[136:139], a[36:39], v[80:95]
    s_add_u32 m0, s32, 2112
    s_add_u32 s42, s31, 1769472
    buffer_load_dwordx4 v242, s[16:19], s42 offen lds
    v_mfma_f32_32x32x16_bf16 v[96:111], v[140:143], a[32:35], v[96:111]
    v_mfma_f32_32x32x16_bf16 v[112:127], v[140:143], a[36:39], v[112:127]
    s_add_u32 m0, s30, 4096
    s_add_u32 s40, s29, 37248
    buffer_load_dwordx4 v240, s[8:11], s40 offen lds
    s_waitcnt lgkmcnt(4)
    v_mfma_f32_32x32x16_bf16 v[0:15], v[144:147], a[40:43], v[0:15]
    ds_read_b64_tr_b16 v[128:129], v236 offset:58112
    ds_read_b64_tr_b16 v[130:131], v236 offset:58368
    v_mfma_f32_32x32x16_bf16 v[16:31], v[144:147], a[44:47], v[16:31]
    ds_read_b128 a[48:51], v234 offset:49664
    ds_read_b128 a[52:55], v234 offset:53760
    s_add_u32 m0, s30, 5120
    s_add_u32 s41, s29, 46464
    buffer_load_dwordx4 v241, s[8:11], s41 offen lds
    v_mfma_f32_32x32x16_bf16 v[32:47], v[148:151], a[40:43], v[32:47]
    ds_read_b64_tr_b16 v[132:133], v236 offset:58144
    ds_read_b64_tr_b16 v[134:135], v236 offset:58400
    v_mfma_f32_32x32x16_bf16 v[48:63], v[148:151], a[44:47], v[48:63]
    ds_read_b64_tr_b16 v[136:137], v236 offset:58176
    ds_read_b64_tr_b16 v[138:139], v236 offset:58432
    s_add_u32 m0, s32, 3168
    s_add_u32 s43, s31, 1787904
    buffer_load_dwordx4 v242, s[16:19], s43 offen lds
    s_waitcnt lgkmcnt(8)
    v_mfma_f32_32x32x16_bf16 v[64:79], v[152:155], a[40:43], v[64:79]
    ds_read_b64_tr_b16 v[140:141], v236 offset:58208
    ds_read_b64_tr_b16 v[142:143], v236 offset:58464
    v_mfma_f32_32x32x16_bf16 v[80:95], v[152:155], a[44:47], v[80:95]
    s_add_u32 m0, s30, 6144
    s_add_u32 s40, s29, 55680
    buffer_load_dwordx4 v240, s[8:11], s40 offen lds
    v_mfma_f32_32x32x16_bf16 v[96:111], v[156:159], a[40:43], v[96:111]
    v_mfma_f32_32x32x16_bf16 v[112:127], v[156:159], a[44:47], v[112:127]
    s_add_u32 m0, s30, 7168
    s_add_u32 s41, s29, 64896
    buffer_load_dwordx4 v241, s[8:11], s41 offen lds
    s_waitcnt lgkmcnt(4)
    v_mfma_f32_32x32x16_bf16 v[0:15], v[128:131], a[48:51], v[0:15]
    ds_read_b64_tr_b16 v[144:145], v236 offset:62336
    ds_read_b64_tr_b16 v[146:147], v236 offset:62592
    v_mfma_f32_32x32x16_bf16 v[16:31], v[128:131], a[52:55], v[16:31]
    ds_read_b128 a[56:59], v235 offset:49664
    ds_read_b128 a[60:63], v235 offset:53760
    buffer_load_dword v228, v229, s[8:11], s86 offen
    v_mfma_f32_32x32x16_bf16 v[32:47], v[132:135], a[48:51], v[32:47]
    ds_read_b64_tr_b16 v[148:149], v236 offset:62368
    ds_read_b64_tr_b16 v[150:151], v236 offset:62624
    v_mfma_f32_32x32x16_bf16 v[48:63], v[132:135], a[52:55], v[48:63]
    ds_read_b64_tr_b16 v[152:153], v236 offset:62400
    ds_read_b64_tr_b16 v[154:155], v236 offset:62656
    s_add_u32 s41, s85, 2359296
    s_waitcnt vmcnt(0)
    buffer_load_dword v228, v230, s[64:67], s41 offen
    s_waitcnt lgkmcnt(8)
    v_mfma_f32_32x32x16_bf16 v[64:79], v[136:139], a[48:51], v[64:79]
    ds_read_b64_tr_b16 v[156:157], v236 offset:62432
    ds_read_b64_tr_b16 v[158:159], v236 offset:62688
    v_mfma_f32_32x32x16_bf16 v[80:95], v[136:139], a[52:55], v[80:95]
    s_mul_i32 s40, s88, 0
    s_add_u32 s40, s40, s87
    s_mul_i32 s41, s101, 0
    s_add_u32 s41, s41, s100
    s_cmp_lt_u32 s40, s89
    s_cselect_b32 s41, s41, 2146435072
    buffer_store_dwordx4 v[192:195], v251, s[56:59], s41 offen sc1
    v_mfma_f32_32x32x16_bf16 v[96:111], v[140:143], a[48:51], v[96:111]
    v_mfma_f32_32x32x16_bf16 v[112:127], v[140:143], a[52:55], v[112:127]
    s_mul_i32 s40, s88, 1
    s_add_u32 s40, s40, s87
    s_mul_i32 s41, s101, 1
    s_add_u32 s41, s41, s100
    s_cmp_lt_u32 s40, s89
    s_cselect_b32 s41, s41, 2146435072
    buffer_store_dwordx4 v[196:199], v251, s[56:59], s41 offen sc1
    s_waitcnt lgkmcnt(0)
    v_mfma_f32_32x32x16_bf16 v[0:15], v[144:147], a[56:59], v[0:15]
    s_barrier
    v_mfma_f32_32x32x16_bf16 v[16:31], v[144:147], a[60:63], v[16:31]
    ds_read_b64_tr_b16 v[128:129], v212 offset:33792
    ds_read_b64_tr_b16 v[130:131], v212 offset:34048
    s_mul_i32 s40, s88, 2
    s_add_u32 s40, s40, s87
    s_mul_i32 s41, s101, 2
    s_add_u32 s41, s41, s100
    s_cmp_lt_u32 s40, s89
    s_cselect_b32 s41, s41, 2146435072
    buffer_store_dwordx4 v[200:203], v251, s[56:59], s41 offen sc1
    v_mfma_f32_32x32x16_bf16 v[32:47], v[148:151], a[56:59], v[32:47]
    ds_read_b128 a[64:67], v208 offset:33792
    ds_read_b128 a[68:71], v208 offset:37888
    s_add_u32 m0, s32, 49664
    s_add_u32 s42, s31, 2359296
    buffer_load_dwordx4 v242, s[12:15], s42 offen lds
    v_mfma_f32_32x32x16_bf16 v[48:63], v[148:151], a[60:63], v[48:63]
    ds_read_b64_tr_b16 v[132:133], v212 offset:33824
    ds_read_b64_tr_b16 v[134:135], v212 offset:34080
    v_mfma_f32_32x32x16_bf16 v[64:79], v[152:155], a[56:59], v[64:79]
    ds_read_b64_tr_b16 v[136:137], v212 offset:33856
    ds_read_b64_tr_b16 v[138:139], v212 offset:34112
    s_add_u32 m0, s30, 49664
    s_add_u32 s40, s29, 512
    buffer_load_dwordx4 v240, s[8:11], s40 offen lds
    v_mfma_f32_32x32x16_bf16 v[80:95], v[152:155], a[60:63], v[80:95]
    ds_read_b64_tr_b16 v[140:141], v212 offset:33888
    ds_read_b64_tr_b16 v[142:143], v212 offset:34144
    v_mfma_f32_32x32x16_bf16 v[96:111], v[156:159], a[56:59], v[96:111]
    s_add_u32 m0, s30, 50688
    s_add_u32 s41, s29, 9728
    buffer_load_dwordx4 v241, s[8:11], s41 offen lds
    v_mfma_f32_32x32x16_bf16 v[112:127], v[156:159], a[60:63], v[112:127]
    s_waitcnt lgkmcnt(4)
    v_mfma_f32_32x32x16_bf16 v[0:15], v[128:131], a[64:67], v[0:15]
    ds_read_b64_tr_b16 v[144:145], v212 offset:38016
    ds_read_b64_tr_b16 v[146:147], v212 offset:38272
    s_add_u32 m0, s32, 50720
    s_add_u32 s43, s31, 2377728
    buffer_load_dwordx4 v242, s[12:15], s43 offen lds
    v_mfma_f32_32x32x16_bf16 v[16:31], v[128:131], a[68:71], v[16:31]
    ds_read_b128 a[72:75], v209 offset:33792
    ds_read_b128 a[76:79], v209 offset:37888
    v_mfma_f32_32x32x16_bf16 v[32:47], v[132:135], a[64:67], v[32:47]
    ds_read_b64_tr_b16 v[148:149], v212 offset:38048
    ds_read_b64_tr_b16 v[150:151], v212 offset:38304
    s_add_u32 m0, s30, 51712
    s_add_u32 s40, s29, 18944
    buffer_load_dwordx4 v240, s[8:11], s40 offen lds
    v_mfma_f32_32x32x16_bf16 v[48:63], v[132:135], a[68:71], v[48:63]
    ds_read_b64_tr_b16 v[152:153], v212 offset:38080
    ds_read_b64_tr_b16 v[154:155], v212 offset:38336
    s_waitcnt lgkmcnt(8)
    v_mfma_f32_32x32x16_bf16 v[64:79], v[136:139], a[64:67], v[64:79]
    ds_read_b64_tr_b16 v[156:157], v212 offset:38112
    ds_read_b64_tr_b16 v[158:159], v212 offset:38368
    s_add_u32 m0, s30, 52736
    s_add_u32 s41, s29, 28160
    buffer_load_dwordx4 v241, s[8:11], s41 offen lds
    v_mfma_f32_32x32x16_bf16 v[80:95], v[136:139], a[68:71], v[80:95]
    v_mfma_f32_32x32x16_bf16 v[96:111], v[140:143], a[64:67], v[96:111]
    s_add_u32 m0, s32, 51776
    s_add_u32 s42, s31, 2359296
    buffer_load_dwordx4 v242, s[16:19], s42 offen lds
    v_mfma_f32_32x32x16_bf16 v[112:127], v[140:143], a[68:71], v[112:127]
    s_waitcnt lgkmcnt(4)
    v_mfma_f32_32x32x16_bf16 v[0:15], v[144:147], a[72:75], v[0:15]
    ds_read_b64_tr_b16 v[128:129], v212 offset:42240
    ds_read_b64_tr_b16 v[130:131], v212 offset:42496
    s_add_u32 m0, s30, 53760
    s_add_u32 s40, s29, 37376
    buffer_load_dwordx4 v240, s[8:11], s40 offen lds
    v_mfma_f32_32x32x16_bf16 v[16:31], v[144:147], a[76:79], v[16:31]
    ds_read_b128 a[80:83], v210 offset:33792
    ds_read_b128 a[84:87], v210 offset:37888
    v_mfma_f32_32x32x16_bf16 v[32:47], v[148:151], a[72:75], v[32:47]
    ds_read_b64_tr_b16 v[132:133], v212 offset:42272
    ds_read_b64_tr_b16 v[134:135], v212 offset:42528
    s_add_u32 m0, s30, 54784
    s_add_u32 s41, s29, 46592
    buffer_load_dwordx4 v241, s[8:11], s41 offen lds
    v_mfma_f32_32x32x16_bf16 v[48:63], v[148:151], a[76:79], v[48:63]
    ds_read_b64_tr_b16 v[136:137], v212 offset:42304
    ds_read_b64_tr_b16 v[138:139], v212 offset:42560
    s_waitcnt lgkmcnt(8)
    v_mfma_f32_32x32x16_bf16 v[64:79], v[152:155], a[72:75], v[64:79]
    ds_read_b64_tr_b16 v[140:141], v212 offset:42336
    ds_read_b64_tr_b16 v[142:143], v212 offset:42592
    s_add_u32 m0, s32, 52832
    s_add_u32 s43, s31, 2377728
    buffer_load_dwordx4 v242, s[16:19], s43 offen lds
    v_mfma_f32_32x32x16_bf16 v[80:95], v[152:155], a[76:79], v[80:95]
    v_mfma_f32_32x32x16_bf16 v[96:111], v[156:159], a[72:75], v[96:111]
    s_add_u32 m0, s30, 55808
    s_add_u32 s40, s29, 55808
    buffer_load_dwordx4 v240, s[8:11], s40 offen lds
    v_mfma_f32_32x32x16_bf16 v[112:127], v[156:159], a[76:79], v[112:127]
    s_waitcnt lgkmcnt(4)
    v_mfma_f32_32x32x16_bf16 v[0:15], v[128:131], a[80:83], v[0:15]
    ds_read_b64_tr_b16 v[144:145], v212 offset:46464
    ds_read_b64_tr_b16 v[146:147], v212 offset:46720
    s_add_u32 m0, s30, 56832
    s_add_u32 s41, s29, 65024
    buffer_load_dwordx4 v241, s[8:11], s41 offen lds
    v_mfma_f32_32x32x16_bf16 v[16:31], v[128:131], a[84:87], v[16:31]
    ds_read_b128 a[88:91], v211 offset:33792
    ds_read_b128 a[92:95], v211 offset:37888
    v_mfma_f32_32x32x16_bf16 v[32:47], v[132:135], a[80:83], v[32:47]
    ds_read_b64_tr_b16 v[148:149], v212 offset:46496
    ds_read_b64_tr_b16 v[150:151], v212 offset:46752
    v_mfma_f32_32x32x16_bf16 v[48:63], v[132:135], a[84:87], v[48:63]
    ds_read_b64_tr_b16 v[152:153], v212 offset:46528
    ds_read_b64_tr_b16 v[154:155], v212 offset:46784
    s_waitcnt lgkmcnt(8)
    v_mfma_f32_32x32x16_bf16 v[64:79], v[136:139], a[80:83], v[64:79]
    ds_read_b64_tr_b16 v[156:157], v212 offset:46560
    ds_read_b64_tr_b16 v[158:159], v212 offset:46816
    v_mfma_f32_32x32x16_bf16 v[80:95], v[136:139], a[84:87], v[80:95]
    v_mfma_f32_32x32x16_bf16 v[96:111], v[140:143], a[80:83], v[96:111]
    v_mfma_f32_32x32x16_bf16 v[112:127], v[140:143], a[84:87], v[112:127]
    s_waitcnt lgkmcnt(0)
    v_mfma_f32_32x32x16_bf16 v[0:15], v[144:147], a[88:91], v[0:15]
    s_barrier
    v_mfma_f32_32x32x16_bf16 v[16:31], v[144:147], a[92:95], v[16:31]
    ds_read_b64_tr_b16 v[128:129], v236
    ds_read_b64_tr_b16 v[130:131], v236 offset:256
    s_add_u32 m0, s32, 99328
    s_add_u32 s42, s31, 2949120
    buffer_load_dwordx4 v242, s[12:15], s42 offen lds
    v_mfma_f32_32x32x16_bf16 v[32:47], v[148:151], a[88:91], v[32:47]
    ds_read_b128 a[96:99], v232
    ds_read_b128 a[100:103], v232 offset:4096
    v_mfma_f32_32x32x16_bf16 v[48:63], v[148:151], a[92:95], v[48:63]
    ds_read_b64_tr_b16 v[132:133], v236 offset:32
    ds_read_b64_tr_b16 v[134:135], v236 offset:288
    s_add_u32 m0, s30, 99328
    s_add_u32 s40, s29, 640
    buffer_load_dwordx4 v240, s[8:11], s40 offen lds
    v_mfma_f32_32x32x16_bf16 v[64:79], v[152:155], a[88:91], v[64:79]
    ds_read_b64_tr_b16 v[136:137], v236 offset:64
    ds_read_b64_tr_b16 v[138:139], v236 offset:320
    v_mfma_f32_32x32x16_bf16 v[80:95], v[152:155], a[92:95], v[80:95]
    ds_read_b64_tr_b16 v[140:141], v236 offset:96
    ds_read_b64_tr_b16 v[142:143], v236 offset:352
    s_add_u32 m0, s30, 100352
    s_add_u32 s41, s29, 9856
    buffer_load_dwordx4 v241, s[8:11], s41 offen lds
    v_mfma_f32_32x32x16_bf16 v[96:111], v[156:159], a[88:91], v[96:111]
    v_mfma_f32_32x32x16_bf16 v[112:127], v[156:159], a[92:95], v[112:127]
    s_add_u32 m0, s32, 100384
    s_add_u32 s43, s31, 2967552
    buffer_load_dwordx4 v242, s[12:15], s43 offen lds
    s_waitcnt lgkmcnt(4)
    v_mfma_f32_32x32x16_bf16 v[0:15], v[128:131], a[96:99], v[0:15]
    ds_read_b64_tr_b16 v[144:145], v236 offset:4224
    ds_read_b64_tr_b16 v[146:147], v236 offset:4480
    v_mfma_f32_32x32x16_bf16 v[16:31], v[128:131], a[100:103], v[16:31]
    ds_read_b128 a[104:107], v233
    ds_read_b128 a[108:111], v233 offset:4096
    s_add_u32 m0, s30, 101376
    s_add_u32 s40, s29, 19072
    buffer_load_dwordx4 v240, s[8:11], s40 offen lds
    v_mfma_f32_32x32x16_bf16 v[32:47], v[132:135], a[96:99], v[32:47]
    ds_read_b64_tr_b16 v[148:149], v236 offset:4256
    ds_read_b64_tr_b16 v[150:151], v236 offset:4512
    v_mfma_f32_32x32x16_bf16 v[48:63], v[132:135], a[100:103], v[48:63]
    ds_read_b64_tr_b16 v[152:153], v236 offset:4288
    ds_read_b64_tr_b16 v[154:155], v236 offset:4544
    s_add_u32 m0, s30, 102400
    s_add_u32 s41, s29, 28288
    buffer_load_dwordx4 v241, s[8:11], s41 offen lds
    s_waitcnt lgkmcnt(8)
    v_mfma_f32_32x32x16_bf16 v[64:79], v[136:139], a[96:99], v[64:79]
    ds_read_b64_tr_b16 v[156:157], v236 offset:4320
    ds_read_b64_tr_b16 v[158:159], v236 offset:4576
    v_mfma_f32_32x32x16_bf16 v[80:95], v[136:139], a[100:103], v[80:95]
    s_add_u32 m0, s32, 101440
    s_add_u32 s42, s31, 2949120
    buffer_load_dwordx4 v242, s[16:19], s42 offen lds
    v_mfma_f32_32x32x16_bf16 v[96:111], v[140:143], a[96:99], v[96:111]
    v_mfma_f32_32x32x16_bf16 v[112:127], v[140:143], a[100:103], v[112:127]
    s_add_u32 m0, s30, 103424
    s_add_u32 s40, s29, 37504
    buffer_load_dwordx4 v240, s[8:11], s40 offen lds
    s_waitcnt lgkmcnt(4)
    v_mfma_f32_32x32x16_bf16 v[0:15], v[144:147], a[104:107], v[0:15]
    ds_read_b64_tr_b16 v[128:129], v236 offset:8448
    ds_read_b64_tr_b16 v[130:131], v236 offset:8704
    s_mov_b32 s36, 1664525
    v_mul_lo_u32 v249, v249, s36
    v_add_u32 v249, 1013904223, v249
    v_mfma_f32_32x32x16_bf16 v[16:31], v[144:147], a[108:111], v[16:31]
    ds_read_b128 a[112:115], v234
    ds_read_b128 a[116:119], v234 offset:4096
    s_add_u32 m0, s30, 104448
    s_add_u32 s41, s29, 46720
    buffer_load_dwordx4 v241, s[8:11], s41 offen lds
    v_mfma_f32_32x32x16_bf16 v[32:47], v[148:151], a[104:107], v[32:47]
    ds_read_b64_tr_b16 v[132:133], v236 offset:8480
    ds_read_b64_tr_b16 v[134:135], v236 offset:8736
    v_mfma_f32_32x32x16_bf16 v[48:63], v[148:151], a[108:111], v[48:63]
    ds_read_b64_tr_b16 v[136:137], v236 offset:8512
    ds_read_b64_tr_b16 v[138:139], v236 offset:8768
    s_add_u32 m0, s32, 102496
    s_add_u32 s43, s31, 2967552
    buffer_load_dwordx4 v242, s[16:19], s43 offen lds
    s_waitcnt lgkmcnt(8)
    v_mfma_f32_32x32x16_bf16 v[64:79], v[152:155], a[104:107], v[64:79]
    ds_read_b64_tr_b16 v[140:141], v236 offset:8544
    ds_read_b64_tr_b16 v[142:143], v236 offset:8800
    v_mfma_f32_32x32x16_bf16 v[80:95], v[152:155], a[108:111], v[80:95]
    s_add_u32 m0, s30, 105472
    s_add_u32 s40, s29, 55936
    buffer_load_dwordx4 v240, s[8:11], s40 offen lds
    v_mfma_f32_32x32x16_bf16 v[96:111], v[156:159], a[104:107], v[96:111]
    v_mfma_f32_32x32x16_bf16 v[112:127], v[156:159], a[108:111], v[112:127]
    s_add_u32 m0, s30, 106496
    s_add_u32 s41, s29, 65152
    buffer_load_dwordx4 v241, s[8:11], s41 offen lds
    s_waitcnt lgkmcnt(4)
    v_mfma_f32_32x32x16_bf16 v[0:15], v[128:131], a[112:115], v[0:15]
    ds_read_b64_tr_b16 v[144:145], v236 offset:12672
    ds_read_b64_tr_b16 v[146:147], v236 offset:12928
    v_mfma_f32_32x32x16_bf16 v[16:31], v[128:131], a[116:119], v[16:31]
    ds_read_b128 a[120:123], v235
    ds_read_b128 a[124:127], v235 offset:4096
    s_add_u32 s41, s85, 128
    s_waitcnt vmcnt(27)
    buffer_load_dword v228, v230, s[64:67], s41 offen
    v_mfma_f32_32x32x16_bf16 v[32:47], v[132:135], a[112:115], v[32:47]
    ds_read_b64_tr_b16 v[148:149], v236 offset:12704
    ds_read_b64_tr_b16 v[150:151], v236 offset:12960
    v_mfma_f32_32x32x16_bf16 v[48:63], v[132:135], a[116:119], v[48:63]
    ds_read_b64_tr_b16 v[152:153], v236 offset:12736
    ds_read_b64_tr_b16 v[154:155], v236 offset:12992
    s_waitcnt lgkmcnt(8)
    v_mfma_f32_32x32x16_bf16 v[64:79], v[136:139], a[112:115], v[64:79]
    ds_read_b64_tr_b16 v[156:157], v236 offset:12768
    ds_read_b64_tr_b16 v[158:159], v236 offset:13024
    v_mfma_f32_32x32x16_bf16 v[80:95], v[136:139], a[116:119], v[80:95]
    v_mfma_f32_32x32x16_bf16 v[96:111], v[140:143], a[112:115], v[96:111]
    s_waitcnt vmcnt(25)
    v_mfma_f32_32x32x16_bf16 v[112:127], v[140:143], a[116:119], v[112:127]
    s_waitcnt lgkmcnt(0)
    v_mfma_f32_32x32x16_bf16 v[0:15], v[144:147], a[120:123], v[0:15]
    s_waitcnt vmcnt(13)
    s_barrier
    v_mfma_f32_32x32x16_bf16 v[16:31], v[144:147], a[124:127], v[16:31]
    ds_read_b64_tr_b16 v[128:129], v236 offset:49664
    ds_read_b64_tr_b16 v[130:131], v236 offset:49920
    s_add_u32 m0, s32, 0
    s_add_u32 s42, s31, 3538944
    buffer_load_dwordx4 v242, s[12:15], s42 offen lds
    s_cmp_eq_u32 s28, 0
    s_cbranch_scc0 L_rfl
    s_mov_b64 exec, 1
    v_mov_b32 v227, 0
    buffer_store_dword v249, v227, s[56:59], s83 offen sc1
    s_mov_b64 exec, -1
L_rfl:
    v_mfma_f32_32x32x16_bf16 v[32:47], v[148:151], a[120:123], v[32:47]
    ds_read_b128 a[128:131], v232 offset:49664
    ds_read_b128 a[132:135], v232 offset:53760
    v_mfma_f32_32x32x16_bf16 v[48:63], v[148:151], a[124:127], v[48:63]
    ds_read_b64_tr_b16 v[132:133], v236 offset:49696
    ds_read_b64_tr_b16 v[134:135], v236 offset:49952
    s_add_u32 m0, s30, 0
    s_add_u32 s40, s29, 768
    buffer_load_dwordx4 v240, s[8:11], s40 offen lds
    v_mfma_f32_32x32x16_bf16 v[64:79], v[152:155], a[120:123], v[64:79]
    ds_read_b64_tr_b16 v[136:137], v236 offset:49728
    ds_read_b64_tr_b16 v[138:139], v236 offset:49984
    v_mfma_f32_32x32x16_bf16 v[80:95], v[152:155], a[124:127], v[80:95]
    ds_read_b64_tr_b16 v[140:141], v236 offset:49760
    ds_read_b64_tr_b16 v[142:143], v236 offset:50016
    s_add_u32 m0, s30, 1024
    s_add_u32 s41, s29, 9984
    buffer_load_dwordx4 v241, s[8:11], s41 offen lds
    v_mfma_f32_32x32x16_bf16 v[96:111], v[156:159], a[120:123], v[96:111]
    v_mfma_f32_32x32x16_bf16 v[112:127], v[156:159], a[124:127], v[112:127]
    s_add_u32 m0, s32, 1056
    s_add_u32 s43, s31, 3557376
    buffer_load_dwordx4 v242, s[12:15], s43 offen lds
    s_waitcnt lgkmcnt(4)
    v_mfma_f32_32x32x16_bf16 v[0:15], v[128:131], a[128:131], v[0:15]
    ds_read_b64_tr_b16 v[144:145], v236 offset:53888
    ds_read_b64_tr_b16 v[146:147], v236 offset:54144
    v_mfma_f32_32x32x16_bf16 v[16:31], v[128:131], a[132:135], v[16:31]
    ds_read_b128 a[136:139], v233 offset:49664
    ds_read_b128 a[140:143], v233 offset:53760
    s_add_u32 m0, s30, 2048
    s_add_u32 s40, s29, 19200
    buffer_load_dwordx4 v240, s[8:11], s40 offen lds
    v_mfma_f32_32x32x16_bf16 v[32:47], v[132:135], a[128:131], v[32:47]
    ds_read_b64_tr_b16 v[148:149], v236 offset:53920
    ds_read_b64_tr_b16 v[150:151], v236 offset:54176
    v_mfma_f32_32x32x16_bf16 v[48:63], v[132:135], a[132:135], v[48:63]
    ds_read_b64_tr_b16 v[152:153], v236 offset:53952
    ds_read_b64_tr_b16 v[154:155], v236 offset:54208
    s_add_u32 m0, s30, 3072
    s_add_u32 s41, s29, 28416
    buffer_load_dwordx4 v241, s[8:11], s41 offen lds
    s_waitcnt lgkmcnt(8)
    v_mfma_f32_32x32x16_bf16 v[64:79], v[136:139], a[128:131], v[64:79]
    ds_read_b64_tr_b16 v[156:157], v236 offset:53984
    ds_read_b64_tr_b16 v[158:159], v236 offset:54240
    v_mfma_f32_32x32x16_bf16 v[80:95], v[136:139], a[132:135], v[80:95]
    s_add_u32 m0, s32, 2112
    s_add_u32 s42, s31, 3538944
    buffer_load_dwordx4 v242, s[16:19], s42 offen lds
    v_mfma_f32_32x32x16_bf16 v[96:111], v[140:143], a[128:131], v[96:111]
    v_mfma_f32_32x32x16_bf16 v[112:127], v[140:143], a[132:135], v[112:127]
    s_add_u32 m0, s30, 4096
    s_add_u32 s40, s29, 37632
    buffer_load_dwordx4 v240, s[8:11], s40 offen lds
    s_waitcnt lgkmcnt(4)
    v_mfma_f32_32x32x16_bf16 v[0:15], v[144:147], a[136:139], v[0:15]
    ds_read_b64_tr_b16 v[128:129], v236 offset:58112
    ds_read_b64_tr_b16 v[130:131], v236 offset:58368
    v_mfma_f32_32x32x16_bf16 v[16:31], v[144:147], a[140:143], v[16:31]
    ds_read_b128 a[144:147], v234 offset:49664
    ds_read_b128 a[148:151], v234 offset:53760
    s_add_u32 m0, s30, 5120
    s_add_u32 s41, s29, 46848
    buffer_load_dwordx4 v241, s[8:11], s41 offen lds
    v_mfma_f32_32x32x16_bf16 v[32:47], v[148:151], a[136:139], v[32:47]
    ds_read_b64_tr_b16 v[132:133], v236 offset:58144
    ds_read_b64_tr_b16 v[134:135], v236 offset:58400
    v_mfma_f32_32x32x16_bf16 v[48:63], v[148:151], a[140:143], v[48:63]
    ds_read_b64_tr_b16 v[136:137], v236 offset:58176
    ds_read_b64_tr_b16 v[138:139], v236 offset:58432
    s_add_u32 m0, s32, 3168
    s_add_u32 s43, s31, 3557376
    buffer_load_dwordx4 v242, s[16:19], s43 offen lds
    s_waitcnt lgkmcnt(8)
    v_mfma_f32_32x32x16_bf16 v[64:79], v[152:155], a[136:139], v[64:79]
    ds_read_b64_tr_b16 v[140:141], v236 offset:58208
    ds_read_b64_tr_b16 v[142:143], v236 offset:58464
    v_mfma_f32_32x32x16_bf16 v[80:95], v[152:155], a[140:143], v[80:95]
    s_add_u32 m0, s30, 6144
    s_add_u32 s40, s29, 56064
    buffer_load_dwordx4 v240, s[8:11], s40 offen lds
    v_mfma_f32_32x32x16_bf16 v[96:111], v[156:159], a[136:139], v[96:111]
    v_mfma_f32_32x32x16_bf16 v[112:127], v[156:159], a[140:143], v[112:127]
    s_add_u32 m0, s30, 7168
    s_add_u32 s41, s29, 65280
    buffer_load_dwordx4 v241, s[8:11], s41 offen lds
    s_waitcnt lgkmcnt(4)
    v_mfma_f32_32x32x16_bf16 v[0:15], v[128:131], a[144:147], v[0:15]
    ds_read_b64_tr_b16 v[144:145], v236 offset:62336
    ds_read_b64_tr_b16 v[146:147], v236 offset:62592
    v_mfma_f32_32x32x16_bf16 v[16:31], v[128:131], a[148:151], v[16:31]
    ds_read_b128 a[152:155], v235 offset:49664
    ds_read_b128 a[156:159], v235 offset:53760
    v_mfma_f32_32x32x16_bf16 v[32:47], v[132:135], a[144:147], v[32:47]
    ds_read_b64_tr_b16 v[148:149], v236 offset:62368
    ds_read_b64_tr_b16 v[150:151], v236 offset:62624
    v_mfma_f32_32x32x16_bf16 v[48:63], v[132:135], a[148:151], v[48:63]
    ds_read_b64_tr_b16 v[152:153], v236 offset:62400
    ds_read_b64_tr_b16 v[154:155], v236 offset:62656
    s_waitcnt lgkmcnt(8)
    v_mfma_f32_32x32x16_bf16 v[64:79], v[136:139], a[144:147], v[64:79]
    ds_read_b64_tr_b16 v[156:157], v236 offset:62432
    ds_read_b64_tr_b16 v[158:159], v236 offset:62688
    v_mfma_f32_32x32x16_bf16 v[80:95], v[136:139], a[148:151], v[80:95]
    v_mfma_f32_32x32x16_bf16 v[96:111], v[140:143], a[144:147], v[96:111]
    v_mfma_f32_32x32x16_bf16 v[112:127], v[140:143], a[148:151], v[112:127]
    s_waitcnt lgkmcnt(0)
    v_mfma_f32_32x32x16_bf16 v[0:15], v[144:147], a[152:155], v[0:15]
    s_waitcnt vmcnt(13)
    s_barrier
    v_mfma_f32_32x32x16_bf16 v[16:31], v[144:147], a[156:159], v[16:31]
    ds_read_b64_tr_b16 v[128:129], v212 offset:33792
    ds_read_b64_tr_b16 v[130:131], v212 offset:34048
    s_add_u32 m0, s32, 49664
    s_add_u32 s42, s31, 4128768
    buffer_load_dwordx4 v242, s[12:15], s42 offen lds
    v_mfma_f32_32x32x16_bf16 v[32:47], v[148:151], a[152:155], v[32:47]
    ds_read_b128 a[160:163], v208 offset:33792
    ds_read_b128 a[164:167], v208 offset:37888
    v_mfma_f32_32x32x16_bf16 v[48:63], v[148:151], a[156:159], v[48:63]
    ds_read_b64_tr_b16 v[132:133], v212 offset:33824
    ds_read_b64_tr_b16 v[134:135], v212 offset:34080
    s_add_u32 m0, s30, 49664
    s_add_u32 s40, s29, 896
    buffer_load_dwordx4 v240, s[8:11], s40 offen lds
    v_mfma_f32_32x32x16_bf16 v[64:79], v[152:155], a[152:155], v[64:79]
    ds_read_b64_tr_b16 v[136:137], v212 offset:33856
    ds_read_b64_tr_b16 v[138:139], v212 offset:34112
    v_mfma_f32_32x32x16_bf16 v[80:95], v[152:155], a[156:159], v[80:95]
    ds_read_b64_tr_b16 v[140:141], v212 offset:33888
    ds_read_b64_tr_b16 v[142:143], v212 offset:34144
    s_add_u32 m0, s30, 50688
    s_add_u32 s41, s29, 10112
    buffer_load_dwordx4 v241, s[8:11], s41 offen lds
    v_mfma_f32_32x32x16_bf16 v[96:111], v[156:159], a[152:155], v[96:111]
    v_mfma_f32_32x32x16_bf16 v[112:127], v[156:159], a[156:159], v[112:127]
    s_add_u32 m0, s32, 50720
    s_add_u32 s43, s31, 4147200
    buffer_load_dwordx4 v242, s[12:15], s43 offen lds
    s_waitcnt lgkmcnt(4)
    v_mfma_f32_32x32x16_bf16 v[0:15], v[128:131], a[160:163], v[0:15]
    ds_read_b64_tr_b16 v[144:145], v212 offset:38016
    ds_read_b64_tr_b16 v[146:147], v212 offset:38272
    v_mfma_f32_32x32x16_bf16 v[16:31], v[128:131], a[164:167], v[16:31]
    ds_read_b128 a[168:171], v209 offset:33792
    ds_read_b128 a[172:175], v209 offset:37888
    s_add_u32 m0, s30, 51712
    s_add_u32 s40, s29, 19328
    buffer_load_dwordx4 v240, s[8:11], s40 offen lds
    v_mfma_f32_32x32x16_bf16 v[32:47], v[132:135], a[160:163], v[32:47]
    ds_read_b64_tr_b16 v[148:149], v212 offset:38048
    ds_read_b64_tr_b16 v[150:151], v212 offset:38304
    v_mfma_f32_32x32x16_bf16 v[48:63], v[132:135], a[164:167], v[48:63]
    ds_read_b64_tr_b16 v[152:153], v212 offset:38080
    ds_read_b64_tr_b16 v[154:155], v212 offset:38336
    s_add_u32 m0, s30, 52736
    s_add_u32 s41, s29, 28544
    buffer_load_dwordx4 v241, s[8:11], s41 offen lds
    s_waitcnt lgkmcnt(8)
    v_mfma_f32_32x32x16_bf16 v[64:79], v[136:139], a[160:163], v[64:79]
    ds_read_b64_tr_b16 v[156:157], v212 offset:38112
    ds_read_b64_tr_b16 v[158:159], v212 offset:38368
    v_mfma_f32_32x32x16_bf16 v[80:95], v[136:139], a[164:167], v[80:95]
    s_add_u32 m0, s32, 51776
    s_add_u32 s42, s31, 4128768
    buffer_load_dwordx4 v242, s[16:19], s42 offen lds
    v_mfma_f32_32x32x16_bf16 v[96:111], v[140:143], a[160:163], v[96:111]
    v_mfma_f32_32x32x16_bf16 v[112:127], v[140:143], a[164:167], v[112:127]
    s_add_u32 m0, s30, 53760
    s_add_u32 s40, s29, 37760
    buffer_load_dwordx4 v240, s[8:11], s40 offen lds
    s_waitcnt lgkmcnt(4)
    v_mfma_f32_32x32x16_bf16 v[0:15], v[144:147], a[168:171], v[0:15]
    ds_read_b64_tr_b16 v[128:129], v212 offset:42240
    ds_read_b64_tr_b16 v[130:131], v212 offset:42496
    v_mfma_f32_32x32x16_bf16 v[16:31], v[144:147], a[172:175], v[16:31]
    ds_read_b128 a[176:179], v210 offset:33792
    ds_read_b128 a[180:183], v210 offset:37888
    s_add_u32 m0, s30, 54784
    s_add_u32 s41, s29, 46976
    buffer_load_dwordx4 v241, s[8:11], s41 offen lds
    v_mfma_f32_32x32x16_bf16 v[32:47], v[148:151], a[168:171], v[32:47]
    ds_read_b64_tr_b16 v[132:133], v212 offset:42272
    ds_read_b64_tr_b16 v[134:135], v212 offset:42528
    v_mfma_f32_32x32x16_bf16 v[48:63], v[148:151], a[172:175], v[48:63]
    ds_read_b64_tr_b16 v[136:137], v212 offset:42304
    ds_read_b64_tr_b16 v[138:139], v212 offset:42560
    s_add_u32 m0, s32, 52832
    s_add_u32 s43, s31, 4147200
    buffer_load_dwordx4 v242, s[16:19], s43 offen lds
    s_waitcnt lgkmcnt(8)
    v_mfma_f32_32x32x16_bf16 v[64:79], v[152:155], a[168:171], v[64:79]
    ds_read_b64_tr_b16 v[140:141], v212 offset:42336
    ds_read_b64_tr_b16 v[142:143], v212 offset:42592
    v_mfma_f32_32x32x16_bf16 v[80:95], v[152:155], a[172:175], v[80:95]
    s_add_u32 m0, s30, 55808
    s_add_u32 s40, s29, 56192
    buffer_load_dwordx4 v240, s[8:11], s40 offen lds
    v_mfma_f32_32x32x16_bf16 v[96:111], v[156:159], a[168:171], v[96:111]
    v_mfma_f32_32x32x16_bf16 v[112:127], v[156:159], a[172:175], v[112:127]
    s_add_u32 m0, s30, 56832
    s_add_u32 s41, s29, 65408
    buffer_load_dwordx4 v241, s[8:11], s41 offen lds
    s_waitcnt lgkmcnt(4)
    v_mfma_f32_32x32x16_bf16 v[0:15], v[128:131], a[176:179], v[0:15]
    ds_read_b64_tr_b16 v[144:145], v212 offset:46464
    ds_read_b64_tr_b16 v[146:147], v212 offset:46720
    v_mfma_f32_32x32x16_bf16 v[16:31], v[128:131], a[180:183], v[16:31]
    ds_read_b128 a[184:187], v211 offset:33792
    ds_read_b128 a[188:191], v211 offset:37888
    v_mfma_f32_32x32x16_bf16 v[32:47], v[132:135], a[176:179], v[32:47]
    ds_read_b64_tr_b16 v[148:149], v212 offset:46496
    ds_read_b64_tr_b16 v[150:151], v212 offset:46752
    v_mfma_f32_32x32x16_bf16 v[48:63], v[132:135], a[180:183], v[48:63]
    ds_read_b64_tr_b16 v[152:153], v212 offset:46528
    ds_read_b64_tr_b16 v[154:155], v212 offset:46784
    s_waitcnt lgkmcnt(8)
    v_mfma_f32_32x32x16_bf16 v[64:79], v[136:139], a[176:179], v[64:79]
    ds_read_b64_tr_b16 v[156:157], v212 offset:46560
    ds_read_b64_tr_b16 v[158:159], v212 offset:46816
    v_mfma_f32_32x32x16_bf16 v[80:95], v[136:139], a[180:183], v[80:95]
    v_mfma_f32_32x32x16_bf16 v[96:111], v[140:143], a[176:179], v[96:111]
    v_mfma_f32_32x32x16_bf16 v[112:127], v[140:143], a[180:183], v[112:127]
    s_waitcnt lgkmcnt(0)
    v_mfma_f32_32x32x16_bf16 v[0:15], v[144:147], a[184:187], v[0:15]
    s_waitcnt vmcnt(12)
    s_barrier
    v_mfma_f32_32x32x16_bf16 v[16:31], v[144:147], a[188:191], v[16:31]
    ds_read_b64_tr_b16 v[128:129], v236
    ds_read_b64_tr_b16 v[130:131], v236 offset:256
    s_add_u32 m0, s32, 99328
    s_add_u32 s42, s31, 4718592
    buffer_load_dwordx4 v242, s[12:15], s42 offen lds
    v_mfma_f32_32x32x16_bf16 v[32:47], v[148:151], a[184:187], v[32:47]
    ds_read_b128 a[192:195], v232
    ds_read_b128 a[196:199], v232 offset:4096
    v_lshrrev_b32 v213, 2, v255
    s_add_u32 s46, s84, 0
    buffer_load_dword v214, v213, s[56:59], s46 offen sc1
    v_mfma_f32_32x32x16_bf16 v[48:63], v[148:151], a[188:191], v[48:63]
    ds_read_b64_tr_b16 v[132:133], v236 offset:32
    ds_read_b64_tr_b16 v[134:135], v236 offset:288
    s_add_u32 m0, s30, 99328
    s_add_u32 s40, s29, 1024
    buffer_load_dwordx4 v240, s[8:11], s40 offen lds
    v_mfma_f32_32x32x16_bf16 v[64:79], v[152:155], a[184:187], v[64:79]
    ds_read_b64_tr_b16 v[136:137], v236 offset:64
    ds_read_b64_tr_b16 v[138:139], v236 offset:320
    v_mfma_f32_32x32x16_bf16 v[80:95], v[152:155], a[188:191], v[80:95]
    ds_read_b64_tr_b16 v[140:141], v236 offset:96
    ds_read_b64_tr_b16 v[142:143], v236 offset:352
    s_add_u32 m0, s30, 100352
    s_add_u32 s41, s29, 10240
    buffer_load_dwordx4 v241, s[8:11], s41 offen lds
    v_mfma_f32_32x32x16_bf16 v[96:111], v[156:159], a[184:187], v[96:111]
    v_mfma_f32_32x32x16_bf16 v[112:127], v[156:159], a[188:191], v[112:127]
    s_add_u32 m0, s32, 100384
    s_add_u32 s43, s31, 4737024
    buffer_load_dwordx4 v242, s[12:15], s43 offen lds
    s_waitcnt lgkmcnt(4)
    v_mfma_f32_32x32x16_bf16 v[0:15], v[128:131], a[192:195], v[0:15]
    ds_read_b64_tr_b16 v[144:145], v236 offset:4224
    ds_read_b64_tr_b16 v[146:147], v236 offset:4480
    v_mfma_f32_32x32x16_bf16 v[16:31], v[128:131], a[196:199], v[16:31]
    ds_read_b128 a[200:203], v233
    ds_read_b128 a[204:207], v233 offset:4096
    s_add_u32 m0, s30, 101376
    s_add_u32 s40, s29, 19456
    buffer_load_dwordx4 v240, s[8:11], s40 offen lds
    v_mfma_f32_32x32x16_bf16 v[32:47], v[132:135], a[192:195], v[32:47]
    ds_read_b64_tr_b16 v[148:149], v236 offset:4256
    ds_read_b64_tr_b16 v[150:151], v236 offset:4512
    v_mfma_f32_32x32x16_bf16 v[48:63], v[132:135], a[196:199], v[48:63]
    ds_read_b64_tr_b16 v[152:153], v236 offset:4288
    ds_read_b64_tr_b16 v[154:155], v236 offset:4544
    s_add_u32 m0, s30, 102400
    s_add_u32 s41, s29, 28672
    buffer_load_dwordx4 v241, s[8:11], s41 offen lds
    s_waitcnt lgkmcnt(8)
    v_mfma_f32_32x32x16_bf16 v[64:79], v[136:139], a[192:195], v[64:79]
    ds_read_b64_tr_b16 v[156:157], v236 offset:4320
    ds_read_b64_tr_b16 v[158:159], v236 offset:4576
    v_mfma_f32_32x32x16_bf16 v[80:95], v[136:139], a[196:199], v[80:95]
    s_add_u32 m0, s32, 101440
    s_add_u32 s42, s31, 4718592
    buffer_load_dwordx4 v242, s[16:19], s42 offen lds
    v_mfma_f32_32x32x16_bf16 v[96:111], v[140:143], a[192:195], v[96:111]
    v_mfma_f32_32x32x16_bf16 v[112:127], v[140:143], a[196:199], v[112:127]
    s_add_u32 m0, s30, 103424
    s_add_u32 s40, s29, 37888
    buffer_load_dwordx4 v240, s[8:11], s40 offen lds
    s_waitcnt lgkmcnt(4)
    v_mfma_f32_32x32x16_bf16 v[0:15], v[144:147], a[200:203], v[0:15]
    ds_read_b64_tr_b16 v[128:129], v236 offset:8448
    ds_read_b64_tr_b16 v[130:131], v236 offset:8704
    v_mfma_f32_32x32x16_bf16 v[16:31], v[144:147], a[204:207], v[16:31]
    ds_read_b128 a[208:211], v234
    ds_read_b128 a[212:215], v234 offset:4096
    s_add_u32 m0, s30, 104448
    s_add_u32 s41, s29, 47104
    buffer_load_dwordx4 v241, s[8:11], s41 offen lds
    v_mfma_f32_32x32x16_bf16 v[32:47], v[148:151], a[200:203], v[32:47]
    ds_read_b64_tr_b16 v[132:133], v236 offset:8480
    ds_read_b64_tr_b16 v[134:135], v236 offset:8736
    v_mfma_f32_32x32x16_bf16 v[48:63], v[148:151], a[204:207], v[48:63]
    ds_read_b64_tr_b16 v[136:137], v236 offset:8512
    ds_read_b64_tr_b16 v[138:139], v236 offset:8768
    s_add_u32 m0, s32, 102496
    s_add_u32 s43, s31, 4737024
    buffer_load_dwordx4 v242, s[16:19], s43 offen lds
    s_waitcnt lgkmcnt(8)
    v_mfma_f32_32x32x16_bf16 v[64:79], v[152:155], a[200:203], v[64:79]
    ds_read_b64_tr_b16 v[140:141], v236 offset:8544
    ds_read_b64_tr_b16 v[142:143], v236 offset:8800
    v_mfma_f32_32x32x16_bf16 v[80:95], v[152:155], a[204:207], v[80:95]
    s_add_u32 m0, s30, 105472
    s_add_u32 s40, s29, 56320
    buffer_load_dwordx4 v240, s[8:11], s40 offen lds
    v_mfma_f32_32x32x16_bf16 v[96:111], v[156:159], a[200:203], v[96:111]
    v_mfma_f32_32x32x16_bf16 v[112:127], v[156:159], a[204:207], v[112:127]
    s_add_u32 m0, s30, 106496
    s_add_u32 s41, s29, 65536
    buffer_load_dwordx4 v241, s[8:11], s41 offen lds
    s_waitcnt lgkmcnt(4)
    v_mfma_f32_32x32x16_bf16 v[0:15], v[128:131], a[208:211], v[0:15]
    ds_read_b64_tr_b16 v[144:145], v236 offset:12672
    ds_read_b64_tr_b16 v[146:147], v236 offset:12928
    v_mfma_f32_32x32x16_bf16 v[16:31], v[128:131], a[212:215], v[16:31]
    ds_read_b128 a[216:219], v235
    ds_read_b128 a[220:223], v235 offset:4096
    v_mfma_f32_32x32x16_bf16 v[32:47], v[132:135], a[208:211], v[32:47]
    ds_read_b64_tr_b16 v[148:149], v236 offset:12704
    ds_read_b64_tr_b16 v[150:151], v236 offset:12960
    s_add_u32 m0, s34, 148992
    s_add_u32 s41, s33, 1622016
    buffer_load_dwordx4 v242, s[20:23], s41 offen lds
    v_mfma_f32_32x32x16_bf16 v[48:63], v[132:135], a[212:215], v[48:63]
    ds_read_b64_tr_b16 v[152:153], v236 offset:12736
    ds_read_b64_tr_b16 v[154:155], v236 offset:12992
    s_waitcnt lgkmcnt(8)
    v_mfma_f32_32x32x16_bf16 v[64:79], v[136:139], a[208:211], v[64:79]
    ds_read_b64_tr_b16 v[156:157], v236 offset:12768
    ds_read_b64_tr_b16 v[158:159], v236 offset:13024
    s_add_u32 m0, s34, 153216
    s_add_u32 s40, s33, 1769472
    buffer_load_dwordx4 v242, s[20:23], s40 offen lds
    v_mfma_f32_32x32x16_bf16 v[80:95], v[136:139], a[212:215], v[80:95]
    v_mfma_f32_32x32x16_bf16 v[96:111], v[140:143], a[208:211], v[96:111]
    s_waitcnt vmcnt(13)
    v_cmp_ne_u32 vcc, v214, v249
    s_cbranch_vccz L_ok2
s_branch L_spin2
L_ok2:
    s_add_u32 m0, s34, 157440
    s_add_u32 s41, s33, 1916928
    buffer_load_dwordx4 v242, s[20:23], s41 offen lds
    v_mfma_f32_32x32x16_bf16 v[112:127], v[140:143], a[212:215], v[112:127]
    s_waitcnt lgkmcnt(0)
    v_mfma_f32_32x32x16_bf16 v[0:15], v[144:147], a[216:219], v[0:15]
    s_barrier
    v_mfma_f32_32x32x16_bf16 v[16:31], v[144:147], a[220:223], v[16:31]
    ds_read_b64_tr_b16 v[128:129], v236 offset:49664
    ds_read_b64_tr_b16 v[130:131], v236 offset:49920
    s_add_u32 m0, s80, 0
    s_add_u32 s40, s35, 0
    buffer_load_dwordx4 v255, s[56:59], s40 offen sc1 lds
    v_mfma_f32_32x32x16_bf16 v[32:47], v[148:151], a[216:219], v[32:47]
    ds_read_b128 a[224:227], v232 offset:49664
    ds_read_b128 a[228:231], v232 offset:53760
    v_mfma_f32_32x32x16_bf16 v[48:63], v[148:151], a[220:223], v[48:63]
    ds_read_b64_tr_b16 v[132:133], v236 offset:49696
    ds_read_b64_tr_b16 v[134:135], v236 offset:49952
    s_add_u32 m0, s80, 4096
    s_add_u32 s41, s35, 4096
    buffer_load_dwordx4 v255, s[56:59], s41 offen sc1 lds
    v_mfma_f32_32x32x16_bf16 v[64:79], v[152:155], a[216:219], v[64:79]
    ds_read_b64_tr_b16 v[136:137], v236 offset:49728
    ds_read_b64_tr_b16 v[138:139], v236 offset:49984
    v_mfma_f32_32x32x16_bf16 v[80:95], v[152:155], a[220:223], v[80:95]
    ds_read_b64_tr_b16 v[140:141], v236 offset:49760
    ds_read_b64_tr_b16 v[142:143], v236 offset:50016
    s_add_u32 m0, s80, 8192
    s_add_u32 s40, s35, 8192
    buffer_load_dwordx4 v255, s[56:59], s40 offen sc1 lds
    v_mfma_f32_32x32x16_bf16 v[96:111], v[156:159], a[216:219], v[96:111]
    v_mfma_f32_32x32x16_bf16 v[112:127], v[156:159], a[220:223], v[112:127]
    s_add_u32 m0, s80, 12288
    s_add_u32 s41, s35, 12288
    buffer_load_dwordx4 v255, s[56:59], s41 offen sc1 lds
    s_waitcnt lgkmcnt(4)
    v_mfma_f32_32x32x16_bf16 v[0:15], v[128:131], a[224:227], v[0:15]
    ds_read_b64_tr_b16 v[144:145], v236 offset:53888
    ds_read_b64_tr_b16 v[146:147], v236 offset:54144
    v_mfma_f32_32x32x16_bf16 v[16:31], v[128:131], a[228:231], v[16:31]
    ds_read_b128 a[232:235], v233 offset:49664
    ds_read_b128 a[236:239], v233 offset:53760
    s_add_u32 m0, s80, 16384
    s_add_u32 s40, s35, 16384
    buffer_load_dwordx4 v255, s[56:59], s40 offen sc1 lds
    v_mfma_f32_32x32x16_bf16 v[32:47], v[132:135], a[224:227], v[32:47]
    ds_read_b64_tr_b16 v[148:149], v236 offset:53920
    ds_read_b64_tr_b16 v[150:151], v236 offset:54176
    v_mfma_f32_32x32x16_bf16 v[48:63], v[132:135], a[228:231], v[48:63]
    ds_read_b64_tr_b16 v[152:153], v236 offset:53952
    ds_read_b64_tr_b16 v[154:155], v236 offset:54208
    s_add_u32 m0, s80, 20480
    s_add_u32 s41, s35, 20480
    buffer_load_dwordx4 v255, s[56:59], s41 offen sc1 lds
    s_waitcnt lgkmcnt(8)
    v_mfma_f32_32x32x16_bf16 v[64:79], v[136:139], a[224:227], v[64:79]
    ds_read_b64_tr_b16 v[156:157], v236 offset:53984
    ds_read_b64_tr_b16 v[158:159], v236 offset:54240
    v_mfma_f32_32x32x16_bf16 v[80:95], v[136:139], a[228:231], v[80:95]
    s_add_u32 m0, s80, 24576
    s_add_u32 s40, s35, 24576
    buffer_load_dwordx4 v255, s[56:59], s40 offen sc1 lds
    v_mfma_f32_32x32x16_bf16 v[96:111], v[140:143], a[224:227], v[96:111]
    v_mfma_f32_32x32x16_bf16 v[112:127], v[140:143], a[228:231], v[112:127]
    s_add_u32 m0, s80, 28672
    s_add_u32 s41, s35, 28672
    buffer_load_dwordx4 v255, s[56:59], s41 offen sc1 lds
    s_waitcnt lgkmcnt(4)
    v_mfma_f32_32x32x16_bf16 v[0:15], v[144:147], a[232:235], v[0:15]
    ds_read_b64_tr_b16 v[128:129], v236 offset:58112
    ds_read_b64_tr_b16 v[130:131], v236 offset:58368
    v_mfma_f32_32x32x16_bf16 v[16:31], v[144:147], a[236:239], v[16:31]
    ds_read_b128 a[240:243], v234 offset:49664
    ds_read_b128 a[244:247], v234 offset:53760
    s_add_u32 m0, s80, 32768
    s_add_u32 s40, s35, 32768
    buffer_load_dwordx4 v255, s[56:59], s40 offen sc1 lds
    v_mfma_f32_32x32x16_bf16 v[32:47], v[148:151], a[232:235], v[32:47]
    ds_read_b64_tr_b16 v[132:133], v236 offset:58144
    ds_read_b64_tr_b16 v[134:135], v236 offset:58400
    s_add_u32 m0, s34, 36864
    s_add_u32 s40, s33, 2064384
    buffer_load_dwordx4 v242, s[20:23], s40 offen lds
    v_mfma_f32_32x32x16_bf16 v[48:63], v[148:151], a[236:239], v[48:63]
    ds_read_b64_tr_b16 v[136:137], v236 offset:58176
    ds_read_b64_tr_b16 v[138:139], v236 offset:58432
    s_waitcnt lgkmcnt(8)
    v_mfma_f32_32x32x16_bf16 v[64:79], v[152:155], a[232:235], v[64:79]
    ds_read_b64_tr_b16 v[140:141], v236 offset:58208
    ds_read_b64_tr_b16 v[142:143], v236 offset:58464
    s_add_u32 m0, s34, 41088
    s_add_u32 s41, s33, 2211840
    buffer_load_dwordx4 v242, s[20:23], s41 offen lds
    v_mfma_f32_32x32x16_bf16 v[80:95], v[152:155], a[236:239], v[80:95]
    v_mfma_f32_32x32x16_bf16 v[96:111], v[156:159], a[232:235], v[96:111]
    s_add_u32 m0, s34, 45312
    s_add_u32 s40, s33, 2359296
    buffer_load_dwordx4 v242, s[20:23], s40 offen lds
    v_mfma_f32_32x32x16_bf16 v[112:127], v[156:159], a[236:239], v[112:127]
    s_waitcnt lgkmcnt(4)
    v_mfma_f32_32x32x16_bf16 v[0:15], v[128:131], a[240:243], v[0:15]
    ds_read_b64_tr_b16 v[144:145], v236 offset:62336
    ds_read_b64_tr_b16 v[146:147], v236 offset:62592
    v_mfma_f32_32x32x16_bf16 v[16:31], v[128:131], a[244:247], v[16:31]
    ds_read_b128 a[248:251], v235 offset:49664
    ds_read_b128 a[252:255], v235 offset:53760
    v_mfma_f32_32x32x16_bf16 v[32:47], v[132:135], a[240:243], v[32:47]
    ds_read_b64_tr_b16 v[148:149], v236 offset:62368
    ds_read_b64_tr_b16 v[150:151], v236 offset:62624
    v_mfma_f32_32x32x16_bf16 v[48:63], v[132:135], a[244:247], v[48:63]
    ds_read_b64_tr_b16 v[152:153], v236 offset:62400
    ds_read_b64_tr_b16 v[154:155], v236 offset:62656
    s_waitcnt lgkmcnt(8)
    v_mfma_f32_32x32x16_bf16 v[64:79], v[136:139], a[240:243], v[64:79]
    ds_read_b64_tr_b16 v[156:157], v236 offset:62432
    ds_read_b64_tr_b16 v[158:159], v236 offset:62688
    v_mfma_f32_32x32x16_bf16 v[80:95], v[136:139], a[244:247], v[80:95]
    v_mfma_f32_32x32x16_bf16 v[96:111], v[140:143], a[240:243], v[96:111]
    v_mfma_f32_32x32x16_bf16 v[112:127], v[140:143], a[244:247], v[112:127]
    s_waitcnt lgkmcnt(0)
    v_mfma_f32_32x32x16_bf16 v[0:15], v[144:147], a[248:251], v[0:15]
    s_waitcnt vmcnt(15)
    s_barrier
    v_mfma_f32_32x32x16_bf16 v[16:31], v[144:147], a[252:255], v[16:31]
    ds_read_b64_tr_b16 v[128:129], v212 offset:33792
    ds_read_b64_tr_b16 v[130:131], v212 offset:34048
    s_add_u32 m0, s34, 49664
    s_add_u32 s40, s33, 0
    buffer_load_dwordx4 v242, s[20:23], s40 offen lds
    v_mfma_f32_32x32x16_bf16 v[32:47], v[148:151], a[248:251], v[32:47]
    ds_read_b128 v[160:163], v208 offset:33792
    ds_read_b128 v[164:167], v208 offset:37888
    v_mfma_f32_32x32x16_bf16 v[48:63], v[148:151], a[252:255], v[48:63]
    ds_read_b64_tr_b16 v[132:133], v212 offset:33824
    ds_read_b64_tr_b16 v[134:135], v212 offset:34080
    s_add_u32 m0, s34, 53888
    s_add_u32 s41, s33, 147456
    buffer_load_dwordx4 v242, s[20:23], s41 offen lds
    v_mfma_f32_32x32x16_bf16 v[64:79], v[152:155], a[248:251], v[64:79]
    ds_read_b64_tr_b16 v[136:137], v212 offset:33856
    ds_read_b64_tr_b16 v[138:139], v212 offset:34112
    v_mfma_f32_32x32x16_bf16 v[80:95], v[152:155], a[252:255], v[80:95]
    ds_read_b64_tr_b16 v[140:141], v212 offset:33888
    ds_read_b64_tr_b16 v[142:143], v212 offset:34144
    s_add_u32 m0, s34, 58112
    s_add_u32 s40, s33, 294912
    buffer_load_dwordx4 v242, s[20:23], s40 offen lds
    v_mfma_f32_32x32x16_bf16 v[96:111], v[156:159], a[248:251], v[96:111]
    v_mfma_f32_32x32x16_bf16 v[112:127], v[156:159], a[252:255], v[112:127]
    s_add_u32 m0, s34, 62336
    s_add_u32 s41, s33, 442368
    buffer_load_dwordx4 v242, s[20:23], s41 offen lds
    s_waitcnt lgkmcnt(4)
    v_mfma_f32_32x32x16_bf16 v[0:15], v[128:131], v[160:163], v[0:15]
    ds_read_b64_tr_b16 v[144:145], v212 offset:38016
    ds_read_b64_tr_b16 v[146:147], v212 offset:38272
    v_mfma_f32_32x32x16_bf16 v[16:31], v[128:131], v[164:167], v[16:31]
    ds_read_b128 v[168:171], v209 offset:33792
    ds_read_b128 v[172:175], v209 offset:37888
    s_add_u32 m0, s34, 66560
    s_add_u32 s40, s33, 589824
    buffer_load_dwordx4 v242, s[20:23], s40 offen lds
    v_mfma_f32_32x32x16_bf16 v[32:47], v[132:135], v[160:163], v[32:47]
    ds_read_b64_tr_b16 v[148:149], v212 offset:38048
    ds_read_b64_tr_b16 v[150:151], v212 offset:38304
    v_mfma_f32_32x32x16_bf16 v[48:63], v[132:135], v[164:167], v[48:63]
    ds_read_b64_tr_b16 v[152:153], v212 offset:38080
    ds_read_b64_tr_b16 v[154:155], v212 offset:38336
    s_add_u32 m0, s34, 70784
    s_add_u32 s41, s33, 737280
    buffer_load_dwordx4 v242, s[20:23], s41 offen lds
    s_waitcnt lgkmcnt(8)
    v_mfma_f32_32x32x16_bf16 v[64:79], v[136:139], v[160:163], v[64:79]
    ds_read_b64_tr_b16 v[156:157], v212 offset:38112
    ds_read_b64_tr_b16 v[158:159], v212 offset:38368
    v_mfma_f32_32x32x16_bf16 v[80:95], v[136:139], v[164:167], v[80:95]
    s_add_u32 m0, s34, 75008
    s_add_u32 s40, s33, 884736
    buffer_load_dwordx4 v242, s[20:23], s40 offen lds
    v_mfma_f32_32x32x16_bf16 v[96:111], v[140:143], v[160:163], v[96:111]
    v_mfma_f32_32x32x16_bf16 v[112:127], v[140:143], v[164:167], v[112:127]
    s_add_u32 m0, s34, 79232
    s_add_u32 s41, s33, 1032192
    buffer_load_dwordx4 v242, s[20:23], s41 offen lds
    s_waitcnt lgkmcnt(4)
    v_mfma_f32_32x32x16_bf16 v[0:15], v[144:147], v[168:171], v[0:15]
    ds_read_b64_tr_b16 v[128:129], v212 offset:42240
    ds_read_b64_tr_b16 v[130:131], v212 offset:42496
    v_mfma_f32_32x32x16_bf16 v[16:31], v[144:147], v[172:175], v[16:31]
    ds_read_b128 v[176:179], v210 offset:33792
    ds_read_b128 v[180:183], v210 offset:37888
    s_add_u32 m0, s34, 83456
    s_add_u32 s40, s33, 1179648
    buffer_load_dwordx4 v242, s[20:23], s40 offen lds
    v_mfma_f32_32x32x16_bf16 v[32:47], v[148:151], v[168:171], v[32:47]
    ds_read_b64_tr_b16 v[132:133], v212 offset:42272
    ds_read_b64_tr_b16 v[134:135], v212 offset:42528
    v_mfma_f32_32x32x16_bf16 v[48:63], v[148:151], v[172:175], v[48:63]
    ds_read_b64_tr_b16 v[136:137], v212 offset:42304
    ds_read_b64_tr_b16 v[138:139], v212 offset:42560
    s_add_u32 m0, s34, 87680
    s_add_u32 s41, s33, 1327104
    buffer_load_dwordx4 v242, s[20:23], s41 offen lds
    s_waitcnt lgkmcnt(8)
    v_mfma_f32_32x32x16_bf16 v[64:79], v[152:155], v[168:171], v[64:79]
    ds_read_b64_tr_b16 v[140:141], v212 offset:42336
    ds_read_b64_tr_b16 v[142:143], v212 offset:42592
    v_mfma_f32_32x32x16_bf16 v[80:95], v[152:155], v[172:175], v[80:95]
    s_add_u32 m0, s34, 91904
    s_add_u32 s40, s33, 1474560
    buffer_load_dwordx4 v242, s[20:23], s40 offen lds
    v_mfma_f32_32x32x16_bf16 v[96:111], v[156:159], v[168:171], v[96:111]
    v_mfma_f32_32x32x16_bf16 v[112:127], v[156:159], v[172:175], v[112:127]
    s_waitcnt lgkmcnt(4)
    v_mfma_f32_32x32x16_bf16 v[0:15], v[128:131], v[176:179], v[0:15]
    ds_read_b64_tr_b16 v[144:145], v212 offset:46464
    ds_read_b64_tr_b16 v[146:147], v212 offset:46720
    v_mfma_f32_32x32x16_bf16 v[16:31], v[128:131], v[180:183], v[16:31]
    ds_read_b128 v[184:187], v211 offset:33792
    ds_read_b128 v[188:191], v211 offset:37888
    v_mfma_f32_32x32x16_bf16 v[32:47], v[132:135], v[176:179], v[32:47]
    ds_read_b64_tr_b16 v[148:149], v212 offset:46496
    ds_read_b64_tr_b16 v[150:151], v212 offset:46752
    v_mfma_f32_32x32x16_bf16 v[48:63], v[132:135], v[180:183], v[48:63]
    ds_read_b64_tr_b16 v[152:153], v212 offset:46528
    ds_read_b64_tr_b16 v[154:155], v212 offset:46784
    s_waitcnt lgkmcnt(8)
    v_mfma_f32_32x32x16_bf16 v[64:79], v[136:139], v[176:179], v[64:79]
    ds_read_b64_tr_b16 v[156:157], v212 offset:46560
    ds_read_b64_tr_b16 v[158:159], v212 offset:46816
    v_mfma_f32_32x32x16_bf16 v[80:95], v[136:139], v[180:183], v[80:95]
    v_mfma_f32_32x32x16_bf16 v[96:111], v[140:143], v[176:179], v[96:111]
    v_mfma_f32_32x32x16_bf16 v[112:127], v[140:143], v[180:183], v[112:127]
    s_waitcnt lgkmcnt(0)
    v_mfma_f32_32x32x16_bf16 v[0:15], v[144:147], v[184:187], v[0:15]
    s_waitcnt vmcnt(14)
    s_barrier
    v_mfma_f32_32x32x16_bf16 v[16:31], v[144:147], v[188:191], v[16:31]
    ds_read_b64_tr_b16 v[192:193], v243
    ds_read_b64_tr_b16 v[194:195], v243 offset:256
    v_mfma_f32_32x32x16_bf16 v[32:47], v[148:151], v[184:187], v[32:47]
    s_add_u32 m0, s34, 99328
    s_add_u32 s41, s33, 2506752
    buffer_load_dwordx4 v242, s[20:23], s41 offen lds
    v_mfma_f32_32x32x16_bf16 v[48:63], v[148:151], v[188:191], v[48:63]
    ds_read_b64_tr_b16 v[196:197], v243 offset:1024
    ds_read_b64_tr_b16 v[198:199], v243 offset:1280
    v_mfma_f32_32x32x16_bf16 v[64:79], v[152:155], v[184:187], v[64:79]
    v_mfma_f32_32x32x16_bf16 v[80:95], v[152:155], v[188:191], v[80:95]
    ds_read_b64_tr_b16 v[200:201], v243 offset:2048
    ds_read_b64_tr_b16 v[202:203], v243 offset:2304
    s_add_u32 m0, s34, 103552
    s_add_u32 s40, s33, 2654208
    buffer_load_dwordx4 v242, s[20:23], s40 offen lds
    v_mfma_f32_32x32x16_bf16 v[96:111], v[156:159], v[184:187], v[96:111]
    v_mfma_f32_32x32x16_bf16 v[112:127], v[156:159], v[188:191], v[112:127]
    s_waitcnt lgkmcnt(2)
    v_mfma_f32_32x32x16_bf16 v[128:143], v[192:195], a[0:3], 0
    ds_read_b64_tr_b16 v[204:205], v243 offset:3072
    ds_read_b64_tr_b16 v[206:207], v243 offset:3328
    s_add_u32 m0, s34, 107776
    s_add_u32 s41, s33, 2801664
    buffer_load_dwordx4 v242, s[20:23], s41 offen lds
    v_mfma_f32_32x32x16_bf16 v[144:159], v[192:195], a[4:7], 0
    v_mul_f32 v208, v0, v0
    v_mul_f32 v209, v1, v1
    v_mul_f32 v210, v2, v2
    v_mul_f32 v211, v3, v3
    v_fma_f32 v208, v208, v246, v245
    v_fma_f32 v209, v209, v246, v245
    v_mfma_f32_32x32x16_bf16 v[128:143], v[196:199], a[8:11], v[128:143]
    ds_read_b64_tr_b16 v[192:193], v243 offset:4096
    ds_read_b64_tr_b16 v[194:195], v243 offset:4352
    v_fma_f32 v210, v210, v246, v245
    v_fma_f32 v211, v211, v246, v245
    v_mul_f32 v208, v0, v208
    v_mul_f32 v209, v1, v209
    v_mfma_f32_32x32x16_bf16 v[144:159], v[196:199], a[12:15], v[144:159]
    s_add_u32 m0, s34, 112000
    s_add_u32 s40, s33, 2949120
    buffer_load_dwordx4 v242, s[20:23], s40 offen lds
    v_mul_f32 v210, v2, v210
    v_mul_f32 v211, v3, v211
    s_waitcnt lgkmcnt(2)
    v_mfma_f32_32x32x16_bf16 v[128:143], v[200:203], a[16:19], v[128:143]
    ds_read_b64_tr_b16 v[196:197], v243 offset:5120
    ds_read_b64_tr_b16 v[198:199], v243 offset:5376
    v_exp_f32 v208, v208
    v_exp_f32 v209, v209
    v_mfma_f32_32x32x16_bf16 v[144:159], v[200:203], a[20:23], v[144:159]
    v_exp_f32 v210, v210
    v_exp_f32 v211, v211
    v_mul_f32 v8, v0, v8
    v_mul_f32 v9, v1, v9
    v_mfma_f32_32x32x16_bf16 v[128:143], v[204:207], a[24:27], v[128:143]
    ds_read_b64_tr_b16 v[200:201], v243 offset:6144
    ds_read_b64_tr_b16 v[202:203], v243 offset:6400
    s_add_u32 m0, s34, 116224
    s_add_u32 s41, s33, 3096576
    buffer_load_dwordx4 v242, s[20:23], s41 offen lds
    v_mul_f32 v10, v2, v10
    v_mfma_f32_32x32x16_bf16 v[144:159], v[204:207], a[28:31], v[144:159]
    v_mul_f32 v11, v3, v11
    v_add_f32 v208, 1.0, v208
    v_add_f32 v209, 1.0, v209
    v_add_f32 v210, 1.0, v210
    v_add_f32 v211, 1.0, v211
    s_waitcnt lgkmcnt(2)
    v_mfma_f32_32x32x16_bf16 v[128:143], v[192:195], a[32:35], v[128:143]
    ds_read_b64_tr_b16 v[204:205], v243 offset:7168
    ds_read_b64_tr_b16 v[206:207], v243 offset:7424
    v_rcp_f32 v208, v208
    v_rcp_f32 v209, v209
    v_mfma_f32_32x32x16_bf16 v[144:159], v[192:195], a[36:39], v[144:159]
    s_add_u32 m0, s34, 120448
    s_add_u32 s40, s33, 3244032
    buffer_load_dwordx4 v242, s[20:23], s40 offen lds
    v_rcp_f32 v210, v210
    v_mfma_f32_32x32x16_bf16 v[128:143], v[196:199], a[40:43], v[128:143]
    ds_read_b64_tr_b16 v[192:193], v243 offset:8192
    ds_read_b64_tr_b16 v[194:195], v243 offset:8448
    v_rcp_f32 v211, v211
    v_mul_f32 v8, v8, v208
    v_mul_f32 v9, v9, v209
    v_mfma_f32_32x32x16_bf16 v[144:159], v[196:199], a[44:47], v[144:159]
    v_mul_f32 v10, v10, v210
    v_mul_f32 v11, v11, v211
    v_cvt_pk_bf16_f32 v224, v8, v9
    v_cvt_pk_bf16_f32 v225, v10, v11
    v_mul_f32 v212, v4, v4
    s_waitcnt lgkmcnt(2)
    v_mfma_f32_32x32x16_bf16 v[128:143], v[200:203], a[48:51], v[128:143]
    ds_read_b64_tr_b16 v[196:197], v243 offset:9216
    ds_read_b64_tr_b16 v[198:199], v243 offset:9472
    s_add_u32 m0, s34, 124672
    s_add_u32 s41, s33, 3391488
    buffer_load_dwordx4 v242, s[20:23], s41 offen lds
    v_mul_f32 v213, v5, v5
    v_mfma_f32_32x32x16_bf16 v[144:159], v[200:203], a[52:55], v[144:159]
    v_mul_f32 v214, v6, v6
    v_mul_f32 v215, v7, v7
    v_fma_f32 v212, v212, v246, v245
    v_fma_f32 v213, v213, v246, v245
    v_fma_f32 v214, v214, v246, v245
    v_fma_f32 v215, v215, v246, v245
    v_mfma_f32_32x32x16_bf16 v[128:143], v[204:207], a[56:59], v[128:143]
    ds_read_b64_tr_b16 v[200:201], v243 offset:10240
    ds_read_b64_tr_b16 v[202:203], v243 offset:10496
    v_mul_f32 v212, v4, v212
    v_mul_f32 v213, v5, v213
    v_mul_f32 v214, v6, v214
    v_mul_f32 v215, v7, v215
    v_mfma_f32_32x32x16_bf16 v[144:159], v[204:207], a[60:63], v[144:159]
    s_add_u32 m0, s34, 128896
    s_add_u32 s40, s33, 3538944
    buffer_load_dwordx4 v242, s[20:23], s40 offen lds
    v_exp_f32 v212, v212
    s_waitcnt lgkmcnt(2)
    v_mfma_f32_32x32x16_bf16 v[128:143], v[192:195], a[64:67], v[128:143]
    ds_read_b64_tr_b16 v[204:205], v243 offset:11264
    ds_read_b64_tr_b16 v[206:207], v243 offset:11520
    v_exp_f32 v213, v213
    v_exp_f32 v214, v214
    v_mfma_f32_32x32x16_bf16 v[144:159], v[192:195], a[68:71], v[144:159]
    v_exp_f32 v215, v215
    v_mul_f32 v12, v4, v12
    v_mul_f32 v13, v5, v13
    v_mul_f32 v14, v6, v14
    v_mul_f32 v15, v7, v15
    v_mfma_f32_32x32x16_bf16 v[128:143], v[196:199], a[72:75], v[128:143]
    ds_read_b64_tr_b16 v[192:193], v243 offset:12288
    ds_read_b64_tr_b16 v[194:195], v243 offset:12544
    s_add_u32 m0, s34, 133120
    s_add_u32 s41, s33, 3686400
    buffer_load_dwordx4 v242, s[20:23], s41 offen lds
    v_add_f32 v212, 1.0, v212
    v_mfma_f32_32x32x16_bf16 v[144:159], v[196:199], a[76:79], v[144:159]
    v_add_f32 v213, 1.0, v213
    v_add_f32 v214, 1.0, v214
    v_add_f32 v215, 1.0, v215
    v_rcp_f32 v212, v212
    s_waitcnt lgkmcnt(2)
    v_mfma_f32_32x32x16_bf16 v[128:143], v[200:203], a[80:83], v[128:143]
    ds_read_b64_tr_b16 v[196:197], v243 offset:13312
    ds_read_b64_tr_b16 v[198:199], v243 offset:13568
    v_rcp_f32 v213, v213
    v_rcp_f32 v214, v214
    v_mfma_f32_32x32x16_bf16 v[144:159], v[200:203], a[84:87], v[144:159]
    s_add_u32 m0, s34, 137344
    s_add_u32 s40, s33, 3833856
    buffer_load_dwordx4 v242, s[20:23], s40 offen lds
    v_rcp_f32 v215, v215
    v_mul_f32 v12, v12, v212
    v_mfma_f32_32x32x16_bf16 v[128:143], v[204:207], a[88:91], v[128:143]
    ds_read_b64_tr_b16 v[200:201], v243 offset:14336
    ds_read_b64_tr_b16 v[202:203], v243 offset:14592
    v_mul_f32 v13, v13, v213
    v_mul_f32 v14, v14, v214
    v_mul_f32 v15, v15, v215
    v_cvt_pk_bf16_f32 v226, v12, v13
    v_mfma_f32_32x32x16_bf16 v[144:159], v[204:207], a[92:95], v[144:159]
    v_cvt_pk_bf16_f32 v227, v14, v15
    s_add_u32 s44, s37, 0
    buffer_store_dwordx4 v[224:227], v244, s[24:27], s44 offen sc1
    v_mul_f32 v216, v16, v16
    v_mul_f32 v217, v17, v17
    s_waitcnt lgkmcnt(2)
    v_mfma_f32_32x32x16_bf16 v[128:143], v[192:195], a[96:99], v[128:143]
    ds_read_b64_tr_b16 v[204:205], v243 offset:15360
    ds_read_b64_tr_b16 v[206:207], v243 offset:15616
    s_add_u32 m0, s34, 141568
    s_add_u32 s41, s33, 3981312
    buffer_load_dwordx4 v242, s[20:23], s41 offen lds
    v_mul_f32 v218, v18, v18
    v_mfma_f32_32x32x16_bf16 v[144:159], v[192:195], a[100:103], v[144:159]
    v_mul_f32 v219, v19, v19
    v_fma_f32 v216, v216, v246, v245
    v_fma_f32 v217, v217, v246, v245
    v_fma_f32 v218, v218, v246, v245
    v_fma_f32 v219, v219, v246, v245
    v_mul_f32 v216, v16, v216
    v_mfma_f32_32x32x16_bf16 v[128:143], v[196:199], a[104:107], v[128:143]
    ds_read_b64_tr_b16 v[192:193], v243 offset:16384
    ds_read_b64_tr_b16 v[194:195], v243 offset:16640
    v_mul_f32 v217, v17, v217
    v_mul_f32 v218, v18, v218
    v_mul_f32 v219, v19, v219
    v_mfma_f32_32x32x16_bf16 v[144:159], v[196:199], a[108:111], v[144:159]
    v_exp_f32 v216, v216
    v_exp_f32 v217, v217
    s_waitcnt lgkmcnt(2)
    v_mfma_f32_32x32x16_bf16 v[128:143], v[200:203], a[112:115], v[128:143]
    ds_read_b64_tr_b16 v[196:197], v243 offset:17408
    ds_read_b64_tr_b16 v[198:199], v243 offset:17664
    v_exp_f32 v218, v218
    v_exp_f32 v219, v219
    v_mfma_f32_32x32x16_bf16 v[144:159], v[200:203], a[116:119], v[144:159]
    v_mul_f32 v24, v16, v24
    v_mul_f32 v25, v17, v25
    v_mul_f32 v26, v18, v26
    v_mul_f32 v27, v19, v27
    v_add_f32 v216, 1.0, v216
    v_add_f32 v217, 1.0, v217
    v_mfma_f32_32x32x16_bf16 v[128:143], v[204:207], a[120:123], v[128:143]
    ds_read_b64_tr_b16 v[200:201], v243 offset:18432
    ds_read_b64_tr_b16 v[202:203], v243 offset:18688
    v_add_f32 v218, 1.0, v218
    v_add_f32 v219, 1.0, v219
    v_rcp_f32 v216, v216
    v_mfma_f32_32x32x16_bf16 v[144:159], v[204:207], a[124:127], v[144:159]
    v_rcp_f32 v217, v217
    v_rcp_f32 v218, v218
    s_waitcnt lgkmcnt(2)
    v_mfma_f32_32x32x16_bf16 v[128:143], v[192:195], a[128:131], v[128:143]
    ds_read_b64_tr_b16 v[204:205], v243 offset:19456
    ds_read_b64_tr_b16 v[206:207], v243 offset:19712
    v_rcp_f32 v219, v219
    v_mul_f32 v24, v24, v216
    v_mul_f32 v25, v25, v217
    v_mfma_f32_32x32x16_bf16 v[144:159], v[192:195], a[132:135], v[144:159]
    v_mul_f32 v26, v26, v218
    v_mul_f32 v27, v27, v219
    v_cvt_pk_bf16_f32 v228, v24, v25
    v_cvt_pk_bf16_f32 v229, v26, v27
    v_mul_f32 v220, v20, v20
    v_mul_f32 v221, v21, v21
    v_mfma_f32_32x32x16_bf16 v[128:143], v[196:199], a[136:139], v[128:143]
    ds_read_b64_tr_b16 v[192:193], v243 offset:20480
    ds_read_b64_tr_b16 v[194:195], v243 offset:20736
    v_mul_f32 v222, v22, v22
    v_mul_f32 v223, v23, v23
    v_fma_f32 v220, v220, v246, v245
    v_fma_f32 v221, v221, v246, v245
    v_mfma_f32_32x32x16_bf16 v[144:159], v[196:199], a[140:143], v[144:159]
    v_fma_f32 v222, v222, v246, v245
    v_fma_f32 v223, v223, v246, v245
    v_mul_f32 v220, v20, v220
    v_mul_f32 v221, v21, v221
    v_mul_f32 v222, v22, v222
    s_waitcnt lgkmcnt(2)
    v_mfma_f32_32x32x16_bf16 v[128:143], v[200:203], a[144:147], v[128:143]
    ds_read_b64_tr_b16 v[196:197], v243 offset:21504
    ds_read_b64_tr_b16 v[198:199], v243 offset:21760
    v_mul_f32 v223, v23, v223
    v_exp_f32 v220, v220
    v_mfma_f32_32x32x16_bf16 v[144:159], v[200:203], a[148:151], v[144:159]
    v_exp_f32 v221, v221
    v_exp_f32 v222, v222
    v_exp_f32 v223, v223
    v_mfma_f32_32x32x16_bf16 v[128:143], v[204:207], a[152:155], v[128:143]
    ds_read_b64_tr_b16 v[200:201], v243 offset:22528
    ds_read_b64_tr_b16 v[202:203], v243 offset:22784
    v_mul_f32 v28, v20, v28
    v_mul_f32 v29, v21, v29
    v_mul_f32 v30, v22, v30
    v_mul_f32 v31, v23, v31
    v_mfma_f32_32x32x16_bf16 v[144:159], v[204:207], a[156:159], v[144:159]
    v_add_f32 v220, 1.0, v220
    v_add_f32 v221, 1.0, v221
    v_add_f32 v222, 1.0, v222
    v_add_f32 v223, 1.0, v223
    s_waitcnt lgkmcnt(2)
    v_mfma_f32_32x32x16_bf16 v[128:143], v[192:195], a[160:163], v[128:143]
    ds_read_b64_tr_b16 v[204:205], v243 offset:23552
    ds_read_b64_tr_b16 v[206:207], v243 offset:23808
    v_rcp_f32 v220, v220
    v_rcp_f32 v221, v221
    v_mfma_f32_32x32x16_bf16 v[144:159], v[192:195], a[164:167], v[144:159]
    v_rcp_f32 v222, v222
    v_rcp_f32 v223, v223
    v_mul_f32 v28, v28, v220
    v_mul_f32 v29, v29, v221
    v_mfma_f32_32x32x16_bf16 v[128:143], v[196:199], a[168:171], v[128:143]
    ds_read_b64_tr_b16 v[192:193], v243 offset:24576
    ds_read_b64_tr_b16 v[194:195], v243 offset:24832
    v_mul_f32 v30, v30, v222
    v_mul_f32 v31, v31, v223
    v_cvt_pk_bf16_f32 v230, v28, v29
    v_cvt_pk_bf16_f32 v231, v30, v31
    v_mfma_f32_32x32x16_bf16 v[144:159], v[196:199], a[172:175], v[144:159]
    s_add_u32 s45, s37, 294912
    buffer_store_dwordx4 v[228:231], v244, s[24:27], s45 offen sc1
    v_mul_f32 v208, v32, v32
    v_mul_f32 v209, v33, v33
    v_mul_f32 v210, v34, v34
    s_waitcnt lgkmcnt(2)
    v_mfma_f32_32x32x16_bf16 v[128:143], v[200:203], a[176:179], v[128:143]
    ds_read_b64_tr_b16 v[196:197], v243 offset:25600
    ds_read_b64_tr_b16 v[198:199], v243 offset:25856
    v_mul_f32 v211, v35, v35
    v_fma_f32 v208, v208, v246, v245
    v_fma_f32 v209, v209, v246, v245
    v_fma_f32 v210, v210, v246, v245
    v_mfma_f32_32x32x16_bf16 v[144:159], v[200:203], a[180:183], v[144:159]
    v_fma_f32 v211, v211, v246, v245
    v_mul_f32 v208, v32, v208
    v_mul_f32 v209, v33, v209
    v_mul_f32 v210, v34, v210
    v_mul_f32 v211, v35, v211
    v_mfma_f32_32x32x16_bf16 v[128:143], v[204:207], a[184:187], v[128:143]
    ds_read_b64_tr_b16 v[200:201], v243 offset:26624
    ds_read_b64_tr_b16 v[202:203], v243 offset:26880
    v_exp_f32 v208, v208
    v_exp_f32 v209, v209
    v_mfma_f32_32x32x16_bf16 v[144:159], v[204:207], a[188:191], v[144:159]
    v_exp_f32 v210, v210
    v_exp_f32 v211, v211
    v_mul_f32 v40, v32, v40
    s_waitcnt lgkmcnt(2)
    v_mfma_f32_32x32x16_bf16 v[128:143], v[192:195], a[192:195], v[128:143]
    ds_read_b64_tr_b16 v[204:205], v243 offset:27648
    ds_read_b64_tr_b16 v[206:207], v243 offset:27904
    v_mul_f32 v41, v33, v41
    v_mul_f32 v42, v34, v42
    v_mul_f32 v43, v35, v43
    v_add_f32 v208, 1.0, v208
    v_mfma_f32_32x32x16_bf16 v[144:159], v[192:195], a[196:199], v[144:159]
    v_add_f32 v209, 1.0, v209
    v_add_f32 v210, 1.0, v210
    v_add_f32 v211, 1.0, v211
    v_rcp_f32 v208, v208
    v_mfma_f32_32x32x16_bf16 v[128:143], v[196:199], a[200:203], v[128:143]
    ds_read_b64_tr_b16 v[192:193], v243 offset:28672
    ds_read_b64_tr_b16 v[194:195], v243 offset:28928
    v_rcp_f32 v209, v209
    v_rcp_f32 v210, v210
    v_mfma_f32_32x32x16_bf16 v[144:159], v[196:199], a[204:207], v[144:159]
    v_rcp_f32 v211, v211
    v_mul_f32 v40, v40, v208
    v_mul_f32 v41, v41, v209
    v_mul_f32 v42, v42, v210
    s_waitcnt lgkmcnt(2)
    v_mfma_f32_32x32x16_bf16 v[128:143], v[200:203], a[208:211], v[128:143]
    ds_read_b64_tr_b16 v[196:197], v243 offset:29696
    ds_read_b64_tr_b16 v[198:199], v243 offset:29952
    v_mul_f32 v43, v43, v211
    v_cvt_pk_bf16_f32 v224, v40, v41
    v_cvt_pk_bf16_f32 v225, v42, v43
    v_mul_f32 v212, v36, v36
    v_mfma_f32_32x32x16_bf16 v[144:159], v[200:203], a[212:215], v[144:159]
    v_mul_f32 v213, v37, v37
    v_mul_f32 v214, v38, v38
    v_mul_f32 v215, v39, v39
    v_fma_f32 v212, v212, v246, v245
    v_fma_f32 v213, v213, v246, v245
    v_fma_f32 v214, v214, v246, v245
    v_mfma_f32_32x32x16_bf16 v[128:143], v[204:207], a[216:219], v[128:143]
    ds_read_b64_tr_b16 v[200:201], v243 offset:30720
    ds_read_b64_tr_b16 v[202:203], v243 offset:30976
    v_fma_f32 v215, v215, v246, v245
    v_mul_f32 v212, v36, v212
    v_mul_f32 v213, v37, v213
    v_mul_f32 v214, v38, v214
    v_mfma_f32_32x32x16_bf16 v[144:159], v[204:207], a[220:223], v[144:159]
    v_mul_f32 v215, v39, v215
    v_exp_f32 v212, v212
    v_exp_f32 v213, v213
    s_waitcnt lgkmcnt(2)
    v_mfma_f32_32x32x16_bf16 v[128:143], v[192:195], a[224:227], v[128:143]
    ds_read_b64_tr_b16 v[204:205], v243 offset:31744
    ds_read_b64_tr_b16 v[206:207], v243 offset:32000
    v_exp_f32 v214, v214
    v_exp_f32 v215, v215
    v_mfma_f32_32x32x16_bf16 v[144:159], v[192:195], a[228:231], v[144:159]
    v_mul_f32 v44, v36, v44
    v_mul_f32 v45, v37, v45
    v_mul_f32 v46, v38, v46
    v_mul_f32 v47, v39, v47
    v_add_f32 v212, 1.0, v212
    v_add_f32 v213, 1.0, v213
    v_mfma_f32_32x32x16_bf16 v[128:143], v[196:199], a[232:235], v[128:143]
    ds_read_b64_tr_b16 v[192:193], v243 offset:32768
    ds_read_b64_tr_b16 v[194:195], v243 offset:33024
    v_add_f32 v214, 1.0, v214
    v_add_f32 v215, 1.0, v215
    v_rcp_f32 v212, v212
    v_mfma_f32_32x32x16_bf16 v[144:159], v[196:199], a[236:239], v[144:159]
    v_rcp_f32 v213, v213
    v_rcp_f32 v214, v214
    s_waitcnt lgkmcnt(2)
    v_mfma_f32_32x32x16_bf16 v[128:143], v[200:203], a[240:243], v[128:143]
    ds_read_b64_tr_b16 v[196:197], v243 offset:33792
    ds_read_b64_tr_b16 v[198:199], v243 offset:34048
    v_rcp_f32 v215, v215
    v_mul_f32 v44, v44, v212
    v_mul_f32 v45, v45, v213
    v_mfma_f32_32x32x16_bf16 v[144:159], v[200:203], a[244:247], v[144:159]
    v_mul_f32 v46, v46, v214
    v_mul_f32 v47, v47, v215
    v_cvt_pk_bf16_f32 v226, v44, v45
    v_cvt_pk_bf16_f32 v227, v46, v47
    s_add_u32 s44, s37, 512
    buffer_store_dwordx4 v[224:227], v244, s[24:27], s44 offen sc1
    v_mfma_f32_32x32x16_bf16 v[128:143], v[204:207], a[248:251], v[128:143]
    ds_read_b64_tr_b16 v[200:201], v243 offset:34816
    ds_read_b64_tr_b16 v[202:203], v243 offset:35072
    v_mul_f32 v216, v48, v48
    v_mul_f32 v217, v49, v49
    v_mul_f32 v218, v50, v50
    v_mul_f32 v219, v51, v51
    v_mfma_f32_32x32x16_bf16 v[144:159], v[204:207], a[252:255], v[144:159]
    v_fma_f32 v216, v216, v246, v245
    v_fma_f32 v217, v217, v246, v245
    v_fma_f32 v218, v218, v246, v245
    v_fma_f32 v219, v219, v246, v245
    v_mul_f32 v216, v48, v216
    s_waitcnt lgkmcnt(2)
    v_mfma_f32_32x32x16_bf16 v[128:143], v[192:195], v[160:163], v[128:143]
    ds_read_b64_tr_b16 v[204:205], v243 offset:35840
    ds_read_b64_tr_b16 v[206:207], v243 offset:36096
    v_mul_f32 v217, v49, v217
    v_mul_f32 v218, v50, v218
    v_mul_f32 v219, v51, v219
    v_mfma_f32_32x32x16_bf16 v[144:159], v[192:195], v[164:167], v[144:159]
    v_exp_f32 v216, v216
    v_exp_f32 v217, v217
    v_exp_f32 v218, v218
    v_mfma_f32_32x32x16_bf16 v[128:143], v[196:199], v[168:171], v[128:143]
    s_waitcnt vmcnt(2) lgkmcnt(0)
    s_barrier
    v_exp_f32 v219, v219
    v_mul_f32 v56, v48, v56
    v_mul_f32 v57, v49, v57
    v_mfma_f32_32x32x16_bf16 v[144:159], v[196:199], v[172:175], v[144:159]
    ds_read_b64_tr_b16 v[192:193], v237 offset:49664
    ds_read_b64_tr_b16 v[194:195], v237 offset:49920
    v_mul_f32 v58, v50, v58
    v_mul_f32 v59, v51, v59
    v_add_f32 v216, 1.0, v216
    v_mfma_f32_32x32x16_bf16 v[128:143], v[200:203], v[176:179], v[128:143]
    ds_read_b64_tr_b16 v[196:197], v237 offset:53888
    ds_read_b64_tr_b16 v[198:199], v237 offset:54144
    s_add_u32 m0, s34, 0
    s_add_u32 s40, s33, 4128768
    buffer_load_dwordx4 v242, s[20:23], s40 offen lds
    v_add_f32 v217, 1.0, v217
    v_mfma_f32_32x32x16_bf16 v[144:159], v[200:203], v[180:183], v[144:159]
    v_add_f32 v218, 1.0, v218
    v_add_f32 v219, 1.0, v219
    v_rcp_f32 v216, v216
    v_rcp_f32 v217, v217
    v_mfma_f32_32x32x16_bf16 v[128:143], v[204:207], v[184:187], v[128:143]
    ds_read_b64_tr_b16 v[200:201], v237 offset:58112
    ds_read_b64_tr_b16 v[202:203], v237 offset:58368
    v_rcp_f32 v218, v218
    v_rcp_f32 v219, v219
    v_mfma_f32_32x32x16_bf16 v[144:159], v[204:207], v[188:191], v[144:159]
    s_add_u32 m0, s34, 4224
    s_add_u32 s41, s33, 4276224
    buffer_load_dwordx4 v242, s[20:23], s41 offen lds
    v_mul_f32 v56, v56, v216
    v_mul_f32 v57, v57, v217
    s_waitcnt lgkmcnt(2)
    v_mfma_f32_32x32x16_bf16 v[0:15], v[192:195], a[0:3], 0
    ds_read_b64_tr_b16 v[204:205], v237 offset:62336
    ds_read_b64_tr_b16 v[206:207], v237 offset:62592
    v_mul_f32 v58, v58, v218
    v_mul_f32 v59, v59, v219
    v_cvt_pk_bf16_f32 v228, v56, v57
    v_cvt_pk_bf16_f32 v229, v58, v59
    v_mfma_f32_32x32x16_bf16 v[16:31], v[192:195], a[4:7], 0
    v_mul_f32 v220, v52, v52
    v_mul_f32 v221, v53, v53
    v_mul_f32 v222, v54, v54
    v_mul_f32 v223, v55, v55
    v_fma_f32 v220, v220, v246, v245
    v_fma_f32 v221, v221, v246, v245
    v_mfma_f32_32x32x16_bf16 v[0:15], v[196:199], a[8:11], v[0:15]
    ds_read_b64_tr_b16 v[192:193], v238 offset:1024
    ds_read_b64_tr_b16 v[194:195], v238 offset:1280
    s_add_u32 m0, s34, 8448
    s_add_u32 s40, s33, 4423680
    buffer_load_dwordx4 v242, s[20:23], s40 offen lds
    v_fma_f32 v222, v222, v246, v245
    v_mfma_f32_32x32x16_bf16 v[16:31], v[196:199], a[12:15], v[16:31]
    v_fma_f32 v223, v223, v246, v245
    v_mul_f32 v220, v52, v220
    v_mul_f32 v221, v53, v221
    v_mul_f32 v222, v54, v222
    v_mul_f32 v223, v55, v223
    s_waitcnt lgkmcnt(2)
    v_mfma_f32_32x32x16_bf16 v[0:15], v[200:203], a[16:19], v[0:15]
    ds_read_b64_tr_b16 v[196:197], v238 offset:5248
    ds_read_b64_tr_b16 v[198:199], v238 offset:5504
    v_exp_f32 v220, v220
    v_exp_f32 v221, v221
    v_mfma_f32_32x32x16_bf16 v[16:31], v[200:203], a[20:23], v[16:31]
    s_add_u32 m0, s34, 12672
    s_add_u32 s41, s33, 4571136
    buffer_load_dwordx4 v242, s[20:23], s41 offen lds
    v_exp_f32 v222, v222
    v_mfma_f32_32x32x16_bf16 v[0:15], v[204:207], a[24:27], v[0:15]
    ds_read_b64_tr_b16 v[200:201], v238 offset:9472
    ds_read_b64_tr_b16 v[202:203], v238 offset:9728
    v_exp_f32 v223, v223
    v_mul_f32 v60, v52, v60
    v_mul_f32 v61, v53, v61
    v_mfma_f32_32x32x16_bf16 v[16:31], v[204:207], a[28:31], v[16:31]
    v_mul_f32 v62, v54, v62
    v_mul_f32 v63, v55, v63
    v_add_f32 v220, 1.0, v220
    v_add_f32 v221, 1.0, v221
    v_add_f32 v222, 1.0, v222
    s_waitcnt lgkmcnt(2)
    v_mfma_f32_32x32x16_bf16 v[0:15], v[192:195], a[32:35], v[0:15]
    ds_read_b64_tr_b16 v[204:205], v238 offset:13696
    ds_read_b64_tr_b16 v[206:207], v238 offset:13952
    s_add_u32 m0, s34, 16896
    s_add_u32 s40, s33, 4718592
    buffer_load_dwordx4 v242, s[20:23], s40 offen lds
    v_add_f32 v223, 1.0, v223
    v_mfma_f32_32x32x16_bf16 v[16:31], v[192:195], a[36:39], v[16:31]
    v_rcp_f32 v220, v220
    v_rcp_f32 v221, v221
    v_rcp_f32 v222, v222
    v_mfma_f32_32x32x16_bf16 v[0:15], v[196:199], a[40:43], v[0:15]
    ds_read_b64_tr_b16 v[192:193], v238 offset:17920
    ds_read_b64_tr_b16 v[194:195], v238 offset:18176
    v_rcp_f32 v223, v223
    v_mul_f32 v60, v60, v220
    v_mul_f32 v61, v61, v221
    v_mfma_f32_32x32x16_bf16 v[16:31], v[196:199], a[44:47], v[16:31]
    s_add_u32 m0, s34, 21120
    s_add_u32 s41, s33, 4866048
    buffer_load_dwordx4 v242, s[20:23], s41 offen lds
    v_mul_f32 v62, v62, v222
    v_mul_f32 v63, v63, v223
    s_waitcnt lgkmcnt(2)
    v_mfma_f32_32x32x16_bf16 v[0:15], v[200:203], a[48:51], v[0:15]
    ds_read_b64_tr_b16 v[196:197], v238 offset:22144
    ds_read_b64_tr_b16 v[198:199], v238 offset:22400
    v_cvt_pk_bf16_f32 v230, v60, v61
    v_cvt_pk_bf16_f32 v231, v62, v63
    s_add_u32 s45, s37, 295424
    buffer_store_dwordx4 v[228:231], v244, s[24:27], s45 offen sc1
    v_mfma_f32_32x32x16_bf16 v[16:31], v[200:203], a[52:55], v[16:31]
    v_mul_f32 v208, v64, v64
    v_mul_f32 v209, v65, v65
    v_mul_f32 v210, v66, v66
    v_mul_f32 v211, v67, v67
    v_fma_f32 v208, v208, v246, v245
    v_fma_f32 v209, v209, v246, v245
    v_mfma_f32_32x32x16_bf16 v[0:15], v[204:207], a[56:59], v[0:15]
    ds_read_b64_tr_b16 v[200:201], v238 offset:26368
    ds_read_b64_tr_b16 v[202:203], v238 offset:26624
    s_add_u32 m0, s34, 25344
    s_add_u32 s40, s33, 5013504
    buffer_load_dwordx4 v242, s[20:23], s40 offen lds
    v_fma_f32 v210, v210, v246, v245
    v_mfma_f32_32x32x16_bf16 v[16:31], v[204:207], a[60:63], v[16:31]
    v_fma_f32 v211, v211, v246, v245
    v_mul_f32 v208, v64, v208
    v_mul_f32 v209, v65, v209
    v_mul_f32 v210, v66, v210
    v_mul_f32 v211, v67, v211
    s_waitcnt lgkmcnt(2)
    v_mfma_f32_32x32x16_bf16 v[0:15], v[192:195], a[64:67], v[0:15]
    ds_read_b64_tr_b16 v[204:205], v239 offset:17920
    ds_read_b64_tr_b16 v[206:207], v239 offset:18176
    v_exp_f32 v208, v208
    v_exp_f32 v209, v209
    v_mfma_f32_32x32x16_bf16 v[16:31], v[192:195], a[68:71], v[16:31]
    s_add_u32 m0, s34, 29568
    s_add_u32 s41, s33, 5160960
    buffer_load_dwordx4 v242, s[20:23], s41 offen lds
    v_exp_f32 v210, v210
    v_mfma_f32_32x32x16_bf16 v[0:15], v[196:199], a[72:75], v[0:15]
    ds_read_b64_tr_b16 v[192:193], v239 offset:22144
    ds_read_b64_tr_b16 v[194:195], v239 offset:22400
    v_exp_f32 v211, v211
    v_mul_f32 v72, v64, v72
    v_mul_f32 v73, v65, v73
    v_mfma_f32_32x32x16_bf16 v[16:31], v[196:199], a[76:79], v[16:31]
    v_mul_f32 v74, v66, v74
    v_mul_f32 v75, v67, v75
    v_add_f32 v208, 1.0, v208
    v_add_f32 v209, 1.0, v209
    v_add_f32 v210, 1.0, v210
    s_waitcnt lgkmcnt(2)
    v_mfma_f32_32x32x16_bf16 v[0:15], v[200:203], a[80:83], v[0:15]
    ds_read_b64_tr_b16 v[196:197], v239 offset:26368
    ds_read_b64_tr_b16 v[198:199], v239 offset:26624
    v_add_f32 v211, 1.0, v211
    v_rcp_f32 v208, v208
    v_mfma_f32_32x32x16_bf16 v[16:31], v[200:203], a[84:87], v[16:31]
    v_rcp_f32 v209, v209
    v_rcp_f32 v210, v210
    v_rcp_f32 v211, v211
    v_mfma_f32_32x32x16_bf16 v[0:15], v[204:207], a[88:91], v[0:15]
    ds_read_b64_tr_b16 v[200:201], v237 offset:36864
    ds_read_b64_tr_b16 v[202:203], v237 offset:37120
    v_mul_f32 v72, v72, v208
    v_mul_f32 v73, v73, v209
    v_mul_f32 v74, v74, v210
    v_mul_f32 v75, v75, v211
    v_mfma_f32_32x32x16_bf16 v[16:31], v[204:207], a[92:95], v[16:31]
    v_cvt_pk_bf16_f32 v224, v72, v73
    v_cvt_pk_bf16_f32 v225, v74, v75
    v_mul_f32 v212, v68, v68
    v_mul_f32 v213, v69, v69
    v_mul_f32 v214, v70, v70
    s_waitcnt lgkmcnt(2)
    v_mfma_f32_32x32x16_bf16 v[0:15], v[192:195], a[96:99], v[0:15]
    ds_read_b64_tr_b16 v[204:205], v237 offset:41088
    ds_read_b64_tr_b16 v[206:207], v237 offset:41344
    v_mul_f32 v215, v71, v71
    v_fma_f32 v212, v212, v246, v245
    v_fma_f32 v213, v213, v246, v245
    v_fma_f32 v214, v214, v246, v245
    v_mfma_f32_32x32x16_bf16 v[16:31], v[192:195], a[100:103], v[16:31]
    v_fma_f32 v215, v215, v246, v245
    v_mul_f32 v212, v68, v212
    v_mul_f32 v213, v69, v213
    v_mul_f32 v214, v70, v214
    v_mul_f32 v215, v71, v215
    v_mfma_f32_32x32x16_bf16 v[0:15], v[196:199], a[104:107], v[0:15]
    ds_read_b64_tr_b16 v[192:193], v237 offset:45312
    ds_read_b64_tr_b16 v[194:195], v237 offset:45568
    v_exp_f32 v212, v212
    v_exp_f32 v213, v213
    v_mfma_f32_32x32x16_bf16 v[16:31], v[196:199], a[108:111], v[16:31]
    v_exp_f32 v214, v214
    v_exp_f32 v215, v215
    v_mul_f32 v76, v68, v76
    s_waitcnt lgkmcnt(2)
    v_mfma_f32_32x32x16_bf16 v[0:15], v[200:203], a[112:115], v[0:15]
    ds_read_b64_tr_b16 v[196:197], v238 offset:33792
    ds_read_b64_tr_b16 v[198:199], v238 offset:34048
    v_mul_f32 v77, v69, v77
    v_mul_f32 v78, v70, v78
    v_mul_f32 v79, v71, v79
    v_add_f32 v212, 1.0, v212
    v_mfma_f32_32x32x16_bf16 v[16:31], v[200:203], a[116:119], v[16:31]
    v_add_f32 v213, 1.0, v213
    v_add_f32 v214, 1.0, v214
    v_add_f32 v215, 1.0, v215
    v_rcp_f32 v212, v212
    v_mfma_f32_32x32x16_bf16 v[0:15], v[204:207], a[120:123], v[0:15]
    ds_read_b64_tr_b16 v[200:201], v238 offset:38016
    ds_read_b64_tr_b16 v[202:203], v238 offset:38272
    v_rcp_f32 v213, v213
    v_rcp_f32 v214, v214
    v_mfma_f32_32x32x16_bf16 v[16:31], v[204:207], a[124:127], v[16:31]
    v_rcp_f32 v215, v215
    v_mul_f32 v76, v76, v212
    v_mul_f32 v77, v77, v213
    v_mul_f32 v78, v78, v214
    s_waitcnt lgkmcnt(2)
    v_mfma_f32_32x32x16_bf16 v[0:15], v[192:195], a[128:131], v[0:15]
    ds_read_b64_tr_b16 v[204:205], v238 offset:42240
    ds_read_b64_tr_b16 v[206:207], v238 offset:42496
    v_mul_f32 v79, v79, v215
    v_cvt_pk_bf16_f32 v226, v76, v77
    v_cvt_pk_bf16_f32 v227, v78, v79
    s_add_u32 s44, s37, 1024
    v_mfma_f32_32x32x16_bf16 v[16:31], v[192:195], a[132:135], v[16:31]
    buffer_store_dwordx4 v[224:227], v244, s[24:27], s44 offen sc1
    v_mul_f32 v216, v80, v80
    v_mul_f32 v217, v81, v81
    v_mul_f32 v218, v82, v82
    v_mul_f32 v219, v83, v83
    v_fma_f32 v216, v216, v246, v245
    v_mfma_f32_32x32x16_bf16 v[0:15], v[196:199], a[136:139], v[0:15]
    ds_read_b64_tr_b16 v[192:193], v238 offset:46464
    ds_read_b64_tr_b16 v[194:195], v238 offset:46720
    v_fma_f32 v217, v217, v246, v245
    v_fma_f32 v218, v218, v246, v245
    v_fma_f32 v219, v219, v246, v245
    v_mul_f32 v216, v80, v216
    v_mfma_f32_32x32x16_bf16 v[16:31], v[196:199], a[140:143], v[16:31]
    v_mul_f32 v217, v81, v217
    v_mul_f32 v218, v82, v218
    v_mul_f32 v219, v83, v219
    v_exp_f32 v216, v216
    s_waitcnt lgkmcnt(2)
    v_mfma_f32_32x32x16_bf16 v[0:15], v[200:203], a[144:147], v[0:15]
    ds_read_b64_tr_b16 v[196:197], v238 offset:50688
    ds_read_b64_tr_b16 v[198:199], v238 offset:50944
    v_exp_f32 v217, v217
    v_exp_f32 v218, v218
    v_mfma_f32_32x32x16_bf16 v[16:31], v[200:203], a[148:151], v[16:31]
    v_exp_f32 v219, v219
    v_mul_f32 v88, v80, v88
    v_mul_f32 v89, v81, v89
    v_mul_f32 v90, v82, v90
    v_mul_f32 v91, v83, v91
    v_mfma_f32_32x32x16_bf16 v[0:15], v[204:207], a[152:155], v[0:15]
    ds_read_b64_tr_b16 v[200:201], v238 offset:54912
    ds_read_b64_tr_b16 v[202:203], v238 offset:55168
    v_add_f32 v216, 1.0, v216
    v_add_f32 v217, 1.0, v217
    v_add_f32 v218, 1.0, v218
    v_add_f32 v219, 1.0, v219
    v_mfma_f32_32x32x16_bf16 v[16:31], v[204:207], a[156:159], v[16:31]
    v_rcp_f32 v216, v216
    v_rcp_f32 v217, v217
    s_waitcnt lgkmcnt(2)
    v_mfma_f32_32x32x16_bf16 v[0:15], v[192:195], a[160:163], v[0:15]
    ds_read_b64_tr_b16 v[204:205], v238 offset:59136
    ds_read_b64_tr_b16 v[206:207], v238 offset:59392
    v_rcp_f32 v218, v218
    v_rcp_f32 v219, v219
    v_mfma_f32_32x32x16_bf16 v[16:31], v[192:195], a[164:167], v[16:31]
    v_mul_f32 v88, v88, v216
    v_mul_f32 v89, v89, v217
    v_mul_f32 v90, v90, v218
    v_mul_f32 v91, v91, v219
    v_cvt_pk_bf16_f32 v228, v88, v89
    v_cvt_pk_bf16_f32 v229, v90, v91
    v_mfma_f32_32x32x16_bf16 v[0:15], v[196:199], a[168:171], v[0:15]
    ds_read_b64_tr_b16 v[192:193], v238 offset:63360
    ds_read_b64_tr_b16 v[194:195], v238 offset:63616
    v_mul_f32 v220, v84, v84
    v_mul_f32 v221, v85, v85
    v_mul_f32 v222, v86, v86
    v_mul_f32 v223, v87, v87
    v_mfma_f32_32x32x16_bf16 v[16:31], v[196:199], a[172:175], v[16:31]
    v_fma_f32 v220, v220, v246, v245
    v_fma_f32 v221, v221, v246, v245
    v_fma_f32 v222, v222, v246, v245
    v_fma_f32 v223, v223, v246, v245
    v_mul_f32 v220, v84, v220
    s_waitcnt lgkmcnt(2)
    v_mfma_f32_32x32x16_bf16 v[0:15], v[200:203], a[176:179], v[0:15]
    ds_read_b64_tr_b16 v[196:197], v239 offset:2048
    ds_read_b64_tr_b16 v[198:199], v239 offset:2304
    v_mul_f32 v221, v85, v221
    v_mul_f32 v222, v86, v222
    v_mul_f32 v223, v87, v223
    v_mfma_f32_32x32x16_bf16 v[16:31], v[200:203], a[180:183], v[16:31]
    v_exp_f32 v220, v220
    v_exp_f32 v221, v221
    v_exp_f32 v222, v222
    v_mfma_f32_32x32x16_bf16 v[0:15], v[204:207], a[184:187], v[0:15]
    ds_read_b64_tr_b16 v[200:201], v239 offset:6272
    ds_read_b64_tr_b16 v[202:203], v239 offset:6528
    v_exp_f32 v223, v223
    v_mul_f32 v92, v84, v92
    v_mul_f32 v93, v85, v93
    v_mfma_f32_32x32x16_bf16 v[16:31], v[204:207], a[188:191], v[16:31]
    v_mul_f32 v94, v86, v94
    v_mul_f32 v95, v87, v95
    v_add_f32 v220, 1.0, v220
    v_add_f32 v221, 1.0, v221
    v_add_f32 v222, 1.0, v222
    s_waitcnt lgkmcnt(2)
    v_mfma_f32_32x32x16_bf16 v[0:15], v[192:195], a[192:195], v[0:15]
    ds_read_b64_tr_b16 v[204:205], v239 offset:10496
    ds_read_b64_tr_b16 v[206:207], v239 offset:10752
    s_lshr_b32 s47, s2, 3
    s_lshl_b32 s47, s47, 2
    s_add_u32 s47, s47, s28
    s_mul_i32 s47, s47, 8192
    s_mul_i32 s85, s3, 1327104
    s_add_u32 s85, s85, s47
    v_mfma_f32_32x32x16_bf16 v[16:31], v[192:195], a[196:199], v[16:31]
    v_add_f32 v223, 1.0, v223
    v_rcp_f32 v220, v220
    v_rcp_f32 v221, v221
    v_mfma_f32_32x32x16_bf16 v[0:15], v[196:199], a[200:203], v[0:15]
    s_waitcnt vmcnt(1)
    s_barrier
    v_lshlrev_b32 v240, 3, v255
    v_rcp_f32 v222, v222
    v_mfma_f32_32x32x16_bf16 v[16:31], v[196:199], a[204:207], v[16:31]
    ds_read_b64_tr_b16 v[192:193], v237
    ds_read_b64_tr_b16 v[194:195], v237 offset:256
    v_rcp_f32 v223, v223
    v_mul_f32 v92, v92, v220
    s_waitcnt lgkmcnt(2)
    v_mfma_f32_32x32x16_bf16 v[0:15], v[200:203], a[208:211], v[0:15]
    ds_read_b64_tr_b16 v[196:197], v237 offset:4224
    ds_read_b64_tr_b16 v[198:199], v237 offset:4480
    v_mul_f32 v93, v93, v221
    v_mul_f32 v94, v94, v222
    v_mul_f32 v95, v95, v223
    v_cvt_pk_bf16_f32 v230, v92, v93
    v_mfma_f32_32x32x16_bf16 v[16:31], v[200:203], a[212:215], v[16:31]
    v_cvt_pk_bf16_f32 v231, v94, v95
    s_add_u32 s45, s37, 295936
    buffer_store_dwordx4 v[228:231], v244, s[24:27], s45 offen sc1
    v_mul_f32 v208, v96, v96
    v_mul_f32 v209, v97, v97
    v_mul_f32 v210, v98, v98
    v_mfma_f32_32x32x16_bf16 v[0:15], v[204:207], a[216:219], v[0:15]
    ds_read_b64_tr_b16 v[200:201], v237 offset:8448
    ds_read_b64_tr_b16 v[202:203], v237 offset:8704
    buffer_load_dword v241, v240, s[52:55], s85 offen
    s_add_u32 s85, s85, 1048576
    v_mul_f32 v211, v99, v99
    v_fma_f32 v208, v208, v246, v245
    v_mfma_f32_32x32x16_bf16 v[16:31], v[204:207], a[220:223], v[16:31]
    v_fma_f32 v209, v209, v246, v245
    v_fma_f32 v210, v210, v246, v245
    v_fma_f32 v211, v211, v246, v245
    v_mul_f32 v208, v96, v208
    v_mul_f32 v209, v97, v209
    s_waitcnt lgkmcnt(2)
    v_mfma_f32_32x32x16_bf16 v[0:15], v[192:195], a[224:227], v[0:15]
    ds_read_b64_tr_b16 v[204:205], v237 offset:12672
    ds_read_b64_tr_b16 v[206:207], v237 offset:12928
    v_mul_f32 v210, v98, v210
    v_mul_f32 v211, v99, v211
    v_exp_f32 v208, v208
    v_mfma_f32_32x32x16_bf16 v[16:31], v[192:195], a[228:231], v[16:31]
    v_exp_f32 v209, v209
    v_exp_f32 v210, v210
    v_exp_f32 v211, v211
    v_mfma_f32_32x32x16_bf16 v[0:15], v[196:199], a[232:235], v[0:15]
    ds_read_b64_tr_b16 v[192:193], v237 offset:16896
    ds_read_b64_tr_b16 v[194:195], v237 offset:17152
    v_mul_f32 v104, v96, v104
    v_mul_f32 v105, v97, v105
    v_mul_f32 v106, v98, v106
    v_mul_f32 v107, v99, v107
    v_mfma_f32_32x32x16_bf16 v[16:31], v[196:199], a[236:239], v[16:31]
    v_add_f32 v208, 1.0, v208
    v_add_f32 v209, 1.0, v209
    v_add_f32 v210, 1.0, v210
    v_add_f32 v211, 1.0, v211
    s_waitcnt lgkmcnt(2)
    v_mfma_f32_32x32x16_bf16 v[0:15], v[200:203], a[240:243], v[0:15]
    ds_read_b64_tr_b16 v[196:197], v237 offset:21120
    ds_read_b64_tr_b16 v[198:199], v237 offset:21376
    v_rcp_f32 v208, v208
    v_rcp_f32 v209, v209
    v_mfma_f32_32x32x16_bf16 v[16:31], v[200:203], a[244:247], v[16:31]
    v_rcp_f32 v210, v210
    v_rcp_f32 v211, v211
    v_mul_f32 v104, v104, v208
    v_mul_f32 v105, v105, v209
    v_mfma_f32_32x32x16_bf16 v[0:15], v[204:207], a[248:251], v[0:15]
    ds_read_b64_tr_b16 v[200:201], v237 offset:25344
    ds_read_b64_tr_b16 v[202:203], v237 offset:25600
    v_mul_f32 v106, v106, v210
    v_mul_f32 v107, v107, v211
    v_cvt_pk_bf16_f32 v224, v104, v105
    v_cvt_pk_bf16_f32 v225, v106, v107
    v_mfma_f32_32x32x16_bf16 v[16:31], v[204:207], a[252:255], v[16:31]
    v_mul_f32 v212, v100, v100
    v_mul_f32 v213, v101, v101
    v_mul_f32 v214, v102, v102
    v_mul_f32 v215, v103, v103
    v_fma_f32 v212, v212, v246, v245
    s_waitcnt lgkmcnt(2)
    v_mfma_f32_32x32x16_bf16 v[0:15], v[192:195], v[160:163], v[0:15]
    ds_read_b64_tr_b16 v[204:205], v237 offset:29568
    ds_read_b64_tr_b16 v[206:207], v237 offset:29824
    v_fma_f32 v213, v213, v246, v245
    v_fma_f32 v214, v214, v246, v245
    v_fma_f32 v215, v215, v246, v245
    v_mul_f32 v212, v100, v212
    v_mfma_f32_32x32x16_bf16 v[16:31], v[192:195], v[164:167], v[16:31]
    v_mul_f32 v213, v101, v213
    v_mul_f32 v214, v102, v214
    v_mul_f32 v215, v103, v215
    v_exp_f32 v212, v212
    v_mfma_f32_32x32x16_bf16 v[0:15], v[196:199], v[168:171], v[0:15]
    ds_read_b64_tr_b16 v[192:193], v237 offset:49696
    ds_read_b64_tr_b16 v[194:195], v237 offset:49952
    v_exp_f32 v213, v213
    v_exp_f32 v214, v214
    v_mfma_f32_32x32x16_bf16 v[16:31], v[196:199], v[172:175], v[16:31]
    v_exp_f32 v215, v215
    v_mul_f32 v108, v100, v108
    v_mul_f32 v109, v101, v109
    v_mul_f32 v110, v102, v110
    s_waitcnt lgkmcnt(2)
    v_mfma_f32_32x32x16_bf16 v[0:15], v[200:203], v[176:179], v[0:15]
    ds_read_b64_tr_b16 v[196:197], v237 offset:53920
    ds_read_b64_tr_b16 v[198:199], v237 offset:54176
    v_mul_f32 v111, v103, v111
    v_add_f32 v212, 1.0, v212
    v_add_f32 v213, 1.0, v213
    v_add_f32 v214, 1.0, v214
    v_mfma_f32_32x32x16_bf16 v[16:31], v[200:203], v[180:183], v[16:31]
    v_add_f32 v215, 1.0, v215
    v_rcp_f32 v212, v212
    v_rcp_f32 v213, v213
    v_mfma_f32_32x32x16_bf16 v[0:15], v[204:207], v[184:187], v[0:15]
    ds_read_b64_tr_b16 v[200:201], v237 offset:58144
    ds_read_b64_tr_b16 v[202:203], v237 offset:58400
    v_rcp_f32 v214, v214
    v_rcp_f32 v215, v215
    v_mfma_f32_32x32x16_bf16 v[16:31], v[204:207], v[188:191], v[16:31]
    v_mul_f32 v108, v108, v212
    v_mul_f32 v109, v109, v213
    v_mul_f32 v110, v110, v214
    v_mul_f32 v111, v111, v215
    v_cvt_pk_bf16_f32 v226, v108, v109
    s_waitcnt lgkmcnt(2)
    v_mfma_f32_32x32x16_bf16 v[32:47], v[192:195], a[0:3], 0
    ds_read_b64_tr_b16 v[204:205], v237 offset:62368
    ds_read_b64_tr_b16 v[206:207], v237 offset:62624
    v_cvt_pk_bf16_f32 v227, v110, v111
    s_add_u32 s44, s37, 1536
    buffer_store_dwordx4 v[224:227], v244, s[24:27], s44 offen sc1
    v_mul_f32 v216, v112, v112
    v_mfma_f32_32x32x16_bf16 v[48:63], v[192:195], a[4:7], 0
    v_mul_f32 v217, v113, v113
    v_mul_f32 v218, v114, v114
    v_mul_f32 v219, v115, v115
    v_fma_f32 v216, v216, v246, v245
    v_fma_f32 v217, v217, v246, v245
    v_fma_f32 v218, v218, v246, v245
    v_mfma_f32_32x32x16_bf16 v[32:47], v[196:199], a[8:11], v[32:47]
    ds_read_b64_tr_b16 v[192:193], v238 offset:1056
    ds_read_b64_tr_b16 v[194:195], v238 offset:1312
    v_fma_f32 v219, v219, v246, v245
    v_mul_f32 v216, v112, v216
    v_mul_f32 v217, v113, v217
    v_mul_f32 v218, v114, v218
    v_mfma_f32_32x32x16_bf16 v[48:63], v[196:199], a[12:15], v[48:63]
    v_mul_f32 v219, v115, v219
    v_exp_f32 v216, v216
    v_exp_f32 v217, v217
    s_waitcnt lgkmcnt(2)
    v_mfma_f32_32x32x16_bf16 v[32:47], v[200:203], a[16:19], v[32:47]
    ds_read_b64_tr_b16 v[196:197], v238 offset:5280
    ds_read_b64_tr_b16 v[198:199], v238 offset:5536
    v_exp_f32 v218, v218
    v_exp_f32 v219, v219
    v_mfma_f32_32x32x16_bf16 v[48:63], v[200:203], a[20:23], v[48:63]
    v_mul_f32 v120, v112, v120
    v_mul_f32 v121, v113, v121
    v_mul_f32 v122, v114, v122
    v_mul_f32 v123, v115, v123
    v_add_f32 v216, 1.0, v216
    v_add_f32 v217, 1.0, v217
    v_mfma_f32_32x32x16_bf16 v[32:47], v[204:207], a[24:27], v[32:47]
    ds_read_b64_tr_b16 v[200:201], v238 offset:9504
    ds_read_b64_tr_b16 v[202:203], v238 offset:9760
    v_add_f32 v218, 1.0, v218
    v_add_f32 v219, 1.0, v219
    v_rcp_f32 v216, v216
    v_mfma_f32_32x32x16_bf16 v[48:63], v[204:207], a[28:31], v[48:63]
    v_rcp_f32 v217, v217
    v_rcp_f32 v218, v218
    s_waitcnt lgkmcnt(2)
    v_mfma_f32_32x32x16_bf16 v[32:47], v[192:195], a[32:35], v[32:47]
    ds_read_b64_tr_b16 v[204:205], v238 offset:13728
    ds_read_b64_tr_b16 v[206:207], v238 offset:13984
    v_rcp_f32 v219, v219
    v_mul_f32 v120, v120, v216
    v_mul_f32 v121, v121, v217
    v_mfma_f32_32x32x16_bf16 v[48:63], v[192:195], a[36:39], v[48:63]
    v_mul_f32 v122, v122, v218
    v_mul_f32 v123, v123, v219
    v_cvt_pk_bf16_f32 v228, v120, v121
    v_cvt_pk_bf16_f32 v229, v122, v123
    v_mul_f32 v220, v116, v116
    v_mul_f32 v221, v117, v117
    v_mfma_f32_32x32x16_bf16 v[32:47], v[196:199], a[40:43], v[32:47]
    ds_read_b64_tr_b16 v[192:193], v238 offset:17952
    ds_read_b64_tr_b16 v[194:195], v238 offset:18208
    v_mul_f32 v222, v118, v118
    v_mul_f32 v223, v119, v119
    v_fma_f32 v220, v220, v246, v245
    v_fma_f32 v221, v221, v246, v245
    v_mfma_f32_32x32x16_bf16 v[48:63], v[196:199], a[44:47], v[48:63]
    v_fma_f32 v222, v222, v246, v245
    v_fma_f32 v223, v223, v246, v245
    v_mul_f32 v220, v116, v220
    v_mul_f32 v221, v117, v221
    v_mul_f32 v222, v118, v222
    s_waitcnt lgkmcnt(2)
    v_mfma_f32_32x32x16_bf16 v[32:47], v[200:203], a[48:51], v[32:47]
    ds_read_b64_tr_b16 v[196:197], v238 offset:22176
    ds_read_b64_tr_b16 v[198:199], v238 offset:22432
    v_mul_f32 v223, v119, v223
    v_exp_f32 v220, v220
    v_mfma_f32_32x32x16_bf16 v[48:63], v[200:203], a[52:55], v[48:63]
    v_exp_f32 v221, v221
    v_exp_f32 v222, v222
    v_exp_f32 v223, v223
    v_mfma_f32_32x32x16_bf16 v[32:47], v[204:207], a[56:59], v[32:47]
    ds_read_b64_tr_b16 v[200:201], v238 offset:26400
    ds_read_b64_tr_b16 v[202:203], v238 offset:26656
    v_mul_f32 v124, v116, v124
    v_mul_f32 v125, v117, v125
    v_mul_f32 v126, v118, v126
    v_mul_f32 v127, v119, v127
    v_mfma_f32_32x32x16_bf16 v[48:63], v[204:207], a[60:63], v[48:63]
    v_add_f32 v220, 1.0, v220
    v_add_f32 v221, 1.0, v221
    v_add_f32 v222, 1.0, v222
    v_add_f32 v223, 1.0, v223
    s_waitcnt lgkmcnt(2)
    v_mfma_f32_32x32x16_bf16 v[32:47], v[192:195], a[64:67], v[32:47]
    ds_read_b64_tr_b16 v[204:205], v239 offset:17952
    ds_read_b64_tr_b16 v[206:207], v239 offset:18208
    v_rcp_f32 v220, v220
    v_rcp_f32 v221, v221
    v_mfma_f32_32x32x16_bf16 v[48:63], v[192:195], a[68:71], v[48:63]
    v_rcp_f32 v222, v222
    v_rcp_f32 v223, v223
    v_mul_f32 v124, v124, v220
    v_mul_f32 v125, v125, v221
    v_mfma_f32_32x32x16_bf16 v[32:47], v[196:199], a[72:75], v[32:47]
    ds_read_b64_tr_b16 v[192:193], v239 offset:22176
    ds_read_b64_tr_b16 v[194:195], v239 offset:22432
    v_mul_f32 v126, v126, v222
    v_mul_f32 v127, v127, v223
    v_cvt_pk_bf16_f32 v230, v124, v125
    v_cvt_pk_bf16_f32 v231, v126, v127
    v_mfma_f32_32x32x16_bf16 v[48:63], v[196:199], a[76:79], v[48:63]
    s_add_u32 s45, s37, 296448
    buffer_store_dwordx4 v[228:231], v244, s[24:27], s45 offen sc1
    v_mul_f32 v208, v128, v128
    v_mul_f32 v209, v129, v129
    v_mul_f32 v210, v130, v130
    s_waitcnt lgkmcnt(2)
    v_mfma_f32_32x32x16_bf16 v[32:47], v[200:203], a[80:83], v[32:47]
    ds_read_b64_tr_b16 v[196:197], v239 offset:26400
    ds_read_b64_tr_b16 v[198:199], v239 offset:26656
    v_mul_f32 v211, v131, v131
    v_fma_f32 v208, v208, v246, v245
    v_fma_f32 v209, v209, v246, v245
    v_fma_f32 v210, v210, v246, v245
    v_mfma_f32_32x32x16_bf16 v[48:63], v[200:203], a[84:87], v[48:63]
    v_fma_f32 v211, v211, v246, v245
    v_mul_f32 v208, v128, v208
    v_mul_f32 v209, v129, v209
    v_mul_f32 v210, v130, v210
    v_mul_f32 v211, v131, v211
    v_mfma_f32_32x32x16_bf16 v[32:47], v[204:207], a[88:91], v[32:47]
    ds_read_b64_tr_b16 v[200:201], v237 offset:36896
    ds_read_b64_tr_b16 v[202:203], v237 offset:37152
    v_exp_f32 v208, v208
    v_exp_f32 v209, v209
    v_mfma_f32_32x32x16_bf16 v[48:63], v[204:207], a[92:95], v[48:63]
    v_exp_f32 v210, v210
    v_exp_f32 v211, v211
    v_mul_f32 v136, v128, v136
    s_waitcnt lgkmcnt(2)
    v_mfma_f32_32x32x16_bf16 v[32:47], v[192:195], a[96:99], v[32:47]
    ds_read_b64_tr_b16 v[204:205], v237 offset:41120
    ds_read_b64_tr_b16 v[206:207], v237 offset:41376
    v_mul_f32 v137, v129, v137
    v_mul_f32 v138, v130, v138
    v_mul_f32 v139, v131, v139
    v_add_f32 v208, 1.0, v208
    v_mfma_f32_32x32x16_bf16 v[48:63], v[192:195], a[100:103], v[48:63]
    v_add_f32 v209, 1.0, v209
    v_add_f32 v210, 1.0, v210
    v_add_f32 v211, 1.0, v211
    v_rcp_f32 v208, v208
    v_mfma_f32_32x32x16_bf16 v[32:47], v[196:199], a[104:107], v[32:47]
    ds_read_b64_tr_b16 v[192:193], v237 offset:45344
    ds_read_b64_tr_b16 v[194:195], v237 offset:45600
    v_rcp_f32 v209, v209
    v_rcp_f32 v210, v210
    v_mfma_f32_32x32x16_bf16 v[48:63], v[196:199], a[108:111], v[48:63]
    v_rcp_f32 v211, v211
    v_mul_f32 v136, v136, v208
    v_mul_f32 v137, v137, v209
    v_mul_f32 v138, v138, v210
    s_waitcnt lgkmcnt(2)
    v_mfma_f32_32x32x16_bf16 v[32:47], v[200:203], a[112:115], v[32:47]
    ds_read_b64_tr_b16 v[196:197], v238 offset:33824
    ds_read_b64_tr_b16 v[198:199], v238 offset:34080
    v_mul_f32 v139, v139, v211
    v_cvt_pk_bf16_f32 v224, v136, v137
    v_cvt_pk_bf16_f32 v225, v138, v139
    v_mul_f32 v212, v132, v132
    v_mfma_f32_32x32x16_bf16 v[48:63], v[200:203], a[116:119], v[48:63]
    v_mul_f32 v213, v133, v133
    v_mul_f32 v214, v134, v134
    v_mul_f32 v215, v135, v135
    v_fma_f32 v212, v212, v246, v245
    v_fma_f32 v213, v213, v246, v245
    v_fma_f32 v214, v214, v246, v245
    v_mfma_f32_32x32x16_bf16 v[32:47], v[204:207], a[120:123], v[32:47]
    ds_read_b64_tr_b16 v[200:201], v238 offset:38048
    ds_read_b64_tr_b16 v[202:203], v238 offset:38304
    v_fma_f32 v215, v215, v246, v245
    v_mul_f32 v212, v132, v212
    v_mul_f32 v213, v133, v213
    v_mul_f32 v214, v134, v214
    v_mfma_f32_32x32x16_bf16 v[48:63], v[204:207], a[124:127], v[48:63]
    v_mul_f32 v215, v135, v215
    v_exp_f32 v212, v212
    v_exp_f32 v213, v213
    s_waitcnt lgkmcnt(2)
    v_mfma_f32_32x32x16_bf16 v[32:47], v[192:195], a[128:131], v[32:47]
    ds_read_b64_tr_b16 v[204:205], v238 offset:42272
    ds_read_b64_tr_b16 v[206:207], v238 offset:42528
    buffer_load_dword v242, v240, s[52:55], s85 offen
    v_exp_f32 v214, v214
    v_mfma_f32_32x32x16_bf16 v[48:63], v[192:195], a[132:135], v[48:63]
    v_exp_f32 v215, v215
    v_mul_f32 v140, v132, v140
    v_mul_f32 v141, v133, v141
    v_mul_f32 v142, v134, v142
    v_mul_f32 v143, v135, v143
    v_mfma_f32_32x32x16_bf16 v[32:47], v[196:199], a[136:139], v[32:47]
    ds_read_b64_tr_b16 v[192:193], v238 offset:46496
    ds_read_b64_tr_b16 v[194:195], v238 offset:46752
    v_add_f32 v212, 1.0, v212
    v_add_f32 v213, 1.0, v213
    v_add_f32 v214, 1.0, v214
    v_add_f32 v215, 1.0, v215
    v_mfma_f32_32x32x16_bf16 v[48:63], v[196:199], a[140:143], v[48:63]
    v_rcp_f32 v212, v212
    v_rcp_f32 v213, v213
    s_waitcnt lgkmcnt(2)
    v_mfma_f32_32x32x16_bf16 v[32:47], v[200:203], a[144:147], v[32:47]
    ds_read_b64_tr_b16 v[196:197], v238 offset:50720
    ds_read_b64_tr_b16 v[198:199], v238 offset:50976
    v_rcp_f32 v214, v214
    v_rcp_f32 v215, v215
    v_mfma_f32_32x32x16_bf16 v[48:63], v[200:203], a[148:151], v[48:63]
    v_mul_f32 v140, v140, v212
    v_mul_f32 v141, v141, v213
    v_mul_f32 v142, v142, v214
    v_mul_f32 v143, v143, v215
    v_cvt_pk_bf16_f32 v226, v140, v141
    v_cvt_pk_bf16_f32 v227, v142, v143
    v_mfma_f32_32x32x16_bf16 v[32:47], v[204:207], a[152:155], v[32:47]
    ds_read_b64_tr_b16 v[200:201], v238 offset:54944
    ds_read_b64_tr_b16 v[202:203], v238 offset:55200
    s_add_u32 s44, s38, 0
    buffer_store_dwordx4 v[224:227], v244, s[24:27], s44 offen sc1
    v_mul_f32 v216, v144, v144
    v_mul_f32 v217, v145, v145
    v_mfma_f32_32x32x16_bf16 v[48:63], v[204:207], a[156:159], v[48:63]
    v_mul_f32 v218, v146, v146
    v_mul_f32 v219, v147, v147
    v_fma_f32 v216, v216, v246, v245
    v_fma_f32 v217, v217, v246, v245
    v_fma_f32 v218, v218, v246, v245
    s_waitcnt lgkmcnt(2)
    v_mfma_f32_32x32x16_bf16 v[32:47], v[192:195], a[160:163], v[32:47]
    ds_read_b64_tr_b16 v[204:205], v238 offset:59168
    ds_read_b64_tr_b16 v[206:207], v238 offset:59424
    v_fma_f32 v219, v219, v246, v245
    v_mul_f32 v216, v144, v216
    v_mul_f32 v217, v145, v217
    v_mul_f32 v218, v146, v218
    v_mfma_f32_32x32x16_bf16 v[48:63], v[192:195], a[164:167], v[48:63]
    v_mul_f32 v219, v147, v219
    v_exp_f32 v216, v216
    v_exp_f32 v217, v217
    v_mfma_f32_32x32x16_bf16 v[32:47], v[196:199], a[168:171], v[32:47]
    ds_read_b64_tr_b16 v[192:193], v238 offset:63392
    ds_read_b64_tr_b16 v[194:195], v238 offset:63648
    v_exp_f32 v218, v218
    v_exp_f32 v219, v219
    v_mfma_f32_32x32x16_bf16 v[48:63], v[196:199], a[172:175], v[48:63]
    v_mul_f32 v152, v144, v152
    v_mul_f32 v153, v145, v153
    v_mul_f32 v154, v146, v154
    v_mul_f32 v155, v147, v155
    v_add_f32 v216, 1.0, v216
    s_waitcnt lgkmcnt(2)
    v_mfma_f32_32x32x16_bf16 v[32:47], v[200:203], a[176:179], v[32:47]
    ds_read_b64_tr_b16 v[196:197], v239 offset:2080
    ds_read_b64_tr_b16 v[198:199], v239 offset:2336
    v_add_f32 v217, 1.0, v217
    v_add_f32 v218, 1.0, v218
    v_add_f32 v219, 1.0, v219
    v_mfma_f32_32x32x16_bf16 v[48:63], v[200:203], a[180:183], v[48:63]
    v_rcp_f32 v216, v216
    v_rcp_f32 v217, v217
    v_rcp_f32 v218, v218
    v_mfma_f32_32x32x16_bf16 v[32:47], v[204:207], a[184:187], v[32:47]
    ds_read_b64_tr_b16 v[200:201], v239 offset:6304
    ds_read_b64_tr_b16 v[202:203], v239 offset:6560
    v_rcp_f32 v219, v219
    v_mul_f32 v152, v152, v216
    v_mul_f32 v153, v153, v217
    v_mfma_f32_32x32x16_bf16 v[48:63], v[204:207], a[188:191], v[48:63]
    v_mul_f32 v154, v154, v218
    v_mul_f32 v155, v155, v219
    v_cvt_pk_bf16_f32 v228, v152, v153
    v_cvt_pk_bf16_f32 v229, v154, v155
    v_mul_f32 v220, v148, v148
    s_waitcnt lgkmcnt(2)
    v_mfma_f32_32x32x16_bf16 v[32:47], v[192:195], a[192:195], v[32:47]
    ds_read_b64_tr_b16 v[204:205], v239 offset:10528
    ds_read_b64_tr_b16 v[206:207], v239 offset:10784
    v_mul_f32 v221, v149, v149
    v_mul_f32 v222, v150, v150
    v_mul_f32 v223, v151, v151
    v_fma_f32 v220, v220, v246, v245
    v_mfma_f32_32x32x16_bf16 v[48:63], v[192:195], a[196:199], v[48:63]
    v_fma_f32 v221, v221, v246, v245
    v_fma_f32 v222, v222, v246, v245
    v_fma_f32 v223, v223, v246, v245
    v_mul_f32 v220, v148, v220
    v_mul_f32 v221, v149, v221
    v_mul_f32 v222, v150, v222
    v_mfma_f32_32x32x16_bf16 v[32:47], v[196:199], a[200:203], v[32:47]
    ds_read_b64_tr_b16 v[192:193], v237 offset:32
    ds_read_b64_tr_b16 v[194:195], v237 offset:288
    v_mul_f32 v223, v151, v223
    v_exp_f32 v220, v220
    v_mfma_f32_32x32x16_bf16 v[48:63], v[196:199], a[204:207], v[48:63]
    v_exp_f32 v221, v221
    v_exp_f32 v222, v222
    s_waitcnt lgkmcnt(2)
    v_mfma_f32_32x32x16_bf16 v[32:47], v[200:203], a[208:211], v[32:47]
    ds_read_b64_tr_b16 v[196:197], v237 offset:4256
    ds_read_b64_tr_b16 v[198:199], v237 offset:4512
    v_exp_f32 v223, v223
    v_mul_f32 v156, v148, v156
    v_mul_f32 v157, v149, v157
    v_mfma_f32_32x32x16_bf16 v[48:63], v[200:203], a[212:215], v[48:63]
    v_mul_f32 v158, v150, v158
    v_mul_f32 v159, v151, v159
    v_add_f32 v220, 1.0, v220
    v_add_f32 v221, 1.0, v221
    v_add_f32 v222, 1.0, v222
    v_add_f32 v223, 1.0, v223
    v_mfma_f32_32x32x16_bf16 v[32:47], v[204:207], a[216:219], v[32:47]
    ds_read_b64_tr_b16 v[200:201], v237 offset:8480
    ds_read_b64_tr_b16 v[202:203], v237 offset:8736
    v_rcp_f32 v220, v220
    v_rcp_f32 v221, v221
    v_mfma_f32_32x32x16_bf16 v[48:63], v[204:207], a[220:223], v[48:63]
    v_rcp_f32 v222, v222
    v_rcp_f32 v223, v223
    v_mul_f32 v156, v156, v220
    s_waitcnt lgkmcnt(2)
    v_mfma_f32_32x32x16_bf16 v[32:47], v[192:195], a[224:227], v[32:47]
    ds_read_b64_tr_b16 v[204:205], v237 offset:12704
    ds_read_b64_tr_b16 v[206:207], v237 offset:12960
    v_add_u32 v232, 65536, v252
    v_add_u32 v233, 131072, v252
    v_add_u32 v234, 65536, v253
    v_add_u32 v235, 131072, v253
    v_mfma_f32_32x32x16_bf16 v[48:63], v[192:195], a[228:231], v[48:63]
    v_mul_f32 v157, v157, v221
    v_mul_f32 v158, v158, v222
    v_mul_f32 v159, v159, v223
    v_cvt_pk_bf16_f32 v230, v156, v157
    v_cvt_pk_bf16_f32 v231, v158, v159
    s_add_u32 s45, s38, 294912
    v_mfma_f32_32x32x16_bf16 v[32:47], v[196:199], a[232:235], v[32:47]
    ds_read_b64_tr_b16 v[192:193], v237 offset:16928
    ds_read_b64_tr_b16 v[194:195], v237 offset:17184
    buffer_store_dwordx4 v[228:231], v244, s[24:27], s45 offen sc1
    v_mul_f32 v208, v0, v0
    v_mul_f32 v209, v1, v1
    v_mul_f32 v210, v2, v2
    v_mfma_f32_32x32x16_bf16 v[48:63], v[196:199], a[236:239], v[48:63]
    v_mul_f32 v211, v3, v3
    v_fma_f32 v208, v208, v246, v245
    v_fma_f32 v209, v209, v246, v245
    v_fma_f32 v210, v210, v246, v245
    v_fma_f32 v211, v211, v246, v245
    s_waitcnt lgkmcnt(2)
    v_mfma_f32_32x32x16_bf16 v[32:47], v[200:203], a[240:243], v[32:47]
    ds_read_b64_tr_b16 v[196:197], v237 offset:21152
    ds_read_b64_tr_b16 v[198:199], v237 offset:21408
    v_mul_f32 v208, v0, v208
    v_mul_f32 v209, v1, v209
    v_mul_f32 v210, v2, v210
    v_mul_f32 v211, v3, v211
    v_mfma_f32_32x32x16_bf16 v[48:63], v[200:203], a[244:247], v[48:63]
    v_exp_f32 v208, v208
    v_exp_f32 v209, v209
    v_exp_f32 v210, v210
    v_mfma_f32_32x32x16_bf16 v[32:47], v[204:207], a[248:251], v[32:47]
    ds_read_b64_tr_b16 v[200:201], v237 offset:25376
    ds_read_b64_tr_b16 v[202:203], v237 offset:25632
    v_exp_f32 v211, v211
    v_mul_f32 v8, v0, v8
    v_mul_f32 v9, v1, v9
    v_mfma_f32_32x32x16_bf16 v[48:63], v[204:207], a[252:255], v[48:63]
    v_mul_f32 v10, v2, v10
    v_mul_f32 v11, v3, v11
    v_add_f32 v208, 1.0, v208
    v_add_f32 v209, 1.0, v209
    v_add_f32 v210, 1.0, v210
    s_waitcnt lgkmcnt(2)
    v_mfma_f32_32x32x16_bf16 v[32:47], v[192:195], v[160:163], v[32:47]
    ds_read_b64_tr_b16 v[204:205], v237 offset:29600
    ds_read_b64_tr_b16 v[206:207], v237 offset:29856
    v_add_f32 v211, 1.0, v211
    v_rcp_f32 v208, v208
    v_mfma_f32_32x32x16_bf16 v[48:63], v[192:195], v[164:167], v[48:63]
    s_waitcnt vmcnt(3)
    s_mov_b64 exec, 1
    s_add_u32 s47, s76, 0
    buffer_store_dword v249, v250, s[56:59], s47 offen sc1
    s_mov_b64 exec, -1
    v_mfma_f32_32x32x16_bf16 v[32:47], v[196:199], v[168:171], v[32:47]
    ds_read_b64_tr_b16 v[192:193], v237 offset:49728
    ds_read_b64_tr_b16 v[194:195], v237 offset:49984
    v_rcp_f32 v209, v209
    v_rcp_f32 v210, v210
    v_mfma_f32_32x32x16_bf16 v[48:63], v[196:199], v[172:175], v[48:63]
    v_rcp_f32 v211, v211
    v_mul_f32 v8, v8, v208
    v_mul_f32 v9, v9, v209
    v_mul_f32 v10, v10, v210
    s_waitcnt lgkmcnt(2)
    v_mfma_f32_32x32x16_bf16 v[32:47], v[200:203], v[176:179], v[32:47]
    ds_read_b64_tr_b16 v[196:197], v237 offset:53952
    ds_read_b64_tr_b16 v[198:199], v237 offset:54208
    v_mul_f32 v11, v11, v211
    v_cvt_pk_bf16_f32 v224, v8, v9
    v_cvt_pk_bf16_f32 v225, v10, v11
    v_mul_f32 v212, v4, v4
    v_mfma_f32_32x32x16_bf16 v[48:63], v[200:203], v[180:183], v[48:63]
    v_mul_f32 v213, v5, v5
    v_mul_f32 v214, v6, v6
    v_mul_f32 v215, v7, v7
    v_fma_f32 v212, v212, v246, v245
    v_fma_f32 v213, v213, v246, v245
    v_fma_f32 v214, v214, v246, v245
    v_mfma_f32_32x32x16_bf16 v[32:47], v[204:207], v[184:187], v[32:47]
    ds_read_b64_tr_b16 v[200:201], v237 offset:58176
    ds_read_b64_tr_b16 v[202:203], v237 offset:58432
    v_fma_f32 v215, v215, v246, v245
    v_mul_f32 v212, v4, v212
    v_mul_f32 v213, v5, v213
    v_mul_f32 v214, v6, v214
    v_mfma_f32_32x32x16_bf16 v[48:63], v[204:207], v[188:191], v[48:63]
    v_mul_f32 v215, v7, v215
    v_exp_f32 v212, v212
    v_exp_f32 v213, v213
    s_waitcnt lgkmcnt(2)
    v_mfma_f32_32x32x16_bf16 v[64:79], v[192:195], a[0:3], 0
    ds_read_b64_tr_b16 v[204:205], v237 offset:62400
    ds_read_b64_tr_b16 v[206:207], v237 offset:62656
    v_exp_f32 v214, v214
    v_exp_f32 v215, v215
    v_mfma_f32_32x32x16_bf16 v[80:95], v[192:195], a[4:7], 0
    v_mul_f32 v12, v4, v12
    v_mul_f32 v13, v5, v13
    v_mul_f32 v14, v6, v14
    v_mul_f32 v15, v7, v15
    v_add_f32 v212, 1.0, v212
    v_add_f32 v213, 1.0, v213
    v_mfma_f32_32x32x16_bf16 v[64:79], v[196:199], a[8:11], v[64:79]
    ds_read_b64_tr_b16 v[192:193], v238 offset:1088
    ds_read_b64_tr_b16 v[194:195], v238 offset:1344
    v_add_f32 v214, 1.0, v214
    v_add_f32 v215, 1.0, v215
    v_rcp_f32 v212, v212
    v_mfma_f32_32x32x16_bf16 v[80:95], v[196:199], a[12:15], v[80:95]
    v_rcp_f32 v213, v213
    v_rcp_f32 v214, v214
    s_waitcnt lgkmcnt(2)
    v_mfma_f32_32x32x16_bf16 v[64:79], v[200:203], a[16:19], v[64:79]
    ds_read_b64_tr_b16 v[196:197], v238 offset:5312
    ds_read_b64_tr_b16 v[198:199], v238 offset:5568
    v_rcp_f32 v215, v215
    v_mul_f32 v12, v12, v212
    v_mul_f32 v13, v13, v213
    v_mfma_f32_32x32x16_bf16 v[80:95], v[200:203], a[20:23], v[80:95]
    v_mul_f32 v14, v14, v214
    v_mul_f32 v15, v15, v215
    v_cvt_pk_bf16_f32 v226, v12, v13
    v_cvt_pk_bf16_f32 v227, v14, v15
    s_add_u32 s44, s37, 2048
    buffer_store_dwordx4 v[224:227], v244, s[24:27], s44 offen sc1
    v_mfma_f32_32x32x16_bf16 v[64:79], v[204:207], a[24:27], v[64:79]
    ds_read_b64_tr_b16 v[200:201], v238 offset:9536
    ds_read_b64_tr_b16 v[202:203], v238 offset:9792
    v_mul_f32 v216, v16, v16
    v_mul_f32 v217, v17, v17
    v_mul_f32 v218, v18, v18
    v_mul_f32 v219, v19, v19
    v_mfma_f32_32x32x16_bf16 v[80:95], v[204:207], a[28:31], v[80:95]
    v_fma_f32 v216, v216, v246, v245
    v_fma_f32 v217, v217, v246, v245
    v_fma_f32 v218, v218, v246, v245
    v_fma_f32 v219, v219, v246, v245
    v_mul_f32 v216, v16, v216
    s_waitcnt lgkmcnt(2)
    v_mfma_f32_32x32x16_bf16 v[64:79], v[192:195], a[32:35], v[64:79]
    ds_read_b64_tr_b16 v[204:205], v238 offset:13760
    ds_read_b64_tr_b16 v[206:207], v238 offset:14016
    v_mul_f32 v217, v17, v217
    v_mul_f32 v218, v18, v218
    v_mul_f32 v219, v19, v219
    v_mfma_f32_32x32x16_bf16 v[80:95], v[192:195], a[36:39], v[80:95]
    v_exp_f32 v216, v216
    v_exp_f32 v217, v217
    v_exp_f32 v218, v218
    v_mfma_f32_32x32x16_bf16 v[64:79], v[196:199], a[40:43], v[64:79]
    ds_read_b64_tr_b16 v[192:193], v238 offset:17984
    ds_read_b64_tr_b16 v[194:195], v238 offset:18240
    v_exp_f32 v219, v219
    v_mul_f32 v24, v16, v24
    v_mul_f32 v25, v17, v25
    v_mfma_f32_32x32x16_bf16 v[80:95], v[196:199], a[44:47], v[80:95]
    v_mul_f32 v26, v18, v26
    v_mul_f32 v27, v19, v27
    v_add_f32 v216, 1.0, v216
    v_add_f32 v217, 1.0, v217
    v_add_f32 v218, 1.0, v218
    s_waitcnt lgkmcnt(2)
    v_mfma_f32_32x32x16_bf16 v[64:79], v[200:203], a[48:51], v[64:79]
    ds_read_b64_tr_b16 v[196:197], v238 offset:22208
    ds_read_b64_tr_b16 v[198:199], v238 offset:22464
    v_add_f32 v219, 1.0, v219
    v_rcp_f32 v216, v216
    v_mfma_f32_32x32x16_bf16 v[80:95], v[200:203], a[52:55], v[80:95]
    v_rcp_f32 v217, v217
    v_rcp_f32 v218, v218
    v_rcp_f32 v219, v219
    v_mfma_f32_32x32x16_bf16 v[64:79], v[204:207], a[56:59], v[64:79]
    ds_read_b64_tr_b16 v[200:201], v238 offset:26432
    ds_read_b64_tr_b16 v[202:203], v238 offset:26688
    v_mul_f32 v24, v24, v216
    v_mul_f32 v25, v25, v217
    v_mul_f32 v26, v26, v218
    v_mul_f32 v27, v27, v219
    v_mfma_f32_32x32x16_bf16 v[80:95], v[204:207], a[60:63], v[80:95]
    v_cvt_pk_bf16_f32 v228, v24, v25
    v_cvt_pk_bf16_f32 v229, v26, v27
    v_mul_f32 v220, v20, v20
    v_mul_f32 v221, v21, v21
    v_mul_f32 v222, v22, v22
    s_waitcnt lgkmcnt(2)
    v_mfma_f32_32x32x16_bf16 v[64:79], v[192:195], a[64:67], v[64:79]
    ds_read_b64_tr_b16 v[204:205], v239 offset:17984
    ds_read_b64_tr_b16 v[206:207], v239 offset:18240
    v_mul_f32 v223, v23, v23
    v_fma_f32 v220, v220, v246, v245
    v_fma_f32 v221, v221, v246, v245
    v_fma_f32 v222, v222, v246, v245
    v_mfma_f32_32x32x16_bf16 v[80:95], v[192:195], a[68:71], v[80:95]
    v_fma_f32 v223, v223, v246, v245
    v_mul_f32 v220, v20, v220
    v_mul_f32 v221, v21, v221
    v_mul_f32 v222, v22, v222
    v_mul_f32 v223, v23, v223
    v_mfma_f32_32x32x16_bf16 v[64:79], v[196:199], a[72:75], v[64:79]
    ds_read_b64_tr_b16 v[192:193], v239 offset:22208
    ds_read_b64_tr_b16 v[194:195], v239 offset:22464
    v_exp_f32 v220, v220
    v_exp_f32 v221, v221
    v_mfma_f32_32x32x16_bf16 v[80:95], v[196:199], a[76:79], v[80:95]
    v_exp_f32 v222, v222
    v_exp_f32 v223, v223
    v_mul_f32 v28, v20, v28
    s_waitcnt lgkmcnt(2)
    v_mfma_f32_32x32x16_bf16 v[64:79], v[200:203], a[80:83], v[64:79]
    ds_read_b64_tr_b16 v[196:197], v239 offset:26432
    ds_read_b64_tr_b16 v[198:199], v239 offset:26688
    v_mul_f32 v29, v21, v29
    v_mul_f32 v30, v22, v30
    v_mul_f32 v31, v23, v31
    v_add_f32 v220, 1.0, v220
    v_mfma_f32_32x32x16_bf16 v[80:95], v[200:203], a[84:87], v[80:95]
    v_add_f32 v221, 1.0, v221
    v_add_f32 v222, 1.0, v222
    v_add_f32 v223, 1.0, v223
    v_rcp_f32 v220, v220
    v_mfma_f32_32x32x16_bf16 v[64:79], v[204:207], a[88:91], v[64:79]
    ds_read_b64_tr_b16 v[200:201], v237 offset:36928
    ds_read_b64_tr_b16 v[202:203], v237 offset:37184
    v_rcp_f32 v221, v221
    v_rcp_f32 v222, v222
    v_mfma_f32_32x32x16_bf16 v[80:95], v[204:207], a[92:95], v[80:95]
    v_rcp_f32 v223, v223
    v_mul_f32 v28, v28, v220
    v_mul_f32 v29, v29, v221
    v_mul_f32 v30, v30, v222
    s_waitcnt lgkmcnt(2)
    v_mfma_f32_32x32x16_bf16 v[64:79], v[192:195], a[96:99], v[64:79]
    ds_read_b64_tr_b16 v[204:205], v237 offset:41152
    ds_read_b64_tr_b16 v[206:207], v237 offset:41408
    v_mul_f32 v31, v31, v223
    v_cvt_pk_bf16_f32 v230, v28, v29
    v_cvt_pk_bf16_f32 v231, v30, v31
    s_add_u32 s45, s37, 296960
    v_mfma_f32_32x32x16_bf16 v[80:95], v[192:195], a[100:103], v[80:95]
    buffer_store_dwordx4 v[228:231], v244, s[24:27], s45 offen sc1
    v_mul_f32 v208, v32, v32
    v_mul_f32 v209, v33, v33
    v_mul_f32 v210, v34, v34
    v_mul_f32 v211, v35, v35
    v_fma_f32 v208, v208, v246, v245
    v_mfma_f32_32x32x16_bf16 v[64:79], v[196:199], a[104:107], v[64:79]
    ds_read_b64_tr_b16 v[192:193], v237 offset:45376
    ds_read_b64_tr_b16 v[194:195], v237 offset:45632
    v_fma_f32 v209, v209, v246, v245
    v_fma_f32 v210, v210, v246, v245
    v_fma_f32 v211, v211, v246, v245
    v_mul_f32 v208, v32, v208
    v_mfma_f32_32x32x16_bf16 v[80:95], v[196:199], a[108:111], v[80:95]
    v_mul_f32 v209, v33, v209
    v_mul_f32 v210, v34, v210
    v_mul_f32 v211, v35, v211
    v_exp_f32 v208, v208
    s_waitcnt lgkmcnt(2)
    v_mfma_f32_32x32x16_bf16 v[64:79], v[200:203], a[112:115], v[64:79]
    ds_read_b64_tr_b16 v[196:197], v238 offset:33856
    ds_read_b64_tr_b16 v[198:199], v238 offset:34112
    v_exp_f32 v209, v209
    v_exp_f32 v210, v210
    v_mfma_f32_32x32x16_bf16 v[80:95], v[200:203], a[116:119], v[80:95]
    v_exp_f32 v211, v211
    v_mul_f32 v40, v32, v40
    v_mul_f32 v41, v33, v41
    v_mul_f32 v42, v34, v42
    v_mul_f32 v43, v35, v43
    v_mfma_f32_32x32x16_bf16 v[64:79], v[204:207], a[120:123], v[64:79]
    ds_read_b64_tr_b16 v[200:201], v238 offset:38080
    ds_read_b64_tr_b16 v[202:203], v238 offset:38336
    v_add_f32 v208, 1.0, v208
    v_add_f32 v209, 1.0, v209
    v_add_f32 v210, 1.0, v210
    v_add_f32 v211, 1.0, v211
    v_mfma_f32_32x32x16_bf16 v[80:95], v[204:207], a[124:127], v[80:95]
    v_rcp_f32 v208, v208
    v_rcp_f32 v209, v209
    s_waitcnt lgkmcnt(2)
    v_mfma_f32_32x32x16_bf16 v[64:79], v[192:195], a[128:131], v[64:79]
    ds_read_b64_tr_b16 v[204:205], v238 offset:42304
    ds_read_b64_tr_b16 v[206:207], v238 offset:42560
    v_rcp_f32 v210, v210
    v_rcp_f32 v211, v211
    v_mfma_f32_32x32x16_bf16 v[80:95], v[192:195], a[132:135], v[80:95]
    v_mul_f32 v40, v40, v208
    v_mul_f32 v41, v41, v209
    v_mul_f32 v42, v42, v210
    v_mul_f32 v43, v43, v211
    v_cvt_pk_bf16_f32 v224, v40, v41
    v_cvt_pk_bf16_f32 v225, v42, v43
    v_mfma_f32_32x32x16_bf16 v[64:79], v[196:199], a[136:139], v[64:79]
    ds_read_b64_tr_b16 v[192:193], v238 offset:46528
    ds_read_b64_tr_b16 v[194:195], v238 offset:46784
    v_mul_f32 v212, v36, v36
    v_mul_f32 v213, v37, v37
    v_mul_f32 v214, v38, v38
    v_mul_f32 v215, v39, v39
    v_mfma_f32_32x32x16_bf16 v[80:95], v[196:199], a[140:143], v[80:95]
    v_fma_f32 v212, v212, v246, v245
    v_fma_f32 v213, v213, v246, v245
    v_fma_f32 v214, v214, v246, v245
    v_fma_f32 v215, v215, v246, v245
    v_mul_f32 v212, v36, v212
    s_waitcnt lgkmcnt(2)
    v_mfma_f32_32x32x16_bf16 v[64:79], v[200:203], a[144:147], v[64:79]
    ds_read_b64_tr_b16 v[196:197], v238 offset:50752
    ds_read_b64_tr_b16 v[198:199], v238 offset:51008
    v_mul_f32 v213, v37, v213
    v_mul_f32 v214, v38, v214
    v_mul_f32 v215, v39, v215
    v_mfma_f32_32x32x16_bf16 v[80:95], v[200:203], a[148:151], v[80:95]
    v_exp_f32 v212, v212
    v_exp_f32 v213, v213
    v_exp_f32 v214, v214
    v_mfma_f32_32x32x16_bf16 v[64:79], v[204:207], a[152:155], v[64:79]
    ds_read_b64_tr_b16 v[200:201], v238 offset:54976
    ds_read_b64_tr_b16 v[202:203], v238 offset:55232
    v_exp_f32 v215, v215
    v_mul_f32 v44, v36, v44
    v_mul_f32 v45, v37, v45
    v_mfma_f32_32x32x16_bf16 v[80:95], v[204:207], a[156:159], v[80:95]
    v_mul_f32 v46, v38, v46
    v_mul_f32 v47, v39, v47
    v_add_f32 v212, 1.0, v212
    v_add_f32 v213, 1.0, v213
    v_add_f32 v214, 1.0, v214
    s_waitcnt lgkmcnt(2)
    v_mfma_f32_32x32x16_bf16 v[64:79], v[192:195], a[160:163], v[64:79]
    ds_read_b64_tr_b16 v[204:205], v238 offset:59200
    ds_read_b64_tr_b16 v[206:207], v238 offset:59456
    v_add_f32 v215, 1.0, v215
    v_rcp_f32 v212, v212
    v_mfma_f32_32x32x16_bf16 v[80:95], v[192:195], a[164:167], v[80:95]
    v_rcp_f32 v213, v213
    v_rcp_f32 v214, v214
    v_rcp_f32 v215, v215
    v_mfma_f32_32x32x16_bf16 v[64:79], v[196:199], a[168:171], v[64:79]
    ds_read_b64_tr_b16 v[192:193], v238 offset:63424
    ds_read_b64_tr_b16 v[194:195], v238 offset:63680
    v_mul_f32 v44, v44, v212
    v_mul_f32 v45, v45, v213
    v_mul_f32 v46, v46, v214
    v_mul_f32 v47, v47, v215
    v_mfma_f32_32x32x16_bf16 v[80:95], v[196:199], a[172:175], v[80:95]
    v_cvt_pk_bf16_f32 v226, v44, v45
    v_cvt_pk_bf16_f32 v227, v46, v47
    s_add_u32 s44, s37, 2560
    buffer_store_dwordx4 v[224:227], v244, s[24:27], s44 offen sc1
    v_mul_f32 v216, v48, v48
    s_waitcnt lgkmcnt(2)
    v_mfma_f32_32x32x16_bf16 v[64:79], v[200:203], a[176:179], v[64:79]
    ds_read_b64_tr_b16 v[196:197], v239 offset:2112
    ds_read_b64_tr_b16 v[198:199], v239 offset:2368
    v_mul_f32 v217, v49, v49
    v_mul_f32 v218, v50, v50
    v_mul_f32 v219, v51, v51
    v_fma_f32 v216, v216, v246, v245
    v_mfma_f32_32x32x16_bf16 v[80:95], v[200:203], a[180:183], v[80:95]
    v_fma_f32 v217, v217, v246, v245
    v_fma_f32 v218, v218, v246, v245
    v_fma_f32 v219, v219, v246, v245
    v_mul_f32 v216, v48, v216
    v_mul_f32 v217, v49, v217
    v_mul_f32 v218, v50, v218
    v_mfma_f32_32x32x16_bf16 v[64:79], v[204:207], a[184:187], v[64:79]
    ds_read_b64_tr_b16 v[200:201], v239 offset:6336
    ds_read_b64_tr_b16 v[202:203], v239 offset:6592
    v_mul_f32 v219, v51, v219
    v_exp_f32 v216, v216
    v_mfma_f32_32x32x16_bf16 v[80:95], v[204:207], a[188:191], v[80:95]
    v_exp_f32 v217, v217
    v_exp_f32 v218, v218
    s_waitcnt lgkmcnt(2)
    v_mfma_f32_32x32x16_bf16 v[64:79], v[192:195], a[192:195], v[64:79]
    ds_read_b64_tr_b16 v[204:205], v239 offset:10560
    ds_read_b64_tr_b16 v[206:207], v239 offset:10816
    v_exp_f32 v219, v219
    v_mul_f32 v56, v48, v56
    v_mul_f32 v57, v49, v57
    v_mfma_f32_32x32x16_bf16 v[80:95], v[192:195], a[196:199], v[80:95]
    v_mul_f32 v58, v50, v58
    v_mul_f32 v59, v51, v59
    v_add_f32 v216, 1.0, v216
    v_add_f32 v217, 1.0, v217
    v_add_f32 v218, 1.0, v218
    v_add_f32 v219, 1.0, v219
    v_mfma_f32_32x32x16_bf16 v[64:79], v[196:199], a[200:203], v[64:79]
    ds_read_b64_tr_b16 v[192:193], v237 offset:64
    ds_read_b64_tr_b16 v[194:195], v237 offset:320
    v_rcp_f32 v216, v216
    v_rcp_f32 v217, v217
    v_mfma_f32_32x32x16_bf16 v[80:95], v[196:199], a[204:207], v[80:95]
    v_rcp_f32 v218, v218
    v_rcp_f32 v219, v219
    v_mul_f32 v56, v56, v216
    s_waitcnt lgkmcnt(2)
    v_mfma_f32_32x32x16_bf16 v[64:79], v[200:203], a[208:211], v[64:79]
    ds_read_b64_tr_b16 v[196:197], v237 offset:4288
    ds_read_b64_tr_b16 v[198:199], v237 offset:4544
    v_mul_f32 v57, v57, v217
    v_mul_f32 v58, v58, v218
    v_mul_f32 v59, v59, v219
    v_cvt_pk_bf16_f32 v228, v56, v57
    v_mfma_f32_32x32x16_bf16 v[80:95], v[200:203], a[212:215], v[80:95]
    v_cvt_pk_bf16_f32 v229, v58, v59
    v_mul_f32 v220, v52, v52
    v_mul_f32 v221, v53, v53
    v_mul_f32 v222, v54, v54
    v_mul_f32 v223, v55, v55
    v_fma_f32 v220, v220, v246, v245
    v_mfma_f32_32x32x16_bf16 v[64:79], v[204:207], a[216:219], v[64:79]
    ds_read_b64_tr_b16 v[200:201], v237 offset:8512
    ds_read_b64_tr_b16 v[202:203], v237 offset:8768
    v_fma_f32 v221, v221, v246, v245
    v_fma_f32 v222, v222, v246, v245
    v_fma_f32 v223, v223, v246, v245
    v_mul_f32 v220, v52, v220
    v_mfma_f32_32x32x16_bf16 v[80:95], v[204:207], a[220:223], v[80:95]
    v_mul_f32 v221, v53, v221
    v_mul_f32 v222, v54, v222
    v_mul_f32 v223, v55, v223
    v_exp_f32 v220, v220
    s_waitcnt lgkmcnt(2)
    v_mfma_f32_32x32x16_bf16 v[64:79], v[192:195], a[224:227], v[64:79]
    ds_read_b64_tr_b16 v[204:205], v237 offset:12736
    ds_read_b64_tr_b16 v[206:207], v237 offset:12992
    v_exp_f32 v221, v221
    v_exp_f32 v222, v222
    v_mfma_f32_32x32x16_bf16 v[80:95], v[192:195], a[228:231], v[80:95]
    v_exp_f32 v223, v223
    v_mul_f32 v60, v52, v60
    v_mul_f32 v61, v53, v61
    v_mul_f32 v62, v54, v62
    v_mul_f32 v63, v55, v63
    v_mfma_f32_32x32x16_bf16 v[64:79], v[196:199], a[232:235], v[64:79]
    ds_read_b64_tr_b16 v[192:193], v237 offset:16960
    ds_read_b64_tr_b16 v[194:195], v237 offset:17216
    v_add_f32 v220, 1.0, v220
    v_add_f32 v221, 1.0, v221
    v_add_f32 v222, 1.0, v222
    v_add_f32 v223, 1.0, v223
    v_mfma_f32_32x32x16_bf16 v[80:95], v[196:199], a[236:239], v[80:95]
    v_rcp_f32 v220, v220
    v_rcp_f32 v221, v221
    s_waitcnt lgkmcnt(2)
    v_mfma_f32_32x32x16_bf16 v[64:79], v[200:203], a[240:243], v[64:79]
    ds_read_b64_tr_b16 v[196:197], v237 offset:21184
    ds_read_b64_tr_b16 v[198:199], v237 offset:21440
    v_rcp_f32 v222, v222
    v_rcp_f32 v223, v223
    v_mfma_f32_32x32x16_bf16 v[80:95], v[200:203], a[244:247], v[80:95]
    v_mul_f32 v60, v60, v220
    v_mul_f32 v61, v61, v221
    v_mul_f32 v62, v62, v222
    v_mul_f32 v63, v63, v223
    v_cvt_pk_bf16_f32 v230, v60, v61
    v_cvt_pk_bf16_f32 v231, v62, v63
    v_mfma_f32_32x32x16_bf16 v[64:79], v[204:207], a[248:251], v[64:79]
    ds_read_b64_tr_b16 v[200:201], v237 offset:25408
    ds_read_b64_tr_b16 v[202:203], v237 offset:25664
    s_add_u32 s45, s37, 297472
    buffer_store_dwordx4 v[228:231], v244, s[24:27], s45 offen sc1
    v_mfma_f32_32x32x16_bf16 v[80:95], v[204:207], a[252:255], v[80:95]
    s_waitcnt lgkmcnt(2)
    v_mfma_f32_32x32x16_bf16 v[64:79], v[192:195], v[160:163], v[64:79]
    ds_read_b64_tr_b16 v[204:205], v237 offset:29632
    ds_read_b64_tr_b16 v[206:207], v237 offset:29888
    v_mfma_f32_32x32x16_bf16 v[80:95], v[192:195], v[164:167], v[80:95]
    v_mfma_f32_32x32x16_bf16 v[64:79], v[196:199], v[168:171], v[64:79]
    ds_read_b64_tr_b16 v[192:193], v237 offset:49760
    ds_read_b64_tr_b16 v[194:195], v237 offset:50016
    v_mfma_f32_32x32x16_bf16 v[80:95], v[196:199], v[172:175], v[80:95]
    s_waitcnt lgkmcnt(2)
    v_mfma_f32_32x32x16_bf16 v[64:79], v[200:203], v[176:179], v[64:79]
    ds_read_b64_tr_b16 v[196:197], v237 offset:53984
    ds_read_b64_tr_b16 v[198:199], v237 offset:54240
    v_mfma_f32_32x32x16_bf16 v[80:95], v[200:203], v[180:183], v[80:95]
    v_mfma_f32_32x32x16_bf16 v[64:79], v[204:207], v[184:187], v[64:79]
    ds_read_b64_tr_b16 v[200:201], v237 offset:58208
    ds_read_b64_tr_b16 v[202:203], v237 offset:58464
    v_mfma_f32_32x32x16_bf16 v[80:95], v[204:207], v[188:191], v[80:95]
    s_waitcnt lgkmcnt(2)
    v_mfma_f32_32x32x16_bf16 v[96:111], v[192:195], a[0:3], 0
    ds_read_b64_tr_b16 v[204:205], v237 offset:62432
    ds_read_b64_tr_b16 v[206:207], v237 offset:62688
    v_mfma_f32_32x32x16_bf16 v[112:127], v[192:195], a[4:7], 0
    s_nop 3
    v_mul_f32 v208, v64, v64
    v_mul_f32 v209, v65, v65
    v_mul_f32 v210, v66, v66
    v_mul_f32 v211, v67, v67
    v_fma_f32 v208, v208, v246, v245
    v_fma_f32 v209, v209, v246, v245
    v_mfma_f32_32x32x16_bf16 v[96:111], v[196:199], a[8:11], v[96:111]
    ds_read_b64_tr_b16 v[192:193], v238 offset:1120
    ds_read_b64_tr_b16 v[194:195], v238 offset:1376
    v_fma_f32 v210, v210, v246, v245
    v_fma_f32 v211, v211, v246, v245
    v_mul_f32 v208, v64, v208
    v_mul_f32 v209, v65, v209
    v_mfma_f32_32x32x16_bf16 v[112:127], v[196:199], a[12:15], v[112:127]
    v_mul_f32 v210, v66, v210
    v_mul_f32 v211, v67, v211
    v_exp_f32 v208, v208
    s_waitcnt lgkmcnt(2)
    v_mfma_f32_32x32x16_bf16 v[96:111], v[200:203], a[16:19], v[96:111]
    ds_read_b64_tr_b16 v[196:197], v238 offset:5344
    ds_read_b64_tr_b16 v[198:199], v238 offset:5600
    v_exp_f32 v209, v209
    v_exp_f32 v210, v210
    v_mfma_f32_32x32x16_bf16 v[112:127], v[200:203], a[20:23], v[112:127]
    v_exp_f32 v211, v211
    v_mul_f32 v72, v64, v72
    v_mul_f32 v73, v65, v73
    v_mul_f32 v74, v66, v74
    v_mul_f32 v75, v67, v75
    v_mfma_f32_32x32x16_bf16 v[96:111], v[204:207], a[24:27], v[96:111]
    ds_read_b64_tr_b16 v[200:201], v238 offset:9568
    ds_read_b64_tr_b16 v[202:203], v238 offset:9824
    v_add_f32 v208, 1.0, v208
    v_add_f32 v209, 1.0, v209
    v_add_f32 v210, 1.0, v210
    v_add_f32 v211, 1.0, v211
    v_mfma_f32_32x32x16_bf16 v[112:127], v[204:207], a[28:31], v[112:127]
    v_rcp_f32 v208, v208
    v_rcp_f32 v209, v209
    s_waitcnt lgkmcnt(2)
    v_mfma_f32_32x32x16_bf16 v[96:111], v[192:195], a[32:35], v[96:111]
    ds_read_b64_tr_b16 v[204:205], v238 offset:13792
    ds_read_b64_tr_b16 v[206:207], v238 offset:14048
    v_rcp_f32 v210, v210
    v_rcp_f32 v211, v211
    v_mfma_f32_32x32x16_bf16 v[112:127], v[192:195], a[36:39], v[112:127]
    v_mul_f32 v72, v72, v208
    v_mul_f32 v73, v73, v209
    v_mul_f32 v74, v74, v210
    v_mul_f32 v75, v75, v211
    v_cvt_pk_bf16_f32 v224, v72, v73
    v_cvt_pk_bf16_f32 v225, v74, v75
    v_mfma_f32_32x32x16_bf16 v[96:111], v[196:199], a[40:43], v[96:111]
    ds_read_b64_tr_b16 v[192:193], v238 offset:18016
    ds_read_b64_tr_b16 v[194:195], v238 offset:18272
    v_mul_f32 v212, v68, v68
    v_mul_f32 v213, v69, v69
    v_mul_f32 v214, v70, v70
    v_mul_f32 v215, v71, v71
    v_mfma_f32_32x32x16_bf16 v[112:127], v[196:199], a[44:47], v[112:127]
    v_fma_f32 v212, v212, v246, v245
    v_fma_f32 v213, v213, v246, v245
    v_fma_f32 v214, v214, v246, v245
    v_fma_f32 v215, v215, v246, v245
    v_mul_f32 v212, v68, v212
    s_waitcnt lgkmcnt(2)
    v_mfma_f32_32x32x16_bf16 v[96:111], v[200:203], a[48:51], v[96:111]
    ds_read_b64_tr_b16 v[196:197], v238 offset:22240
    ds_read_b64_tr_b16 v[198:199], v238 offset:22496
    v_mul_f32 v213, v69, v213
    v_mul_f32 v214, v70, v214
    v_mul_f32 v215, v71, v215
    v_mfma_f32_32x32x16_bf16 v[112:127], v[200:203], a[52:55], v[112:127]
    v_exp_f32 v212, v212
    v_exp_f32 v213, v213
    v_exp_f32 v214, v214
    v_mfma_f32_32x32x16_bf16 v[96:111], v[204:207], a[56:59], v[96:111]
    ds_read_b64_tr_b16 v[200:201], v238 offset:26464
    ds_read_b64_tr_b16 v[202:203], v238 offset:26720
    v_exp_f32 v215, v215
    v_mul_f32 v76, v68, v76
    v_mul_f32 v77, v69, v77
    v_mfma_f32_32x32x16_bf16 v[112:127], v[204:207], a[60:63], v[112:127]
    v_mul_f32 v78, v70, v78
    v_mul_f32 v79, v71, v79
    v_add_f32 v212, 1.0, v212
    v_add_f32 v213, 1.0, v213
    v_add_f32 v214, 1.0, v214
    s_waitcnt lgkmcnt(2)
    v_mfma_f32_32x32x16_bf16 v[96:111], v[192:195], a[64:67], v[96:111]
    ds_read_b64_tr_b16 v[204:205], v239 offset:18016
    ds_read_b64_tr_b16 v[206:207], v239 offset:18272
    v_add_f32 v215, 1.0, v215
    v_rcp_f32 v212, v212
    v_mfma_f32_32x32x16_bf16 v[112:127], v[192:195], a[68:71], v[112:127]
    v_rcp_f32 v213, v213
    v_rcp_f32 v214, v214
    v_rcp_f32 v215, v215
    v_mfma_f32_32x32x16_bf16 v[96:111], v[196:199], a[72:75], v[96:111]
    ds_read_b64_tr_b16 v[192:193], v239 offset:22240
    ds_read_b64_tr_b16 v[194:195], v239 offset:22496
    v_mul_f32 v76, v76, v212
    v_mul_f32 v77, v77, v213
    v_mul_f32 v78, v78, v214
    v_mul_f32 v79, v79, v215
    v_mfma_f32_32x32x16_bf16 v[112:127], v[196:199], a[76:79], v[112:127]
    v_cvt_pk_bf16_f32 v226, v76, v77
    v_cvt_pk_bf16_f32 v227, v78, v79
    s_add_u32 s44, s37, 3072
    buffer_store_dwordx4 v[224:227], v244, s[24:27], s44 offen sc1
    v_mul_f32 v216, v80, v80
    s_waitcnt lgkmcnt(2)
    v_mfma_f32_32x32x16_bf16 v[96:111], v[200:203], a[80:83], v[96:111]
    ds_read_b64_tr_b16 v[196:197], v239 offset:26464
    ds_read_b64_tr_b16 v[198:199], v239 offset:26720
    s_add_u32 s46, s77, 0
    buffer_load_dword v236, v250, s[56:59], s46 offen sc1
    v_mul_f32 v217, v81, v81
    v_mul_f32 v218, v82, v82
    v_mfma_f32_32x32x16_bf16 v[112:127], v[200:203], a[84:87], v[112:127]
    v_mul_f32 v219, v83, v83
    v_fma_f32 v216, v216, v246, v245
    v_fma_f32 v217, v217, v246, v245
    v_fma_f32 v218, v218, v246, v245
    v_fma_f32 v219, v219, v246, v245
    v_mul_f32 v216, v80, v216
    v_mfma_f32_32x32x16_bf16 v[96:111], v[204:207], a[88:91], v[96:111]
    ds_read_b64_tr_b16 v[200:201], v237 offset:36960
    ds_read_b64_tr_b16 v[202:203], v237 offset:37216
    v_mul_f32 v217, v81, v217
    v_mul_f32 v218, v82, v218
    v_mul_f32 v219, v83, v219
    v_mfma_f32_32x32x16_bf16 v[112:127], v[204:207], a[92:95], v[112:127]
    v_exp_f32 v216, v216
    v_exp_f32 v217, v217
    s_waitcnt lgkmcnt(2)
    v_mfma_f32_32x32x16_bf16 v[96:111], v[192:195], a[96:99], v[96:111]
    ds_read_b64_tr_b16 v[204:205], v237 offset:41184
    ds_read_b64_tr_b16 v[206:207], v237 offset:41440
    s_barrier
    v_exp_f32 v218, v218
    v_mfma_f32_32x32x16_bf16 v[112:127], v[192:195], a[100:103], v[112:127]
    s_add_u32 s75, s6, 49664
    s_add_u32 m0, s75, 0
    s_add_u32 s40, s48, 0
    buffer_load_dwordx4 v247, s[52:55], s40 offen lds
    v_exp_f32 v219, v219
    v_mfma_f32_32x32x16_bf16 v[96:111], v[196:199], a[104:107], v[96:111]
    ds_read_b64_tr_b16 v[192:193], v237 offset:45408
    ds_read_b64_tr_b16 v[194:195], v237 offset:45664
    v_mul_f32 v88, v80, v88
    v_mul_f32 v89, v81, v89
    v_mul_f32 v90, v82, v90
    v_mul_f32 v91, v83, v91
    v_mfma_f32_32x32x16_bf16 v[112:127], v[196:199], a[108:111], v[112:127]
    v_add_f32 v216, 1.0, v216
    v_add_f32 v217, 1.0, v217
    v_add_f32 v218, 1.0, v218
    v_add_f32 v219, 1.0, v219
    s_waitcnt lgkmcnt(2)
    v_mfma_f32_32x32x16_bf16 v[96:111], v[200:203], a[112:115], v[96:111]
    ds_read_b64_tr_b16 v[196:197], v238 offset:33888
    ds_read_b64_tr_b16 v[198:199], v238 offset:34144
    s_add_u32 m0, s75, 1056
    s_add_u32 s41, s48, 1152
    buffer_load_dwordx4 v247, s[52:55], s41 offen lds
    v_mfma_f32_32x32x16_bf16 v[112:127], v[200:203], a[116:119], v[112:127]
    v_rcp_f32 v216, v216
    v_rcp_f32 v217, v217
    v_rcp_f32 v218, v218
    v_mfma_f32_32x32x16_bf16 v[96:111], v[204:207], a[120:123], v[96:111]
    ds_read_b64_tr_b16 v[200:201], v238 offset:38112
    ds_read_b64_tr_b16 v[202:203], v238 offset:38368
    v_rcp_f32 v219, v219
    v_mul_f32 v88, v88, v216
    v_mul_f32 v89, v89, v217
    v_mfma_f32_32x32x16_bf16 v[112:127], v[204:207], a[124:127], v[112:127]
    s_add_u32 m0, s75, 2112
    s_add_u32 s40, s48, 2304
    buffer_load_dwordx4 v247, s[52:55], s40 offen lds
    v_mul_f32 v90, v90, v218
    v_mul_f32 v91, v91, v219
    s_waitcnt lgkmcnt(2)
    v_mfma_f32_32x32x16_bf16 v[96:111], v[192:195], a[128:131], v[96:111]
    ds_read_b64_tr_b16 v[204:205], v238 offset:42336
    ds_read_b64_tr_b16 v[206:207], v238 offset:42592
    v_cvt_pk_bf16_f32 v228, v88, v89
    v_cvt_pk_bf16_f32 v229, v90, v91
    v_mul_f32 v220, v84, v84
    v_mul_f32 v221, v85, v85
    v_mfma_f32_32x32x16_bf16 v[112:127], v[192:195], a[132:135], v[112:127]
    s_waitcnt vmcnt(5)
    s_mov_b64 exec, 1
    s_add_u32 s47, s76, 32
    buffer_store_dword v249, v250, s[56:59], s47 offen sc1
    s_mov_b64 exec, -1
    s_waitcnt vmcnt(4)
    v_cmp_ne_u32 vcc, v236, v249
    s_cbranch_vccz L_ok3
s_branch L_spin3
L_ok3:
    v_mfma_f32_32x32x16_bf16 v[96:111], v[196:199], a[136:139], v[96:111]
    ds_read_b64_tr_b16 v[192:193], v238 offset:46560
    ds_read_b64_tr_b16 v[194:195], v238 offset:46816
    s_add_u32 m0, s75, 3168
    s_add_u32 s41, s48, 3456
    buffer_load_dwordx4 v247, s[52:55], s41 offen lds
    v_mul_f32 v222, v86, v86
    v_mfma_f32_32x32x16_bf16 v[112:127], v[196:199], a[140:143], v[112:127]
    s_add_u32 s42, s7, 0
    buffer_load_dwordx4 a[0:3], v255, s[24:27], s42 offen sc1
    v_mul_f32 v223, v87, v87
    v_fma_f32 v220, v220, v246, v245
    v_fma_f32 v221, v221, v246, v245
    s_waitcnt lgkmcnt(2)
    v_mfma_f32_32x32x16_bf16 v[96:111], v[200:203], a[144:147], v[96:111]
    ds_read_b64_tr_b16 v[196:197], v238 offset:50784
    ds_read_b64_tr_b16 v[198:199], v238 offset:51040
    v_fma_f32 v222, v222, v246, v245
    v_fma_f32 v223, v223, v246, v245
    v_mul_f32 v220, v84, v220
    v_mul_f32 v221, v85, v221
    v_mfma_f32_32x32x16_bf16 v[112:127], v[200:203], a[148:151], v[112:127]
    s_add_u32 m0, s75, 4224
    s_add_u32 s40, s48, 4608
    buffer_load_dwordx4 v247, s[52:55], s40 offen lds
    s_add_u32 s43, s7, 147456
    buffer_load_dwordx4 a[4:7], v255, s[24:27], s43 offen sc1
    v_mul_f32 v222, v86, v222
    v_mfma_f32_32x32x16_bf16 v[96:111], v[204:207], a[152:155], v[96:111]
    ds_read_b64_tr_b16 v[200:201], v238 offset:55008
    ds_read_b64_tr_b16 v[202:203], v238 offset:55264
    v_mul_f32 v223, v87, v223
    v_exp_f32 v220, v220
    v_mfma_f32_32x32x16_bf16 v[112:127], v[204:207], a[156:159], v[112:127]
    s_add_u32 s42, s7, 4096
    buffer_load_dwordx4 a[8:11], v255, s[24:27], s42 offen sc1
    v_exp_f32 v221, v221
    s_waitcnt lgkmcnt(2)
    v_mfma_f32_32x32x16_bf16 v[96:111], v[192:195], a[160:163], v[96:111]
    ds_read_b64_tr_b16 v[204:205], v238 offset:59232
    ds_read_b64_tr_b16 v[206:207], v238 offset:59488
    s_add_u32 m0, s75, 5280
    s_add_u32 s41, s48, 5760
    buffer_load_dwordx4 v247, s[52:55], s41 offen lds
    v_mfma_f32_32x32x16_bf16 v[112:127], v[192:195], a[164:167], v[112:127]
    s_add_u32 s43, s7, 151552
    buffer_load_dwordx4 a[12:15], v255, s[24:27], s43 offen sc1
    v_exp_f32 v222, v222
    v_exp_f32 v223, v223
    v_mfma_f32_32x32x16_bf16 v[96:111], v[196:199], a[168:171], v[96:111]
    ds_read_b64_tr_b16 v[192:193], v238 offset:63456
    ds_read_b64_tr_b16 v[194:195], v238 offset:63712
    v_mul_f32 v92, v84, v92
    v_mul_f32 v93, v85, v93
    v_mul_f32 v94, v86, v94
    v_mul_f32 v95, v87, v95
    v_mfma_f32_32x32x16_bf16 v[112:127], v[196:199], a[172:175], v[112:127]
    s_add_u32 m0, s75, 6336
    s_add_u32 s40, s48, 6912
    buffer_load_dwordx4 v247, s[52:55], s40 offen lds
    s_add_u32 s42, s7, 8192
    buffer_load_dwordx4 a[16:19], v255, s[24:27], s42 offen sc1
    s_waitcnt lgkmcnt(2)
    v_mfma_f32_32x32x16_bf16 v[96:111], v[200:203], a[176:179], v[96:111]
    ds_read_b64_tr_b16 v[196:197], v239 offset:2144
    ds_read_b64_tr_b16 v[198:199], v239 offset:2400
    v_add_f32 v220, 1.0, v220
    v_add_f32 v221, 1.0, v221
    v_add_f32 v222, 1.0, v222
    v_add_f32 v223, 1.0, v223
    v_mfma_f32_32x32x16_bf16 v[112:127], v[200:203], a[180:183], v[112:127]
    s_add_u32 s43, s7, 155648
    buffer_load_dwordx4 a[20:23], v255, s[24:27], s43 offen sc1
    v_rcp_f32 v220, v220
    v_rcp_f32 v221, v221
    v_mfma_f32_32x32x16_bf16 v[96:111], v[204:207], a[184:187], v[96:111]
    ds_read_b64_tr_b16 v[200:201], v239 offset:6368
    ds_read_b64_tr_b16 v[202:203], v239 offset:6624
    s_add_u32 m0, s75, 7392
    s_add_u32 s41, s48, 8064
    buffer_load_dwordx4 v247, s[52:55], s41 offen lds
    v_mfma_f32_32x32x16_bf16 v[112:127], v[204:207], a[188:191], v[112:127]
    s_add_u32 s42, s7, 12288
    buffer_load_dwordx4 a[24:27], v255, s[24:27], s42 offen sc1
    v_rcp_f32 v222, v222
    s_waitcnt lgkmcnt(2)
    v_mfma_f32_32x32x16_bf16 v[96:111], v[192:195], a[192:195], v[96:111]
    ds_read_b64_tr_b16 v[204:205], v239 offset:10592
    ds_read_b64_tr_b16 v[206:207], v239 offset:10848
    v_rcp_f32 v223, v223
    v_mul_f32 v92, v92, v220
    v_mul_f32 v93, v93, v221
    v_mfma_f32_32x32x16_bf16 v[112:127], v[192:195], a[196:199], v[112:127]
    s_add_u32 m0, s75, 8448
    s_add_u32 s40, s50, 0
    buffer_load_dwordx4 v255, s[56:59], s40 offen sc1 lds
    s_add_u32 s43, s7, 159744
    buffer_load_dwordx4 a[28:31], v255, s[24:27], s43 offen sc1
    v_mul_f32 v94, v94, v222
    v_mfma_f32_32x32x16_bf16 v[96:111], v[196:199], a[200:203], v[96:111]
    ds_read_b64_tr_b16 v[192:193], v237 offset:96
    ds_read_b64_tr_b16 v[194:195], v237 offset:352
    v_mul_f32 v95, v95, v223
    v_cvt_pk_bf16_f32 v230, v92, v93
    v_cvt_pk_bf16_f32 v231, v94, v95
    s_add_u32 s45, s37, 297984
    v_mfma_f32_32x32x16_bf16 v[112:127], v[196:199], a[204:207], v[112:127]
    s_add_u32 s42, s7, 1024
    buffer_load_dwordx4 a[32:35], v255, s[24:27], s42 offen sc1
    buffer_store_dwordx4 v[228:231], v244, s[24:27], s45 offen sc1
    s_waitcnt lgkmcnt(2)
    v_mfma_f32_32x32x16_bf16 v[96:111], v[200:203], a[208:211], v[96:111]
    ds_read_b64_tr_b16 v[196:197], v237 offset:4320
    ds_read_b64_tr_b16 v[198:199], v237 offset:4576
    v_mfma_f32_32x32x16_bf16 v[112:127], v[200:203], a[212:215], v[112:127]
    s_add_u32 s43, s7, 148480
    buffer_load_dwordx4 a[36:39], v255, s[24:27], s43 offen sc1
    v_mfma_f32_32x32x16_bf16 v[96:111], v[204:207], a[216:219], v[96:111]
    ds_read_b64_tr_b16 v[200:201], v237 offset:8544
    ds_read_b64_tr_b16 v[202:203], v237 offset:8800
    v_mfma_f32_32x32x16_bf16 v[112:127], v[204:207], a[220:223], v[112:127]
    s_add_u32 s42, s7, 5120
    buffer_load_dwordx4 a[40:43], v255, s[24:27], s42 offen sc1
    s_waitcnt lgkmcnt(2)
    v_mfma_f32_32x32x16_bf16 v[96:111], v[192:195], a[224:227], v[96:111]
    ds_read_b64_tr_b16 v[204:205], v237 offset:12768
    ds_read_b64_tr_b16 v[206:207], v237 offset:13024
    v_mfma_f32_32x32x16_bf16 v[112:127], v[192:195], a[228:231], v[112:127]
    s_add_u32 s43, s7, 152576
    buffer_load_dwordx4 a[44:47], v255, s[24:27], s43 offen sc1
    v_mfma_f32_32x32x16_bf16 v[96:111], v[196:199], a[232:235], v[96:111]
    ds_read_b64_tr_b16 v[192:193], v237 offset:16992
    ds_read_b64_tr_b16 v[194:195], v237 offset:17248
    s_barrier
    v_mfma_f32_32x32x16_bf16 v[112:127], v[196:199], a[236:239], v[112:127]
    s_add_u32 s42, s7, 9216
    buffer_load_dwordx4 a[48:51], v255, s[24:27], s42 offen sc1
    s_waitcnt lgkmcnt(2)
    v_mfma_f32_32x32x16_bf16 v[96:111], v[200:203], a[240:243], v[96:111]
    ds_read_b64_tr_b16 v[196:197], v237 offset:21216
    ds_read_b64_tr_b16 v[198:199], v237 offset:21472
    s_add_u32 s75, s6, 87552
    s_add_u32 m0, s75, 0
    s_add_u32 s40, s48, 36864
    buffer_load_dwordx4 v247, s[52:55], s40 offen lds
    v_mfma_f32_32x32x16_bf16 v[112:127], v[200:203], a[244:247], v[112:127]
    s_add_u32 s43, s7, 156672
    buffer_load_dwordx4 a[52:55], v255, s[24:27], s43 offen sc1
    s_add_u32 m0, s75, 1056
    s_add_u32 s41, s48, 38016
    buffer_load_dwordx4 v247, s[52:55], s41 offen lds
    v_mfma_f32_32x32x16_bf16 v[96:111], v[204:207], a[248:251], v[96:111]
    ds_read_b64_tr_b16 v[200:201], v237 offset:25440
    ds_read_b64_tr_b16 v[202:203], v237 offset:25696
    s_add_u32 m0, s75, 2112
    s_add_u32 s40, s48, 39168
    buffer_load_dwordx4 v247, s[52:55], s40 offen lds
    v_mfma_f32_32x32x16_bf16 v[112:127], v[204:207], a[252:255], v[112:127]
    s_add_u32 s42, s7, 13312
    buffer_load_dwordx4 a[56:59], v255, s[24:27], s42 offen sc1
    s_add_u32 m0, s75, 3168
    s_add_u32 s41, s48, 40320
    buffer_load_dwordx4 v247, s[52:55], s41 offen lds
    s_waitcnt lgkmcnt(2)
    v_mfma_f32_32x32x16_bf16 v[96:111], v[192:195], v[160:163], v[96:111]
    ds_read_b64_tr_b16 v[204:205], v237 offset:29664
    ds_read_b64_tr_b16 v[206:207], v237 offset:29920
    s_add_u32 m0, s75, 4224
    s_add_u32 s40, s48, 41472
    buffer_load_dwordx4 v247, s[52:55], s40 offen lds
    v_mfma_f32_32x32x16_bf16 v[112:127], v[192:195], v[164:167], v[112:127]
    s_add_u32 s43, s7, 160768
    buffer_load_dwordx4 a[60:63], v255, s[24:27], s43 offen sc1
    s_add_u32 m0, s75, 5280
    s_add_u32 s41, s48, 42624
    buffer_load_dwordx4 v247, s[52:55], s41 offen lds
    v_mfma_f32_32x32x16_bf16 v[96:111], v[196:199], v[168:171], v[96:111]
    s_add_u32 m0, s75, 6336
    s_add_u32 s40, s48, 43776
    buffer_load_dwordx4 v247, s[52:55], s40 offen lds
    v_mfma_f32_32x32x16_bf16 v[112:127], v[196:199], v[172:175], v[112:127]
    s_add_u32 m0, s75, 7392
    s_add_u32 s41, s48, 44928
    buffer_load_dwordx4 v247, s[52:55], s41 offen lds
    s_waitcnt lgkmcnt(0)
    v_mfma_f32_32x32x16_bf16 v[96:111], v[200:203], v[176:179], v[96:111]
    s_waitcnt vmcnt(18)
    s_barrier
    s_add_u32 m0, s75, 8448
    s_add_u32 s40, s50, 1024
    buffer_load_dwordx4 v255, s[56:59], s40 offen sc1 lds
    v_mfma_f32_32x32x16_bf16 v[112:127], v[200:203], v[180:183], v[112:127]
    ds_read_b64_tr_b16 a[128:129], v252 offset:49664
    ds_read_b64_tr_b16 a[130:131], v252 offset:49920
    ds_read_b64_tr_b16 a[132:133], v252 offset:49696
    ds_read_b64_tr_b16 a[134:135], v252 offset:49952
    v_mfma_f32_32x32x16_bf16 v[96:111], v[204:207], v[184:187], v[96:111]
    ds_read_b64_tr_b16 a[136:137], v252 offset:49728
    ds_read_b64_tr_b16 a[138:139], v252 offset:49984
    ds_read_b64_tr_b16 a[140:141], v252 offset:49760
    ds_read_b64_tr_b16 a[142:143], v252 offset:50016
    v_mfma_f32_32x32x16_bf16 v[112:127], v[204:207], v[188:191], v[112:127]
    ds_read_b64_tr_b16 a[144:145], v252 offset:49792
    ds_read_b64_tr_b16 a[146:147], v252 offset:50048
    ds_read_b64_tr_b16 a[148:149], v252 offset:49824
    ds_read_b64_tr_b16 a[150:151], v252 offset:50080
    s_waitcnt lgkmcnt(10)
    v_mfma_f32_16x16x32_bf16 v[128:131], a[128:131], a[0:3], 0
    ds_read_b64_tr_b16 a[152:153], v252 offset:49856
    s_add_u32 s75, s6, 125440
    v_mfma_f32_16x16x32_bf16 v[132:135], a[128:131], a[4:7], 0
    ds_read_b64_tr_b16 a[154:155], v252 offset:50112
    s_add_u32 m0, s75, 0
    v_mul_f32 v208, v96, v96
    s_waitcnt lgkmcnt(10)
    v_mfma_f32_16x16x32_bf16 v[136:139], a[132:135], a[0:3], 0
    ds_read_b64_tr_b16 a[156:157], v252 offset:49888
    s_add_u32 s40, s48, 589824
    v_mul_f32 v209, v97, v97
    v_mfma_f32_16x16x32_bf16 v[140:143], a[132:135], a[4:7], 0
    ds_read_b64_tr_b16 a[158:159], v252 offset:50144
    buffer_load_dwordx4 v247, s[52:55], s40 offen lds
    v_mul_f32 v210, v98, v98
    s_waitcnt lgkmcnt(10)
    v_mfma_f32_16x16x32_bf16 v[144:147], a[136:139], a[0:3], 0
    ds_read_b64_tr_b16 a[160:161], v253 offset:49664
    s_add_u32 m0, s75, 1056
    v_mul_f32 v211, v99, v99
    v_mfma_f32_16x16x32_bf16 v[148:151], a[136:139], a[4:7], 0
    ds_read_b64_tr_b16 a[162:163], v253 offset:49920
    v_fma_f32 v208, v208, v246, v245
    s_waitcnt lgkmcnt(6)
    v_mfma_f32_16x16x32_bf16 v[152:155], a[140:143], a[0:3], 0
    ds_read_b64_tr_b16 a[164:165], v252 offset:59136
    s_add_u32 s41, s48, 590976
    v_fma_f32 v209, v209, v246, v245
    v_mfma_f32_16x16x32_bf16 v[156:159], a[140:143], a[4:7], 0
    ds_read_b64_tr_b16 a[166:167], v252 offset:59392
    buffer_load_dwordx4 v247, s[52:55], s41 offen lds
    v_fma_f32 v210, v210, v246, v245
    v_mfma_f32_16x16x32_bf16 v[160:163], a[144:147], a[0:3], 0
    ds_read_b64_tr_b16 a[168:169], v252 offset:59168
    s_add_u32 m0, s75, 2112
    v_fma_f32 v211, v211, v246, v245
    v_mfma_f32_16x16x32_bf16 v[164:167], a[144:147], a[4:7], 0
    ds_read_b64_tr_b16 a[170:171], v252 offset:59424
    s_add_u32 s40, s48, 592128
    v_mul_f32 v208, v96, v208
    v_mfma_f32_16x16x32_bf16 v[168:171], a[148:151], a[0:3], 0
    ds_read_b64_tr_b16 a[172:173], v252 offset:59200
    buffer_load_dwordx4 v247, s[52:55], s40 offen lds
    v_mul_f32 v209, v97, v209
    v_mfma_f32_16x16x32_bf16 v[172:175], a[148:151], a[4:7], 0
    ds_read_b64_tr_b16 a[174:175], v252 offset:59456
    v_mul_f32 v210, v98, v210
    s_waitcnt lgkmcnt(6)
    v_mfma_f32_16x16x32_bf16 v[176:179], a[152:155], a[0:3], 0
    ds_read_b64_tr_b16 a[176:177], v252 offset:59232
    s_add_u32 m0, s75, 3168
    v_mul_f32 v211, v99, v211
    v_mfma_f32_16x16x32_bf16 v[180:183], a[152:155], a[4:7], 0
    ds_read_b64_tr_b16 a[178:179], v252 offset:59488
    s_add_u32 s41, s48, 593280
    v_exp_f32 v208, v208
    v_mfma_f32_16x16x32_bf16 v[184:187], a[156:159], a[0:3], 0
    ds_read_b64_tr_b16 a[180:181], v252 offset:59264
    buffer_load_dwordx4 v247, s[52:55], s41 offen lds
    v_exp_f32 v209, v209
    v_mfma_f32_16x16x32_bf16 v[188:191], a[156:159], a[4:7], 0
    ds_read_b64_tr_b16 a[182:183], v252 offset:59520
    s_add_u32 m0, s75, 4224
    v_exp_f32 v210, v210
    v_mfma_f32_16x16x32_bf16 v[192:195], a[160:163], a[0:3], 0
    ds_read_b64_tr_b16 a[184:185], v252 offset:59296
    s_add_u32 s40, s48, 594432
    v_exp_f32 v211, v211
    v_mfma_f32_16x16x32_bf16 v[196:199], a[160:163], a[4:7], 0
    ds_read_b64_tr_b16 a[186:187], v252 offset:59552
    v_mul_f32 v104, v96, v104
    s_waitcnt lgkmcnt(6)
    v_mfma_f32_16x16x32_bf16 v[128:131], a[164:167], a[8:11], v[128:131]
    ds_read_b64_tr_b16 a[188:189], v252 offset:59328
    buffer_load_dwordx4 v247, s[52:55], s40 offen lds
    v_mul_f32 v105, v97, v105
    v_mfma_f32_16x16x32_bf16 v[132:135], a[164:167], a[12:15], v[132:135]
    ds_read_b64_tr_b16 a[190:191], v252 offset:59584
    s_add_u32 m0, s75, 5280
    v_mul_f32 v106, v98, v106
    v_mfma_f32_16x16x32_bf16 v[136:139], a[168:171], a[8:11], v[136:139]
    ds_read_b64_tr_b16 a[192:193], v252 offset:59360
    s_add_u32 s41, s48, 595584
    v_mul_f32 v107, v99, v107
    v_mfma_f32_16x16x32_bf16 v[140:143], a[168:171], a[12:15], v[140:143]
    ds_read_b64_tr_b16 a[194:195], v252 offset:59616
    buffer_load_dwordx4 v247, s[52:55], s41 offen lds
    v_add_f32 v208, 1.0, v208
    v_mfma_f32_16x16x32_bf16 v[144:147], a[172:175], a[8:11], v[144:147]
    ds_read_b64_tr_b16 a[196:197], v253 offset:59136
    s_add_u32 m0, s75, 6336
    v_add_f32 v209, 1.0, v209
    v_mfma_f32_16x16x32_bf16 v[148:151], a[172:175], a[12:15], v[148:151]
    ds_read_b64_tr_b16 a[198:199], v253 offset:59392
    v_add_f32 v210, 1.0, v210
    s_waitcnt lgkmcnt(6)
    v_mfma_f32_16x16x32_bf16 v[152:155], a[176:179], a[8:11], v[152:155]
    ds_read_b64_tr_b16 a[128:129], v232 offset:3072
    s_add_u32 s40, s48, 596736
    v_add_f32 v211, 1.0, v211
    v_mfma_f32_16x16x32_bf16 v[156:159], a[176:179], a[12:15], v[156:159]
    ds_read_b64_tr_b16 a[130:131], v232 offset:3328
    buffer_load_dwordx4 v247, s[52:55], s40 offen lds
    v_rcp_f32 v208, v208
    v_mfma_f32_16x16x32_bf16 v[160:163], a[180:183], a[8:11], v[160:163]
    ds_read_b64_tr_b16 a[132:133], v232 offset:3104
    s_add_u32 m0, s75, 7392
    v_rcp_f32 v209, v209
    v_mfma_f32_16x16x32_bf16 v[164:167], a[180:183], a[12:15], v[164:167]
    ds_read_b64_tr_b16 a[134:135], v232 offset:3360
    s_add_u32 s41, s48, 597888
    v_rcp_f32 v210, v210
    v_mfma_f32_16x16x32_bf16 v[168:171], a[184:187], a[8:11], v[168:171]
    ds_read_b64_tr_b16 a[136:137], v232 offset:3136
    buffer_load_dwordx4 v247, s[52:55], s41 offen lds
    v_rcp_f32 v211, v211
    v_mfma_f32_16x16x32_bf16 v[172:175], a[184:187], a[12:15], v[172:175]
    ds_read_b64_tr_b16 a[138:139], v232 offset:3392
    v_mul_f32 v104, v104, v208
    s_waitcnt lgkmcnt(6)
    v_mfma_f32_16x16x32_bf16 v[176:179], a[188:191], a[8:11], v[176:179]
    ds_read_b64_tr_b16 a[140:141], v232 offset:3168
    s_add_u32 s42, s7, 16384
    v_mul_f32 v105, v105, v209
    v_mfma_f32_16x16x32_bf16 v[180:183], a[188:191], a[12:15], v[180:183]
    ds_read_b64_tr_b16 a[142:143], v232 offset:3424
    buffer_load_dwordx4 v[0:3], v255, s[24:27], s42 offen sc1
    v_mul_f32 v106, v106, v210
    v_mfma_f32_16x16x32_bf16 v[184:187], a[192:195], a[8:11], v[184:187]
    ds_read_b64_tr_b16 a[144:145], v232 offset:3200
    s_add_u32 m0, s75, 8448
    v_mul_f32 v107, v107, v211
    v_mfma_f32_16x16x32_bf16 v[188:191], a[192:195], a[12:15], v[188:191]
    ds_read_b64_tr_b16 a[146:147], v232 offset:3456
    s_add_u32 s40, s50, 16384
    v_cvt_pk_bf16_f32 v224, v104, v105
    v_mfma_f32_16x16x32_bf16 v[192:195], a[196:199], a[8:11], v[192:195]
    ds_read_b64_tr_b16 a[148:149], v232 offset:3232
    buffer_load_dwordx4 v255, s[56:59], s40 offen sc1 lds
    v_cvt_pk_bf16_f32 v225, v106, v107
    v_mfma_f32_16x16x32_bf16 v[196:199], a[196:199], a[12:15], v[196:199]
    ds_read_b64_tr_b16 a[150:151], v232 offset:3488
    v_mul_f32 v212, v100, v100
    s_waitcnt lgkmcnt(6)
    v_mfma_f32_16x16x32_bf16 v[128:131], a[128:131], a[16:19], v[128:131]
    ds_read_b64_tr_b16 a[152:153], v232 offset:3264
    s_add_u32 s43, s7, 163840
    v_mul_f32 v213, v101, v101
    v_mfma_f32_16x16x32_bf16 v[132:135], a[128:131], a[20:23], v[132:135]
    ds_read_b64_tr_b16 a[154:155], v232 offset:3520
    buffer_load_dwordx4 v[4:7], v255, s[24:27], s43 offen sc1
    v_mul_f32 v214, v102, v102
    v_mfma_f32_16x16x32_bf16 v[136:139], a[132:135], a[16:19], v[136:139]
    ds_read_b64_tr_b16 a[156:157], v232 offset:3296
    s_add_u32 s75, s6, 0
    v_mul_f32 v215, v103, v103
    v_mfma_f32_16x16x32_bf16 v[140:143], a[132:135], a[20:23], v[140:143]
    ds_read_b64_tr_b16 a[158:159], v232 offset:3552
    s_add_u32 m0, s75, 0
    v_fma_f32 v212, v212, v246, v245
    v_mfma_f32_16x16x32_bf16 v[144:147], a[136:139], a[16:19], v[144:147]
    ds_read_b64_tr_b16 a[160:161], v234 offset:3072
    s_add_u32 s40, s48, 626688
    v_fma_f32 v213, v213, v246, v245
    v_mfma_f32_16x16x32_bf16 v[148:151], a[136:139], a[20:23], v[148:151]
    ds_read_b64_tr_b16 a[162:163], v234 offset:3328
    v_fma_f32 v214, v214, v246, v245
    s_waitcnt lgkmcnt(6)
    v_mfma_f32_16x16x32_bf16 v[152:155], a[140:143], a[16:19], v[152:155]
    ds_read_b64_tr_b16 a[164:165], v232 offset:12544
    buffer_load_dwordx4 v247, s[52:55], s40 offen lds
    v_fma_f32 v215, v215, v246, v245
    v_mfma_f32_16x16x32_bf16 v[156:159], a[140:143], a[20:23], v[156:159]
    ds_read_b64_tr_b16 a[166:167], v232 offset:12800
    s_add_u32 m0, s75, 1056
    v_mul_f32 v212, v100, v212
    v_mfma_f32_16x16x32_bf16 v[160:163], a[144:147], a[16:19], v[160:163]
    ds_read_b64_tr_b16 a[168:169], v232 offset:12576
    s_add_u32 s41, s48, 627840
    v_mul_f32 v213, v101, v213
    v_mfma_f32_16x16x32_bf16 v[164:167], a[144:147], a[20:23], v[164:167]
    ds_read_b64_tr_b16 a[170:171], v232 offset:12832
    buffer_load_dwordx4 v247, s[52:55], s41 offen lds
    v_mul_f32 v214, v102, v214
    v_mfma_f32_16x16x32_bf16 v[168:171], a[148:151], a[16:19], v[168:171]
    ds_read_b64_tr_b16 a[172:173], v232 offset:12608
    s_add_u32 m0, s75, 2112
    v_mul_f32 v215, v103, v215
    v_mfma_f32_16x16x32_bf16 v[172:175], a[148:151], a[20:23], v[172:175]
    ds_read_b64_tr_b16 a[174:175], v232 offset:12864
    v_exp_f32 v212, v212
    s_waitcnt lgkmcnt(6)
    v_mfma_f32_16x16x32_bf16 v[176:179], a[152:155], a[16:19], v[176:179]
    ds_read_b64_tr_b16 a[176:177], v232 offset:12640
    s_add_u32 s40, s48, 628992
    v_exp_f32 v213, v213
    v_mfma_f32_16x16x32_bf16 v[180:183], a[152:155], a[20:23], v[180:183]
    ds_read_b64_tr_b16 a[178:179], v232 offset:12896
    buffer_load_dwordx4 v247, s[52:55], s40 offen lds
    v_exp_f32 v214, v214
    v_mfma_f32_16x16x32_bf16 v[184:187], a[156:159], a[16:19], v[184:187]
    ds_read_b64_tr_b16 a[180:181], v232 offset:12672
    s_add_u32 m0, s75, 3168
    v_exp_f32 v215, v215
    v_mfma_f32_16x16x32_bf16 v[188:191], a[156:159], a[20:23], v[188:191]
    ds_read_b64_tr_b16 a[182:183], v232 offset:12928
    s_add_u32 s41, s48, 630144
    v_mul_f32 v108, v100, v108
    v_mfma_f32_16x16x32_bf16 v[192:195], a[160:163], a[16:19], v[192:195]
    ds_read_b64_tr_b16 a[184:185], v232 offset:12704
    buffer_load_dwordx4 v247, s[52:55], s41 offen lds
    v_mul_f32 v109, v101, v109
    v_mfma_f32_16x16x32_bf16 v[196:199], a[160:163], a[20:23], v[196:199]
    ds_read_b64_tr_b16 a[186:187], v232 offset:12960
    v_mul_f32 v110, v102, v110
    s_waitcnt lgkmcnt(6)
    v_mfma_f32_16x16x32_bf16 v[128:131], a[164:167], a[24:27], v[128:131]
    ds_read_b64_tr_b16 a[188:189], v232 offset:12736
    s_waitcnt vmcnt(15)
    s_barrier
    v_mfma_f32_16x16x32_bf16 v[132:135], a[164:167], a[28:31], v[132:135]
    ds_read_b64_tr_b16 a[190:191], v232 offset:12992
    s_add_u32 m0, s75, 4224
    v_mul_f32 v111, v103, v111
    v_mfma_f32_16x16x32_bf16 v[136:139], a[168:171], a[24:27], v[136:139]
    ds_read_b64_tr_b16 a[192:193], v232 offset:12768
    s_add_u32 s40, s48, 631296
    v_add_f32 v212, 1.0, v212
    v_mfma_f32_16x16x32_bf16 v[140:143], a[168:171], a[28:31], v[140:143]
    ds_read_b64_tr_b16 a[194:195], v232 offset:13024
    buffer_load_dwordx4 v247, s[52:55], s40 offen lds
    v_add_f32 v213, 1.0, v213
    v_mfma_f32_16x16x32_bf16 v[144:147], a[172:175], a[24:27], v[144:147]
    ds_read_b64_tr_b16 a[196:197], v234 offset:12544
    s_add_u32 s42, s7, 20480
    v_add_f32 v214, 1.0, v214
    v_mfma_f32_16x16x32_bf16 v[148:151], a[172:175], a[28:31], v[148:151]
    ds_read_b64_tr_b16 a[198:199], v234 offset:12800
    v_add_f32 v215, 1.0, v215
    s_waitcnt lgkmcnt(6)
    v_mfma_f32_16x16x32_bf16 v[152:155], a[176:179], a[24:27], v[152:155]
    ds_read_b64_tr_b16 a[128:129], v232 offset:22016
    buffer_load_dwordx4 v[8:11], v255, s[24:27], s42 offen sc1
    v_rcp_f32 v212, v212
    v_mfma_f32_16x16x32_bf16 v[156:159], a[176:179], a[28:31], v[156:159]
    ds_read_b64_tr_b16 a[130:131], v232 offset:22272
    s_add_u32 m0, s75, 5280
    v_rcp_f32 v213, v213
    v_mfma_f32_16x16x32_bf16 v[160:163], a[180:183], a[24:27], v[160:163]
    ds_read_b64_tr_b16 a[132:133], v232 offset:22048
    s_add_u32 s41, s48, 632448
    v_rcp_f32 v214, v214
    v_mfma_f32_16x16x32_bf16 v[164:167], a[180:183], a[28:31], v[164:167]
    ds_read_b64_tr_b16 a[134:135], v232 offset:22304
    buffer_load_dwordx4 v247, s[52:55], s41 offen lds
    v_rcp_f32 v215, v215
    v_mfma_f32_16x16x32_bf16 v[168:171], a[184:187], a[24:27], v[168:171]
    ds_read_b64_tr_b16 a[136:137], v232 offset:22080
    s_add_u32 s43, s7, 167936
    v_mul_f32 v108, v108, v212
    v_mfma_f32_16x16x32_bf16 v[172:175], a[184:187], a[28:31], v[172:175]
    ds_read_b64_tr_b16 a[138:139], v232 offset:22336
    v_mul_f32 v109, v109, v213
    s_waitcnt lgkmcnt(6)
    v_mfma_f32_16x16x32_bf16 v[176:179], a[188:191], a[24:27], v[176:179]
    ds_read_b64_tr_b16 a[140:141], v232 offset:22112
    buffer_load_dwordx4 v[12:15], v255, s[24:27], s43 offen sc1
    v_mul_f32 v110, v110, v214
    v_mfma_f32_16x16x32_bf16 v[180:183], a[188:191], a[28:31], v[180:183]
    ds_read_b64_tr_b16 a[142:143], v232 offset:22368
    s_add_u32 m0, s75, 6336
    v_mul_f32 v111, v111, v215
    v_mfma_f32_16x16x32_bf16 v[184:187], a[192:195], a[24:27], v[184:187]
    ds_read_b64_tr_b16 a[144:145], v232 offset:22144
    s_add_u32 s40, s48, 633600
    v_cvt_pk_bf16_f32 v226, v108, v109
    v_mfma_f32_16x16x32_bf16 v[188:191], a[192:195], a[28:31], v[188:191]
    ds_read_b64_tr_b16 a[146:147], v232 offset:22400
    buffer_load_dwordx4 v247, s[52:55], s40 offen lds
    v_cvt_pk_bf16_f32 v227, v110, v111
    v_mfma_f32_16x16x32_bf16 v[192:195], a[196:199], a[24:27], v[192:195]
    ds_read_b64_tr_b16 a[148:149], v232 offset:22176
    s_add_u32 m0, s75, 7392
    s_add_u32 s44, s37, 3584
    v_mfma_f32_16x16x32_bf16 v[196:199], a[196:199], a[28:31], v[196:199]
    ds_read_b64_tr_b16 a[150:151], v232 offset:22432
    buffer_store_dwordx4 v[224:227], v244, s[24:27], s44 offen sc1
    s_waitcnt lgkmcnt(6)
    v_mfma_f32_16x16x32_bf16 v[128:131], a[128:131], a[32:35], v[128:131]
    ds_read_b64_tr_b16 a[152:153], v232 offset:22208
    s_add_u32 s41, s48, 634752
    v_mul_f32 v216, v112, v112
    v_mfma_f32_16x16x32_bf16 v[132:135], a[128:131], a[36:39], v[132:135]
    ds_read_b64_tr_b16 a[154:155], v232 offset:22464
    buffer_load_dwordx4 v247, s[52:55], s41 offen lds
    v_mul_f32 v217, v113, v113
    v_mfma_f32_16x16x32_bf16 v[136:139], a[132:135], a[32:35], v[136:139]
    ds_read_b64_tr_b16 a[156:157], v232 offset:22240
    s_add_u32 m0, s75, 8448
    v_mul_f32 v218, v114, v114
    v_mfma_f32_16x16x32_bf16 v[140:143], a[132:135], a[36:39], v[140:143]
    ds_read_b64_tr_b16 a[158:159], v232 offset:22496
    s_add_u32 s40, s50, 17408
    v_mul_f32 v219, v115, v115
    v_mfma_f32_16x16x32_bf16 v[144:147], a[136:139], a[32:35], v[144:147]
    ds_read_b64_tr_b16 a[160:161], v234 offset:22016
    buffer_load_dwordx4 v255, s[56:59], s40 offen sc1 lds
    v_fma_f32 v216, v216, v246, v245
    v_mfma_f32_16x16x32_bf16 v[148:151], a[136:139], a[36:39], v[148:151]
    ds_read_b64_tr_b16 a[162:163], v234 offset:22272
    v_fma_f32 v217, v217, v246, v245
    s_waitcnt lgkmcnt(6)
    v_mfma_f32_16x16x32_bf16 v[152:155], a[140:143], a[32:35], v[152:155]
    ds_read_b64_tr_b16 a[164:165], v232 offset:31488
    s_mov_b32 s75, s72
    v_fma_f32 v218, v218, v246, v245
    v_mfma_f32_16x16x32_bf16 v[156:159], a[140:143], a[36:39], v[156:159]
    ds_read_b64_tr_b16 a[166:167], v232 offset:31744
    s_add_u32 m0, s75, 0
    v_fma_f32 v219, v219, v246, v245
    v_mfma_f32_16x16x32_bf16 v[160:163], a[144:147], a[32:35], v[160:163]
    ds_read_b64_tr_b16 a[168:169], v232 offset:31520
    s_add_u32 s40, s48, 73728
    v_mul_f32 v216, v112, v216
    v_mfma_f32_16x16x32_bf16 v[164:167], a[144:147], a[36:39], v[164:167]
    ds_read_b64_tr_b16 a[170:171], v232 offset:31776
    buffer_load_dwordx4 v247, s[52:55], s40 offen lds
    v_mul_f32 v217, v113, v217
    v_mfma_f32_16x16x32_bf16 v[168:171], a[148:151], a[32:35], v[168:171]
    ds_read_b64_tr_b16 a[172:173], v232 offset:31552
    s_add_u32 s42, s7, 24576
    v_mul_f32 v218, v114, v218
    v_mfma_f32_16x16x32_bf16 v[172:175], a[148:151], a[36:39], v[172:175]
    ds_read_b64_tr_b16 a[174:175], v232 offset:31808
    v_mul_f32 v219, v115, v219
    s_waitcnt lgkmcnt(6)
    v_mfma_f32_16x16x32_bf16 v[176:179], a[152:155], a[32:35], v[176:179]
    ds_read_b64_tr_b16 a[176:177], v232 offset:31584
    buffer_load_dwordx4 v[16:19], v255, s[24:27], s42 offen sc1
    v_exp_f32 v216, v216
    v_mfma_f32_16x16x32_bf16 v[180:183], a[152:155], a[36:39], v[180:183]
    ds_read_b64_tr_b16 a[178:179], v232 offset:31840
    s_add_u32 s43, s7, 172032
    v_exp_f32 v217, v217
    v_mfma_f32_16x16x32_bf16 v[184:187], a[156:159], a[32:35], v[184:187]
    ds_read_b64_tr_b16 a[180:181], v232 offset:31616
    buffer_load_dwordx4 v[20:23], v255, s[24:27], s43 offen sc1
    v_exp_f32 v218, v218
    v_mfma_f32_16x16x32_bf16 v[188:191], a[156:159], a[36:39], v[188:191]
    ds_read_b64_tr_b16 a[182:183], v232 offset:31872
    s_add_u32 m0, s75, 1056
    v_exp_f32 v219, v219
    v_mfma_f32_16x16x32_bf16 v[192:195], a[160:163], a[32:35], v[192:195]
    ds_read_b64_tr_b16 a[184:185], v232 offset:31648
    s_add_u32 s41, s48, 74880
    v_mul_f32 v120, v112, v120
    v_mfma_f32_16x16x32_bf16 v[196:199], a[160:163], a[36:39], v[196:199]
    ds_read_b64_tr_b16 a[186:187], v232 offset:31904
    v_mul_f32 v121, v113, v121
    s_waitcnt lgkmcnt(6)
    v_mfma_f32_16x16x32_bf16 v[128:131], a[164:167], a[40:43], v[128:131]
    ds_read_b64_tr_b16 a[188:189], v232 offset:31680
    buffer_load_dwordx4 v247, s[52:55], s41 offen lds
    v_mul_f32 v122, v114, v122
    v_mfma_f32_16x16x32_bf16 v[132:135], a[164:167], a[44:47], v[132:135]
    ds_read_b64_tr_b16 a[190:191], v232 offset:31936
    s_add_u32 m0, s75, 2112
    v_mul_f32 v123, v115, v123
    v_mfma_f32_16x16x32_bf16 v[136:139], a[168:171], a[40:43], v[136:139]
    ds_read_b64_tr_b16 a[192:193], v232 offset:31712
    s_add_u32 s40, s48, 76032
    v_add_f32 v216, 1.0, v216
    v_mfma_f32_16x16x32_bf16 v[140:143], a[168:171], a[44:47], v[140:143]
    ds_read_b64_tr_b16 a[194:195], v232 offset:31968
    buffer_load_dwordx4 v247, s[52:55], s40 offen lds
    v_add_f32 v217, 1.0, v217
    v_mfma_f32_16x16x32_bf16 v[144:147], a[172:175], a[40:43], v[144:147]
    ds_read_b64_tr_b16 a[196:197], v234 offset:31488
    s_add_u32 m0, s75, 3168
    v_add_f32 v218, 1.0, v218
    v_mfma_f32_16x16x32_bf16 v[148:151], a[172:175], a[44:47], v[148:151]
    ds_read_b64_tr_b16 a[198:199], v234 offset:31744
    v_add_f32 v219, 1.0, v219
    s_waitcnt lgkmcnt(6)
    v_mfma_f32_16x16x32_bf16 v[152:155], a[176:179], a[40:43], v[152:155]
    ds_read_b64_tr_b16 a[128:129], v232 offset:40960
    s_add_u32 s41, s48, 77184
    v_rcp_f32 v216, v216
    v_mfma_f32_16x16x32_bf16 v[156:159], a[176:179], a[44:47], v[156:159]
    ds_read_b64_tr_b16 a[130:131], v232 offset:41216
    buffer_load_dwordx4 v247, s[52:55], s41 offen lds
    v_rcp_f32 v217, v217
    v_mfma_f32_16x16x32_bf16 v[160:163], a[180:183], a[40:43], v[160:163]
    ds_read_b64_tr_b16 a[132:133], v232 offset:40992
    s_add_u32 s42, s7, 28672
    v_rcp_f32 v218, v218
    v_mfma_f32_16x16x32_bf16 v[164:167], a[180:183], a[44:47], v[164:167]
    ds_read_b64_tr_b16 a[134:135], v232 offset:41248
    buffer_load_dwordx4 v[24:27], v255, s[24:27], s42 offen sc1
    v_rcp_f32 v219, v219
    v_mfma_f32_16x16x32_bf16 v[168:171], a[184:187], a[40:43], v[168:171]
    ds_read_b64_tr_b16 a[136:137], v232 offset:41024
    s_add_u32 m0, s75, 4224
    v_mul_f32 v120, v120, v216
    v_mfma_f32_16x16x32_bf16 v[172:175], a[184:187], a[44:47], v[172:175]
    ds_read_b64_tr_b16 a[138:139], v232 offset:41280
    v_mul_f32 v121, v121, v217
    s_waitcnt lgkmcnt(6)
    v_mfma_f32_16x16x32_bf16 v[176:179], a[188:191], a[40:43], v[176:179]
    ds_read_b64_tr_b16 a[140:141], v232 offset:41056
    s_add_u32 s40, s48, 78336
    v_mul_f32 v122, v122, v218
    v_mfma_f32_16x16x32_bf16 v[180:183], a[188:191], a[44:47], v[180:183]
    ds_read_b64_tr_b16 a[142:143], v232 offset:41312
    buffer_load_dwordx4 v247, s[52:55], s40 offen lds
    v_mul_f32 v123, v123, v219
    v_mfma_f32_16x16x32_bf16 v[184:187], a[192:195], a[40:43], v[184:187]
    ds_read_b64_tr_b16 a[144:145], v232 offset:41088
    s_add_u32 s43, s7, 176128
    v_cvt_pk_bf16_f32 v228, v120, v121
    v_mfma_f32_16x16x32_bf16 v[188:191], a[192:195], a[44:47], v[188:191]
    ds_read_b64_tr_b16 a[146:147], v232 offset:41344
    buffer_load_dwordx4 v[28:31], v255, s[24:27], s43 offen sc1
    v_cvt_pk_bf16_f32 v229, v122, v123
    v_mfma_f32_16x16x32_bf16 v[192:195], a[196:199], a[40:43], v[192:195]
    ds_read_b64_tr_b16 a[148:149], v232 offset:41120
    s_add_u32 m0, s75, 5280
    v_mul_f32 v220, v116, v116
    v_mfma_f32_16x16x32_bf16 v[196:199], a[196:199], a[44:47], v[196:199]
    ds_read_b64_tr_b16 a[150:151], v232 offset:41376
    v_mul_f32 v221, v117, v117
    s_waitcnt lgkmcnt(6)
    v_mfma_f32_16x16x32_bf16 v[128:131], a[128:131], a[48:51], v[128:131]
    ds_read_b64_tr_b16 a[152:153], v232 offset:41152
    s_add_u32 s41, s48, 79488
    v_mul_f32 v222, v118, v118
    v_mfma_f32_16x16x32_bf16 v[132:135], a[128:131], a[52:55], v[132:135]
    ds_read_b64_tr_b16 a[154:155], v232 offset:41408
    buffer_load_dwordx4 v247, s[52:55], s41 offen lds
    v_mul_f32 v223, v119, v119
    v_mfma_f32_16x16x32_bf16 v[136:139], a[132:135], a[48:51], v[136:139]
    ds_read_b64_tr_b16 a[156:157], v232 offset:41184
    s_add_u32 m0, s75, 6336
    v_fma_f32 v220, v220, v246, v245
    v_mfma_f32_16x16x32_bf16 v[140:143], a[132:135], a[52:55], v[140:143]
    ds_read_b64_tr_b16 a[158:159], v232 offset:41440
    s_add_u32 s40, s48, 80640
    v_fma_f32 v221, v221, v246, v245
    v_mfma_f32_16x16x32_bf16 v[144:147], a[136:139], a[48:51], v[144:147]
    ds_read_b64_tr_b16 a[160:161], v234 offset:40960
    buffer_load_dwordx4 v247, s[52:55], s40 offen lds
    v_fma_f32 v222, v222, v246, v245
    v_mfma_f32_16x16x32_bf16 v[148:151], a[136:139], a[52:55], v[148:151]
    ds_read_b64_tr_b16 a[162:163], v234 offset:41216
    v_fma_f32 v223, v223, v246, v245
    s_waitcnt lgkmcnt(6)
    v_mfma_f32_16x16x32_bf16 v[152:155], a[140:143], a[48:51], v[152:155]
    ds_read_b64_tr_b16 a[164:165], v232 offset:50432
    s_add_u32 m0, s75, 7392
    v_mul_f32 v220, v116, v220
    v_mfma_f32_16x16x32_bf16 v[156:159], a[140:143], a[52:55], v[156:159]
    ds_read_b64_tr_b16 a[166:167], v232 offset:50688
    s_add_u32 s41, s48, 81792
    v_mul_f32 v221, v117, v221
    v_mfma_f32_16x16x32_bf16 v[160:163], a[144:147], a[48:51], v[160:163]
    ds_read_b64_tr_b16 a[168:169], v232 offset:50464
    buffer_load_dwordx4 v247, s[52:55], s41 offen lds
    v_mul_f32 v222, v118, v222
    v_mfma_f32_16x16x32_bf16 v[164:167], a[144:147], a[52:55], v[164:167]
    ds_read_b64_tr_b16 a[170:171], v232 offset:50720
    s_add_u32 s42, s7, 17408
    v_mul_f32 v223, v119, v223
    v_mfma_f32_16x16x32_bf16 v[168:171], a[148:151], a[48:51], v[168:171]
    ds_read_b64_tr_b16 a[172:173], v232 offset:50496
    buffer_load_dwordx4 v[32:35], v255, s[24:27], s42 offen sc1
    v_exp_f32 v220, v220
    v_mfma_f32_16x16x32_bf16 v[172:175], a[148:151], a[52:55], v[172:175]
    ds_read_b64_tr_b16 a[174:175], v232 offset:50752
    v_exp_f32 v221, v221
    s_waitcnt lgkmcnt(6)
    v_mfma_f32_16x16x32_bf16 v[176:179], a[152:155], a[48:51], v[176:179]
    ds_read_b64_tr_b16 a[176:177], v232 offset:50528
    s_add_u32 m0, s75, 8448
    v_exp_f32 v222, v222
    v_mfma_f32_16x16x32_bf16 v[180:183], a[152:155], a[52:55], v[180:183]
    ds_read_b64_tr_b16 a[178:179], v232 offset:50784
    s_add_u32 s40, s50, 2048
    v_exp_f32 v223, v223
    v_mfma_f32_16x16x32_bf16 v[184:187], a[156:159], a[48:51], v[184:187]
    ds_read_b64_tr_b16 a[180:181], v232 offset:50560
    buffer_load_dwordx4 v255, s[56:59], s40 offen sc1 lds
    v_mul_f32 v124, v116, v124
    v_mfma_f32_16x16x32_bf16 v[188:191], a[156:159], a[52:55], v[188:191]
    ds_read_b64_tr_b16 a[182:183], v232 offset:50816
    s_add_u32 s43, s7, 164864
    v_mul_f32 v125, v117, v125
    v_mfma_f32_16x16x32_bf16 v[192:195], a[160:163], a[48:51], v[192:195]
    ds_read_b64_tr_b16 a[184:185], v232 offset:50592
    buffer_load_dwordx4 v[36:39], v255, s[24:27], s43 offen sc1
    v_mul_f32 v126, v118, v126
    v_mfma_f32_16x16x32_bf16 v[196:199], a[160:163], a[52:55], v[196:199]
    ds_read_b64_tr_b16 a[186:187], v232 offset:50848
    v_mul_f32 v127, v119, v127
    s_waitcnt lgkmcnt(6)
    v_mfma_f32_16x16x32_bf16 v[128:131], a[164:167], a[56:59], v[128:131]
    ds_read_b64_tr_b16 a[188:189], v232 offset:50624
    s_waitcnt vmcnt(28)
    s_barrier
    v_mfma_f32_16x16x32_bf16 v[132:135], a[164:167], a[60:63], v[132:135]
    ds_read_b64_tr_b16 a[190:191], v232 offset:50880
    s_add_u32 s42, s7, 21504
    v_add_f32 v220, 1.0, v220
    v_mfma_f32_16x16x32_bf16 v[136:139], a[168:171], a[56:59], v[136:139]
    ds_read_b64_tr_b16 a[192:193], v232 offset:50656
    buffer_load_dwordx4 v[40:43], v255, s[24:27], s42 offen sc1
    v_add_f32 v221, 1.0, v221
    v_mfma_f32_16x16x32_bf16 v[140:143], a[168:171], a[60:63], v[140:143]
    ds_read_b64_tr_b16 a[194:195], v232 offset:50912
    s_add_u32 s43, s7, 168960
    v_add_f32 v222, 1.0, v222
    v_mfma_f32_16x16x32_bf16 v[144:147], a[172:175], a[56:59], v[144:147]
    ds_read_b64_tr_b16 a[196:197], v234 offset:50432
    buffer_load_dwordx4 v[44:47], v255, s[24:27], s43 offen sc1
    v_add_f32 v223, 1.0, v223
    v_mfma_f32_16x16x32_bf16 v[148:151], a[172:175], a[60:63], v[148:151]
    ds_read_b64_tr_b16 a[198:199], v234 offset:50688
    v_rcp_f32 v220, v220
    s_waitcnt lgkmcnt(6)
    v_mfma_f32_16x16x32_bf16 v[152:155], a[176:179], a[56:59], v[152:155]
    ds_read_b64_tr_b16 a[128:129], v232 offset:59904
    s_add_u32 s46, s77, 32
    v_rcp_f32 v221, v221
    v_mfma_f32_16x16x32_bf16 v[156:159], a[176:179], a[60:63], v[156:159]
    ds_read_b64_tr_b16 a[130:131], v232 offset:60160
    buffer_load_dword v236, v250, s[56:59], s46 offen sc1
    v_rcp_f32 v222, v222
    v_mfma_f32_16x16x32_bf16 v[160:163], a[180:183], a[56:59], v[160:163]
    ds_read_b64_tr_b16 a[132:133], v232 offset:59936
    s_add_u32 s75, s6, 78080
    v_rcp_f32 v223, v223
    v_mfma_f32_16x16x32_bf16 v[164:167], a[180:183], a[60:63], v[164:167]
    ds_read_b64_tr_b16 a[134:135], v232 offset:60192
    s_add_u32 m0, s75, 0
    v_mul_f32 v124, v124, v220
    v_mfma_f32_16x16x32_bf16 v[168:171], a[184:187], a[56:59], v[168:171]
    ds_read_b64_tr_b16 a[136:137], v232 offset:59968
    s_add_u32 s40, s48, 663552
    v_mul_f32 v125, v125, v221
    v_mfma_f32_16x16x32_bf16 v[172:175], a[184:187], a[60:63], v[172:175]
    ds_read_b64_tr_b16 a[138:139], v232 offset:60224
    v_mul_f32 v126, v126, v222
    s_waitcnt lgkmcnt(6)
    v_mfma_f32_16x16x32_bf16 v[176:179], a[188:191], a[56:59], v[176:179]
    ds_read_b64_tr_b16 a[140:141], v232 offset:60000
    buffer_load_dwordx4 v247, s[52:55], s40 offen lds
    v_mul_f32 v127, v127, v223
    v_mfma_f32_16x16x32_bf16 v[180:183], a[188:191], a[60:63], v[180:183]
    ds_read_b64_tr_b16 a[142:143], v232 offset:60256
    s_add_u32 s42, s7, 25600
    v_cvt_pk_bf16_f32 v230, v124, v125
    v_mfma_f32_16x16x32_bf16 v[184:187], a[192:195], a[56:59], v[184:187]
    ds_read_b64_tr_b16 a[144:145], v232 offset:60032
    buffer_load_dwordx4 v[48:51], v255, s[24:27], s42 offen sc1
    v_cvt_pk_bf16_f32 v231, v126, v127
    v_mfma_f32_16x16x32_bf16 v[188:191], a[192:195], a[60:63], v[188:191]
    ds_read_b64_tr_b16 a[146:147], v232 offset:60288
    s_add_u32 s43, s7, 173056
    s_add_u32 s45, s37, 298496
    v_mfma_f32_16x16x32_bf16 v[192:195], a[196:199], a[56:59], v[192:195]
    ds_read_b64_tr_b16 a[148:149], v232 offset:60064
    buffer_load_dwordx4 v[52:55], v255, s[24:27], s43 offen sc1
    buffer_store_dwordx4 v[228:231], v244, s[24:27], s45 offen sc1
    v_mfma_f32_16x16x32_bf16 v[196:199], a[196:199], a[60:63], v[196:199]
    ds_read_b64_tr_b16 a[150:151], v232 offset:60320
    s_waitcnt lgkmcnt(6)
    v_mfma_f32_16x16x32_bf16 v[128:131], a[128:131], v[0:3], v[128:131]
    ds_read_b64_tr_b16 a[152:153], v232 offset:60096
    s_add_u32 m0, s75, 1056
    s_waitcnt vmcnt(34)
    v_mfma_f32_16x16x32_bf16 v[132:135], a[128:131], v[4:7], v[132:135]
    ds_read_b64_tr_b16 a[154:155], v232 offset:60352
    s_add_u32 s41, s48, 664704
    v_mfma_f32_16x16x32_bf16 v[136:139], a[132:135], v[0:3], v[136:139]
    ds_read_b64_tr_b16 a[156:157], v232 offset:60128
    buffer_load_dwordx4 v247, s[52:55], s41 offen lds
    v_mfma_f32_16x16x32_bf16 v[140:143], a[132:135], v[4:7], v[140:143]
    ds_read_b64_tr_b16 a[158:159], v232 offset:60384
    s_add_u32 m0, s75, 2112
    v_mfma_f32_16x16x32_bf16 v[144:147], a[136:139], v[0:3], v[144:147]
    ds_read_b64_tr_b16 a[160:161], v234 offset:59904
    s_add_u32 s40, s48, 665856
    v_mfma_f32_16x16x32_bf16 v[148:151], a[136:139], v[4:7], v[148:151]
    ds_read_b64_tr_b16 a[162:163], v234 offset:60160
    s_waitcnt lgkmcnt(6)
    v_mfma_f32_16x16x32_bf16 v[152:155], a[140:143], v[0:3], v[152:155]
    ds_read_b64_tr_b16 a[164:165], v233 offset:3840
    buffer_load_dwordx4 v247, s[52:55], s40 offen lds
    v_mfma_f32_16x16x32_bf16 v[156:159], a[140:143], v[4:7], v[156:159]
    ds_read_b64_tr_b16 a[166:167], v233 offset:4096
    s_add_u32 m0, s75, 3168
    v_mfma_f32_16x16x32_bf16 v[160:163], a[144:147], v[0:3], v[160:163]
    ds_read_b64_tr_b16 a[168:169], v233 offset:3872
    s_add_u32 s41, s48, 667008
    v_mfma_f32_16x16x32_bf16 v[164:167], a[144:147], v[4:7], v[164:167]
    ds_read_b64_tr_b16 a[170:171], v233 offset:4128
    buffer_load_dwordx4 v247, s[52:55], s41 offen lds
    v_mfma_f32_16x16x32_bf16 v[168:171], a[148:151], v[0:3], v[168:171]
    ds_read_b64_tr_b16 a[172:173], v233 offset:3904
    s_add_u32 s42, s7, 29696
    v_mfma_f32_16x16x32_bf16 v[172:175], a[148:151], v[4:7], v[172:175]
    ds_read_b64_tr_b16 a[174:175], v233 offset:4160
    s_waitcnt lgkmcnt(6)
    v_mfma_f32_16x16x32_bf16 v[176:179], a[152:155], v[0:3], v[176:179]
    ds_read_b64_tr_b16 a[176:177], v233 offset:3936
    buffer_load_dwordx4 v[56:59], v255, s[24:27], s42 offen sc1
    v_mfma_f32_16x16x32_bf16 v[180:183], a[152:155], v[4:7], v[180:183]
    ds_read_b64_tr_b16 a[178:179], v233 offset:4192
    s_add_u32 m0, s75, 4224
    v_mfma_f32_16x16x32_bf16 v[184:187], a[156:159], v[0:3], v[184:187]
    ds_read_b64_tr_b16 a[180:181], v233 offset:3968
    s_add_u32 s40, s48, 668160
    v_mfma_f32_16x16x32_bf16 v[188:191], a[156:159], v[4:7], v[188:191]
    ds_read_b64_tr_b16 a[182:183], v233 offset:4224
    buffer_load_dwordx4 v247, s[52:55], s40 offen lds
    v_mfma_f32_16x16x32_bf16 v[192:195], a[160:163], v[0:3], v[192:195]
    ds_read_b64_tr_b16 a[184:185], v233 offset:4000
    s_add_u32 s43, s7, 177152
    v_mfma_f32_16x16x32_bf16 v[196:199], a[160:163], v[4:7], v[196:199]
    ds_read_b64_tr_b16 a[186:187], v233 offset:4256
    s_waitcnt lgkmcnt(6)
    s_waitcnt vmcnt(33)
    v_mfma_f32_16x16x32_bf16 v[128:131], a[164:167], v[8:11], v[128:131]
    ds_read_b64_tr_b16 a[188:189], v233 offset:4032
    buffer_load_dwordx4 v[60:63], v255, s[24:27], s43 offen sc1
    s_waitcnt vmcnt(32)
    v_mfma_f32_16x16x32_bf16 v[132:135], a[164:167], v[12:15], v[132:135]
    ds_read_b64_tr_b16 a[190:191], v233 offset:4288
    s_waitcnt vmcnt(10)
    v_cmp_ne_u32 vcc, v236, v249
    s_cbranch_vccz L_ok4
s_branch L_spin4
L_ok4:
    v_mfma_f32_16x16x32_bf16 v[136:139], a[168:171], v[8:11], v[136:139]
    ds_read_b64_tr_b16 a[192:193], v233 offset:4064
    s_add_u32 m0, s75, 5280
    v_mfma_f32_16x16x32_bf16 v[140:143], a[168:171], v[12:15], v[140:143]
    ds_read_b64_tr_b16 a[194:195], v233 offset:4320
    s_add_u32 s41, s48, 669312
    v_mfma_f32_16x16x32_bf16 v[144:147], a[172:175], v[8:11], v[144:147]
    ds_read_b64_tr_b16 a[196:197], v235 offset:3840
    buffer_load_dwordx4 v247, s[52:55], s41 offen lds
    v_mfma_f32_16x16x32_bf16 v[148:151], a[172:175], v[12:15], v[148:151]
    ds_read_b64_tr_b16 a[198:199], v235 offset:4096
    s_waitcnt lgkmcnt(6)
    v_mfma_f32_16x16x32_bf16 v[152:155], a[176:179], v[8:11], v[152:155]
    ds_read_b64_tr_b16 a[128:129], v233 offset:13312
    s_add_u32 m0, s75, 6336
    v_mfma_f32_16x16x32_bf16 v[156:159], a[176:179], v[12:15], v[156:159]
    ds_read_b64_tr_b16 a[130:131], v233 offset:13568
    s_add_u32 s40, s48, 670464
    v_mfma_f32_16x16x32_bf16 v[160:163], a[180:183], v[8:11], v[160:163]
    ds_read_b64_tr_b16 a[132:133], v233 offset:13344
    buffer_load_dwordx4 v247, s[52:55], s40 offen lds
    v_mfma_f32_16x16x32_bf16 v[164:167], a[180:183], v[12:15], v[164:167]
    ds_read_b64_tr_b16 a[134:135], v233 offset:13600
    s_add_u32 m0, s75, 7392
    v_mfma_f32_16x16x32_bf16 v[168:171], a[184:187], v[8:11], v[168:171]
    ds_read_b64_tr_b16 a[136:137], v233 offset:13376
    s_add_u32 s41, s48, 671616
    v_mfma_f32_16x16x32_bf16 v[172:175], a[184:187], v[12:15], v[172:175]
    ds_read_b64_tr_b16 a[138:139], v233 offset:13632
    s_waitcnt lgkmcnt(6)
    v_mfma_f32_16x16x32_bf16 v[176:179], a[188:191], v[8:11], v[176:179]
    ds_read_b64_tr_b16 a[140:141], v233 offset:13408
    buffer_load_dwordx4 v247, s[52:55], s41 offen lds
    v_mfma_f32_16x16x32_bf16 v[180:183], a[188:191], v[12:15], v[180:183]
    ds_read_b64_tr_b16 a[142:143], v233 offset:13664
    s_add_u32 s42, s7, 2048
    v_mfma_f32_16x16x32_bf16 v[184:187], a[192:195], v[8:11], v[184:187]
    ds_read_b64_tr_b16 a[144:145], v233 offset:13440
    buffer_load_dwordx4 v[200:203], v255, s[24:27], s42 offen sc1
    v_mfma_f32_16x16x32_bf16 v[188:191], a[192:195], v[12:15], v[188:191]
    ds_read_b64_tr_b16 a[146:147], v233 offset:13696
    s_add_u32 m0, s75, 8448
    v_mfma_f32_16x16x32_bf16 v[192:195], a[196:199], v[8:11], v[192:195]
    ds_read_b64_tr_b16 a[148:149], v233 offset:13472
    s_add_u32 s40, s50, 18432
    v_mfma_f32_16x16x32_bf16 v[196:199], a[196:199], v[12:15], v[196:199]
    ds_read_b64_tr_b16 a[150:151], v233 offset:13728
    s_waitcnt lgkmcnt(6)
    v_mfma_f32_16x16x32_bf16 v[128:131], a[128:131], v[16:19], v[128:131]
    ds_read_b64_tr_b16 a[152:153], v233 offset:13504
    buffer_load_dwordx4 v255, s[56:59], s40 offen sc1 lds
    v_mfma_f32_16x16x32_bf16 v[132:135], a[128:131], v[20:23], v[132:135]
    ds_read_b64_tr_b16 a[154:155], v233 offset:13760
    s_add_u32 s43, s7, 149504
    v_mfma_f32_16x16x32_bf16 v[136:139], a[132:135], v[16:19], v[136:139]
    ds_read_b64_tr_b16 a[156:157], v233 offset:13536
    buffer_load_dwordx4 v[204:207], v255, s[24:27], s43 offen sc1
    v_mfma_f32_16x16x32_bf16 v[140:143], a[132:135], v[20:23], v[140:143]
    ds_read_b64_tr_b16 a[158:159], v233 offset:13792
    s_add_u32 s42, s7, 6144
    v_mfma_f32_16x16x32_bf16 v[144:147], a[136:139], v[16:19], v[144:147]
    ds_read_b64_tr_b16 a[160:161], v235 offset:13312
    buffer_load_dwordx4 v[208:211], v255, s[24:27], s42 offen sc1
    v_mfma_f32_16x16x32_bf16 v[148:151], a[136:139], v[20:23], v[148:151]
    ds_read_b64_tr_b16 a[162:163], v235 offset:13568
    s_waitcnt lgkmcnt(6)
    v_mfma_f32_16x16x32_bf16 v[152:155], a[140:143], v[16:19], v[152:155]
    ds_read_b64_tr_b16 a[164:165], v233 offset:22784
    v_mfma_f32_16x16x32_bf16 v[156:159], a[140:143], v[20:23], v[156:159]
    ds_read_b64_tr_b16 a[166:167], v233 offset:23040
    s_add_u32 s43, s7, 153600
    v_mfma_f32_16x16x32_bf16 v[160:163], a[144:147], v[16:19], v[160:163]
    ds_read_b64_tr_b16 a[168:169], v233 offset:22816
    buffer_load_dwordx4 v[212:215], v255, s[24:27], s43 offen sc1
    v_mfma_f32_16x16x32_bf16 v[164:167], a[144:147], v[20:23], v[164:167]
    ds_read_b64_tr_b16 a[170:171], v233 offset:23072
    v_mfma_f32_16x16x32_bf16 v[168:171], a[148:151], v[16:19], v[168:171]
    ds_read_b64_tr_b16 a[172:173], v233 offset:22848
    v_mfma_f32_16x16x32_bf16 v[172:175], a[148:151], v[20:23], v[172:175]
    ds_read_b64_tr_b16 a[174:175], v233 offset:23104
    s_waitcnt lgkmcnt(6)
    v_mfma_f32_16x16x32_bf16 v[176:179], a[152:155], v[16:19], v[176:179]
    ds_read_b64_tr_b16 a[176:177], v233 offset:22880
    s_waitcnt vmcnt(14)
    s_mov_b64 exec, 1
    s_add_u32 s47, s76, 64
    buffer_store_dword v249, v250, s[56:59], s47 offen sc1
    s_mov_b64 exec, -1
    v_mfma_f32_16x16x32_bf16 v[180:183], a[152:155], v[20:23], v[180:183]
    ds_read_b64_tr_b16 a[178:179], v233 offset:23136
    v_mfma_f32_16x16x32_bf16 v[184:187], a[156:159], v[16:19], v[184:187]
    ds_read_b64_tr_b16 a[180:181], v233 offset:22912
    v_mfma_f32_16x16x32_bf16 v[188:191], a[156:159], v[20:23], v[188:191]
    ds_read_b64_tr_b16 a[182:183], v233 offset:23168
    v_mfma_f32_16x16x32_bf16 v[192:195], a[160:163], v[16:19], v[192:195]
    ds_read_b64_tr_b16 a[184:185], v233 offset:22944
    v_mfma_f32_16x16x32_bf16 v[196:199], a[160:163], v[20:23], v[196:199]
    ds_read_b64_tr_b16 a[186:187], v233 offset:23200
    s_waitcnt lgkmcnt(6)
    v_mfma_f32_16x16x32_bf16 v[128:131], a[164:167], v[24:27], v[128:131]
    ds_read_b64_tr_b16 a[188:189], v233 offset:22976
    s_barrier
    v_mfma_f32_16x16x32_bf16 v[132:135], a[164:167], v[28:31], v[132:135]
    ds_read_b64_tr_b16 a[190:191], v233 offset:23232
    v_mfma_f32_16x16x32_bf16 v[136:139], a[168:171], v[24:27], v[136:139]
    ds_read_b64_tr_b16 a[192:193], v233 offset:23008
    s_add_u32 s75, s6, 115968
    v_mfma_f32_16x16x32_bf16 v[140:143], a[168:171], v[28:31], v[140:143]
    ds_read_b64_tr_b16 a[194:195], v233 offset:23264
    s_add_u32 m0, s75, 0
    v_mfma_f32_16x16x32_bf16 v[144:147], a[172:175], v[24:27], v[144:147]
    ds_read_b64_tr_b16 a[196:197], v235 offset:22784
    s_add_u32 s40, s48, 110592
    v_mfma_f32_16x16x32_bf16 v[148:151], a[172:175], v[28:31], v[148:151]
    ds_read_b64_tr_b16 a[198:199], v235 offset:23040
    s_waitcnt lgkmcnt(6)
    v_mfma_f32_16x16x32_bf16 v[152:155], a[176:179], v[24:27], v[152:155]
    ds_read_b64_tr_b16 a[128:129], v252
    buffer_load_dwordx4 v247, s[52:55], s40 offen lds
    v_mfma_f32_16x16x32_bf16 v[156:159], a[176:179], v[28:31], v[156:159]
    ds_read_b64_tr_b16 a[130:131], v252 offset:256
    s_add_u32 s42, s7, 10240
    v_mfma_f32_16x16x32_bf16 v[160:163], a[180:183], v[24:27], v[160:163]
    ds_read_b64_tr_b16 a[132:133], v252 offset:32
    buffer_load_dwordx4 v[216:219], v255, s[24:27], s42 offen sc1
    v_mfma_f32_16x16x32_bf16 v[164:167], a[180:183], v[28:31], v[164:167]
    ds_read_b64_tr_b16 a[134:135], v252 offset:288
    s_add_u32 s43, s7, 157696
    v_mfma_f32_16x16x32_bf16 v[168:171], a[184:187], v[24:27], v[168:171]
    ds_read_b64_tr_b16 a[136:137], v252 offset:64
    buffer_load_dwordx4 v[220:223], v255, s[24:27], s43 offen sc1
    v_mfma_f32_16x16x32_bf16 v[172:175], a[184:187], v[28:31], v[172:175]
    ds_read_b64_tr_b16 a[138:139], v252 offset:320
    s_waitcnt lgkmcnt(6)
    v_mfma_f32_16x16x32_bf16 v[176:179], a[188:191], v[24:27], v[176:179]
    ds_read_b64_tr_b16 a[140:141], v252 offset:96
    s_add_u32 m0, s75, 1056
    v_mfma_f32_16x16x32_bf16 v[180:183], a[188:191], v[28:31], v[180:183]
    ds_read_b64_tr_b16 a[142:143], v252 offset:352
    s_add_u32 s41, s48, 111744
    v_mfma_f32_16x16x32_bf16 v[184:187], a[192:195], v[24:27], v[184:187]
    ds_read_b64_tr_b16 a[144:145], v252 offset:128
    buffer_load_dwordx4 v247, s[52:55], s41 offen lds
    v_mfma_f32_16x16x32_bf16 v[188:191], a[192:195], v[28:31], v[188:191]
    ds_read_b64_tr_b16 a[146:147], v252 offset:384
    s_add_u32 m0, s75, 2112
    v_mfma_f32_16x16x32_bf16 v[192:195], a[196:199], v[24:27], v[192:195]
    ds_read_b64_tr_b16 a[148:149], v252 offset:160
    s_add_u32 s40, s48, 112896
    v_mfma_f32_16x16x32_bf16 v[196:199], a[196:199], v[28:31], v[196:199]
    ds_read_b64_tr_b16 a[150:151], v252 offset:416
    s_waitcnt lgkmcnt(6)
    v_mfma_f32_16x16x32_bf16 v[128:131], a[128:131], v[32:35], v[128:131]
    ds_read_b64_tr_b16 a[152:153], v252 offset:192
    buffer_load_dwordx4 v247, s[52:55], s40 offen lds
    v_mfma_f32_16x16x32_bf16 v[132:135], a[128:131], v[36:39], v[132:135]
    ds_read_b64_tr_b16 a[154:155], v252 offset:448
    s_add_u32 m0, s75, 3168
    v_mfma_f32_16x16x32_bf16 v[136:139], a[132:135], v[32:35], v[136:139]
    ds_read_b64_tr_b16 a[156:157], v252 offset:224
    s_add_u32 s41, s48, 114048
    v_mfma_f32_16x16x32_bf16 v[140:143], a[132:135], v[36:39], v[140:143]
    ds_read_b64_tr_b16 a[158:159], v252 offset:480
    buffer_load_dwordx4 v247, s[52:55], s41 offen lds
    v_mfma_f32_16x16x32_bf16 v[144:147], a[136:139], v[32:35], v[144:147]
    ds_read_b64_tr_b16 a[160:161], v253
    s_add_u32 s42, s7, 14336
    v_mfma_f32_16x16x32_bf16 v[148:151], a[136:139], v[36:39], v[148:151]
    ds_read_b64_tr_b16 a[162:163], v253 offset:256
    s_waitcnt lgkmcnt(6)
    v_mfma_f32_16x16x32_bf16 v[152:155], a[140:143], v[32:35], v[152:155]
    ds_read_b64_tr_b16 a[164:165], v252 offset:9472
    buffer_load_dwordx4 v[224:227], v255, s[24:27], s42 offen sc1
    v_mfma_f32_16x16x32_bf16 v[156:159], a[140:143], v[36:39], v[156:159]
    ds_read_b64_tr_b16 a[166:167], v252 offset:9728
    s_add_u32 m0, s75, 4224
    v_mfma_f32_16x16x32_bf16 v[160:163], a[144:147], v[32:35], v[160:163]
    ds_read_b64_tr_b16 a[168:169], v252 offset:9504
    s_add_u32 s40, s48, 115200
    v_mfma_f32_16x16x32_bf16 v[164:167], a[144:147], v[36:39], v[164:167]
    ds_read_b64_tr_b16 a[170:171], v252 offset:9760
    buffer_load_dwordx4 v247, s[52:55], s40 offen lds
    v_mfma_f32_16x16x32_bf16 v[168:171], a[148:151], v[32:35], v[168:171]
    ds_read_b64_tr_b16 a[172:173], v252 offset:9536
    s_add_u32 s43, s7, 161792
    v_mfma_f32_16x16x32_bf16 v[172:175], a[148:151], v[36:39], v[172:175]
    ds_read_b64_tr_b16 a[174:175], v252 offset:9792
    s_waitcnt lgkmcnt(6)
    v_mfma_f32_16x16x32_bf16 v[176:179], a[152:155], v[32:35], v[176:179]
    ds_read_b64_tr_b16 a[176:177], v252 offset:9568
    buffer_load_dwordx4 v[228:231], v255, s[24:27], s43 offen sc1
    v_mfma_f32_16x16x32_bf16 v[180:183], a[152:155], v[36:39], v[180:183]
    ds_read_b64_tr_b16 a[178:179], v252 offset:9824
    s_add_u32 m0, s75, 5280
    v_mfma_f32_16x16x32_bf16 v[184:187], a[156:159], v[32:35], v[184:187]
    ds_read_b64_tr_b16 a[180:181], v252 offset:9600
    s_add_u32 s41, s48, 116352
    v_mfma_f32_16x16x32_bf16 v[188:191], a[156:159], v[36:39], v[188:191]
    ds_read_b64_tr_b16 a[182:183], v252 offset:9856
    buffer_load_dwordx4 v247, s[52:55], s41 offen lds
    v_mfma_f32_16x16x32_bf16 v[192:195], a[160:163], v[32:35], v[192:195]
    ds_read_b64_tr_b16 a[184:185], v252 offset:9632
    s_add_u32 m0, s75, 6336
    v_mfma_f32_16x16x32_bf16 v[196:199], a[160:163], v[36:39], v[196:199]
    ds_read_b64_tr_b16 a[186:187], v252 offset:9888
    s_waitcnt lgkmcnt(6)
    v_mfma_f32_16x16x32_bf16 v[128:131], a[164:167], v[40:43], v[128:131]
    ds_read_b64_tr_b16 a[188:189], v252 offset:9664
    s_add_u32 s40, s48, 117504
    v_mfma_f32_16x16x32_bf16 v[132:135], a[164:167], v[44:47], v[132:135]
    ds_read_b64_tr_b16 a[190:191], v252 offset:9920
    buffer_load_dwordx4 v247, s[52:55], s40 offen lds
    v_mfma_f32_16x16x32_bf16 v[136:139], a[168:171], v[40:43], v[136:139]
    ds_read_b64_tr_b16 a[192:193], v252 offset:9696
    s_add_u32 m0, s75, 7392
    v_mfma_f32_16x16x32_bf16 v[140:143], a[168:171], v[44:47], v[140:143]
    ds_read_b64_tr_b16 a[194:195], v252 offset:9952
    s_add_u32 s41, s48, 118656
    v_mfma_f32_16x16x32_bf16 v[144:147], a[172:175], v[40:43], v[144:147]
    ds_read_b64_tr_b16 a[196:197], v253 offset:9472
    buffer_load_dwordx4 v247, s[52:55], s41 offen lds
    v_mfma_f32_16x16x32_bf16 v[148:151], a[172:175], v[44:47], v[148:151]
    ds_read_b64_tr_b16 a[198:199], v253 offset:9728
    s_waitcnt lgkmcnt(6)
    v_mfma_f32_16x16x32_bf16 v[152:155], a[176:179], v[40:43], v[152:155]
    ds_read_b64_tr_b16 a[128:129], v252 offset:18944
    s_add_u32 s42, s7, 18432
    v_mfma_f32_16x16x32_bf16 v[156:159], a[176:179], v[44:47], v[156:159]
    ds_read_b64_tr_b16 a[130:131], v252 offset:19200
    buffer_load_dwordx4 v[0:3], v255, s[24:27], s42 offen sc1
    v_mfma_f32_16x16x32_bf16 v[160:163], a[180:183], v[40:43], v[160:163]
    ds_read_b64_tr_b16 a[132:133], v252 offset:18976
    s_add_u32 m0, s75, 8448
    v_mfma_f32_16x16x32_bf16 v[164:167], a[180:183], v[44:47], v[164:167]
    ds_read_b64_tr_b16 a[134:135], v252 offset:19232
    s_add_u32 s40, s50, 3072
    v_mfma_f32_16x16x32_bf16 v[168:171], a[184:187], v[40:43], v[168:171]
    ds_read_b64_tr_b16 a[136:137], v252 offset:19008
    buffer_load_dwordx4 v255, s[56:59], s40 offen sc1 lds
    v_mfma_f32_16x16x32_bf16 v[172:175], a[184:187], v[44:47], v[172:175]
    ds_read_b64_tr_b16 a[138:139], v252 offset:19264
    s_waitcnt lgkmcnt(6)
    v_mfma_f32_16x16x32_bf16 v[176:179], a[188:191], v[40:43], v[176:179]
    ds_read_b64_tr_b16 a[140:141], v252 offset:19040
    s_add_u32 s43, s7, 165888
    v_mfma_f32_16x16x32_bf16 v[180:183], a[188:191], v[44:47], v[180:183]
    ds_read_b64_tr_b16 a[142:143], v252 offset:19296
    buffer_load_dwordx4 v[4:7], v255, s[24:27], s43 offen sc1
    v_mfma_f32_16x16x32_bf16 v[184:187], a[192:195], v[40:43], v[184:187]
    ds_read_b64_tr_b16 a[144:145], v252 offset:19072
    v_mfma_f32_16x16x32_bf16 v[188:191], a[192:195], v[44:47], v[188:191]
    ds_read_b64_tr_b16 a[146:147], v252 offset:19328
    v_mfma_f32_16x16x32_bf16 v[192:195], a[196:199], v[40:43], v[192:195]
    ds_read_b64_tr_b16 a[148:149], v252 offset:19104
    v_mfma_f32_16x16x32_bf16 v[196:199], a[196:199], v[44:47], v[196:199]
    ds_read_b64_tr_b16 a[150:151], v252 offset:19360
    s_waitcnt lgkmcnt(6)
    v_mfma_f32_16x16x32_bf16 v[128:131], a[128:131], v[48:51], v[128:131]
    ds_read_b64_tr_b16 a[152:153], v252 offset:19136
    v_mfma_f32_16x16x32_bf16 v[132:135], a[128:131], v[52:55], v[132:135]
    ds_read_b64_tr_b16 a[154:155], v252 offset:19392
    v_mfma_f32_16x16x32_bf16 v[136:139], a[132:135], v[48:51], v[136:139]
    ds_read_b64_tr_b16 a[156:157], v252 offset:19168
    v_mfma_f32_16x16x32_bf16 v[140:143], a[132:135], v[52:55], v[140:143]
    ds_read_b64_tr_b16 a[158:159], v252 offset:19424
    s_add_u32 s42, s7, 22528
    v_mfma_f32_16x16x32_bf16 v[144:147], a[136:139], v[48:51], v[144:147]
    ds_read_b64_tr_b16 a[160:161], v253 offset:18944
    buffer_load_dwordx4 v[8:11], v255, s[24:27], s42 offen sc1
    v_mfma_f32_16x16x32_bf16 v[148:151], a[136:139], v[52:55], v[148:151]
    ds_read_b64_tr_b16 a[162:163], v253 offset:19200
    s_waitcnt lgkmcnt(6)
    v_mfma_f32_16x16x32_bf16 v[152:155], a[140:143], v[48:51], v[152:155]
    ds_read_b64_tr_b16 a[164:165], v252 offset:28416
    v_mfma_f32_16x16x32_bf16 v[156:159], a[140:143], v[52:55], v[156:159]
    ds_read_b64_tr_b16 a[166:167], v252 offset:28672
    s_add_u32 s43, s7, 169984
    v_mfma_f32_16x16x32_bf16 v[160:163], a[144:147], v[48:51], v[160:163]
    ds_read_b64_tr_b16 a[168:169], v252 offset:28448
    buffer_load_dwordx4 v[12:15], v255, s[24:27], s43 offen sc1
    v_mfma_f32_16x16x32_bf16 v[164:167], a[144:147], v[52:55], v[164:167]
    ds_read_b64_tr_b16 a[170:171], v252 offset:28704
    v_mfma_f32_16x16x32_bf16 v[168:171], a[148:151], v[48:51], v[168:171]
    ds_read_b64_tr_b16 a[172:173], v252 offset:28480
    v_mfma_f32_16x16x32_bf16 v[172:175], a[148:151], v[52:55], v[172:175]
    ds_read_b64_tr_b16 a[174:175], v252 offset:28736
    s_waitcnt lgkmcnt(6)
    v_mfma_f32_16x16x32_bf16 v[176:179], a[152:155], v[48:51], v[176:179]
    ds_read_b64_tr_b16 a[176:177], v252 offset:28512
    v_mfma_f32_16x16x32_bf16 v[180:183], a[152:155], v[52:55], v[180:183]
    ds_read_b64_tr_b16 a[178:179], v252 offset:28768
    v_mfma_f32_16x16x32_bf16 v[184:187], a[156:159], v[48:51], v[184:187]
    ds_read_b64_tr_b16 a[180:181], v252 offset:28544
    v_mfma_f32_16x16x32_bf16 v[188:191], a[156:159], v[52:55], v[188:191]
    ds_read_b64_tr_b16 a[182:183], v252 offset:28800
    v_mfma_f32_16x16x32_bf16 v[192:195], a[160:163], v[48:51], v[192:195]
    ds_read_b64_tr_b16 a[184:185], v252 offset:28576
    v_mfma_f32_16x16x32_bf16 v[196:199], a[160:163], v[52:55], v[196:199]
    ds_read_b64_tr_b16 a[186:187], v252 offset:28832
    s_waitcnt lgkmcnt(6)
    s_waitcnt vmcnt(28)
    v_mfma_f32_16x16x32_bf16 v[128:131], a[164:167], v[56:59], v[128:131]
    ds_read_b64_tr_b16 a[188:189], v252 offset:28608
    s_barrier
    s_waitcnt vmcnt(26)
    v_mfma_f32_16x16x32_bf16 v[132:135], a[164:167], v[60:63], v[132:135]
    ds_read_b64_tr_b16 a[190:191], v252 offset:28864
    v_mfma_f32_16x16x32_bf16 v[136:139], a[168:171], v[56:59], v[136:139]
    ds_read_b64_tr_b16 a[192:193], v252 offset:28640
    s_mov_b32 s75, s73
    v_mfma_f32_16x16x32_bf16 v[140:143], a[168:171], v[60:63], v[140:143]
    ds_read_b64_tr_b16 a[194:195], v252 offset:28896
    s_add_u32 m0, s75, 0
    v_mfma_f32_16x16x32_bf16 v[144:147], a[172:175], v[56:59], v[144:147]
    ds_read_b64_tr_b16 a[196:197], v253 offset:28416
    s_add_u32 s40, s48, 700416
    v_mfma_f32_16x16x32_bf16 v[148:151], a[172:175], v[60:63], v[148:151]
    ds_read_b64_tr_b16 a[198:199], v253 offset:28672
    s_waitcnt lgkmcnt(6)
    v_mfma_f32_16x16x32_bf16 v[152:155], a[176:179], v[56:59], v[152:155]
    ds_read_b64_tr_b16 a[128:129], v252 offset:37888
    buffer_load_dwordx4 v247, s[52:55], s40 offen lds
    v_mfma_f32_16x16x32_bf16 v[156:159], a[176:179], v[60:63], v[156:159]
    ds_read_b64_tr_b16 a[130:131], v252 offset:38144
    s_add_u32 s42, s7, 26624
    v_mfma_f32_16x16x32_bf16 v[160:163], a[180:183], v[56:59], v[160:163]
    ds_read_b64_tr_b16 a[132:133], v252 offset:37920
    buffer_load_dwordx4 v[16:19], v255, s[24:27], s42 offen sc1
    v_mfma_f32_16x16x32_bf16 v[164:167], a[180:183], v[60:63], v[164:167]
    ds_read_b64_tr_b16 a[134:135], v252 offset:38176
    s_add_u32 s43, s7, 174080
    v_mfma_f32_16x16x32_bf16 v[168:171], a[184:187], v[56:59], v[168:171]
    ds_read_b64_tr_b16 a[136:137], v252 offset:37952
    buffer_load_dwordx4 v[20:23], v255, s[24:27], s43 offen sc1
    v_mfma_f32_16x16x32_bf16 v[172:175], a[184:187], v[60:63], v[172:175]
    ds_read_b64_tr_b16 a[138:139], v252 offset:38208
    s_waitcnt lgkmcnt(6)
    v_mfma_f32_16x16x32_bf16 v[176:179], a[188:191], v[56:59], v[176:179]
    ds_read_b64_tr_b16 a[140:141], v252 offset:37984
    s_add_u32 m0, s75, 1056
    v_mfma_f32_16x16x32_bf16 v[180:183], a[188:191], v[60:63], v[180:183]
    ds_read_b64_tr_b16 a[142:143], v252 offset:38240
    s_add_u32 s41, s48, 701568
    v_mfma_f32_16x16x32_bf16 v[184:187], a[192:195], v[56:59], v[184:187]
    ds_read_b64_tr_b16 a[144:145], v252 offset:38016
    buffer_load_dwordx4 v247, s[52:55], s41 offen lds
    v_mfma_f32_16x16x32_bf16 v[188:191], a[192:195], v[60:63], v[188:191]
    ds_read_b64_tr_b16 a[146:147], v252 offset:38272
    s_add_u32 m0, s75, 2112
    v_mfma_f32_16x16x32_bf16 v[192:195], a[196:199], v[56:59], v[192:195]
    ds_read_b64_tr_b16 a[148:149], v252 offset:38048
    s_add_u32 s40, s48, 702720
    v_mfma_f32_16x16x32_bf16 v[196:199], a[196:199], v[60:63], v[196:199]
    ds_read_b64_tr_b16 a[150:151], v252 offset:38304
    s_waitcnt lgkmcnt(6)
    s_waitcnt vmcnt(26)
    v_mfma_f32_16x16x32_bf16 v[128:131], a[128:131], v[200:203], v[128:131]
    ds_read_b64_tr_b16 a[152:153], v252 offset:38080
    buffer_load_dwordx4 v247, s[52:55], s40 offen lds
    s_waitcnt vmcnt(25)
    v_mfma_f32_16x16x32_bf16 v[132:135], a[128:131], v[204:207], v[132:135]
    ds_read_b64_tr_b16 a[154:155], v252 offset:38336
    s_add_u32 m0, s75, 3168
    v_mfma_f32_16x16x32_bf16 v[136:139], a[132:135], v[200:203], v[136:139]
    ds_read_b64_tr_b16 a[156:157], v252 offset:38112
    s_add_u32 s41, s48, 703872
    v_mfma_f32_16x16x32_bf16 v[140:143], a[132:135], v[204:207], v[140:143]
    ds_read_b64_tr_b16 a[158:159], v252 offset:38368
    buffer_load_dwordx4 v247, s[52:55], s41 offen lds
    v_mfma_f32_16x16x32_bf16 v[144:147], a[136:139], v[200:203], v[144:147]
    ds_read_b64_tr_b16 a[160:161], v253 offset:37888
    s_add_u32 s42, s7, 30720
    v_mfma_f32_16x16x32_bf16 v[148:151], a[136:139], v[204:207], v[148:151]
    ds_read_b64_tr_b16 a[162:163], v253 offset:38144
    s_waitcnt lgkmcnt(6)
    v_mfma_f32_16x16x32_bf16 v[152:155], a[140:143], v[200:203], v[152:155]
    ds_read_b64_tr_b16 a[164:165], v252 offset:49664
    buffer_load_dwordx4 v[24:27], v255, s[24:27], s42 offen sc1
    v_mfma_f32_16x16x32_bf16 v[156:159], a[140:143], v[204:207], v[156:159]
    ds_read_b64_tr_b16 a[166:167], v252 offset:49920
    s_add_u32 m0, s75, 4224
    v_mfma_f32_16x16x32_bf16 v[160:163], a[144:147], v[200:203], v[160:163]
    ds_read_b64_tr_b16 a[168:169], v252 offset:49696
    s_add_u32 s40, s48, 705024
    v_mfma_f32_16x16x32_bf16 v[164:167], a[144:147], v[204:207], v[164:167]
    ds_read_b64_tr_b16 a[170:171], v252 offset:49952
    buffer_load_dwordx4 v247, s[52:55], s40 offen lds
    v_mfma_f32_16x16x32_bf16 v[168:171], a[148:151], v[200:203], v[168:171]
    ds_read_b64_tr_b16 a[172:173], v252 offset:49728
    s_add_u32 s43, s7, 178176
    v_mfma_f32_16x16x32_bf16 v[172:175], a[148:151], v[204:207], v[172:175]
    ds_read_b64_tr_b16 a[174:175], v252 offset:49984
    s_waitcnt lgkmcnt(6)
    v_mfma_f32_16x16x32_bf16 v[176:179], a[152:155], v[200:203], v[176:179]
    ds_read_b64_tr_b16 a[176:177], v252 offset:49760
    buffer_load_dwordx4 v[28:31], v255, s[24:27], s43 offen sc1
    v_mfma_f32_16x16x32_bf16 v[180:183], a[152:155], v[204:207], v[180:183]
    ds_read_b64_tr_b16 a[178:179], v252 offset:50016
    s_add_u32 m0, s75, 5280
    v_mfma_f32_16x16x32_bf16 v[184:187], a[156:159], v[200:203], v[184:187]
    ds_read_b64_tr_b16 a[180:181], v252 offset:49792
    s_add_u32 s41, s48, 706176
    v_mfma_f32_16x16x32_bf16 v[188:191], a[156:159], v[204:207], v[188:191]
    ds_read_b64_tr_b16 a[182:183], v252 offset:50048
    buffer_load_dwordx4 v247, s[52:55], s41 offen lds
    v_mfma_f32_16x16x32_bf16 v[192:195], a[160:163], v[200:203], v[192:195]
    ds_read_b64_tr_b16 a[184:185], v252 offset:49824
    s_add_u32 m0, s75, 6336
    v_mfma_f32_16x16x32_bf16 v[196:199], a[160:163], v[204:207], v[196:199]
    ds_read_b64_tr_b16 a[186:187], v252 offset:50080
    s_waitcnt lgkmcnt(6)
    s_waitcnt vmcnt(29)
    v_mfma_f32_16x16x32_bf16 v[128:131], a[164:167], v[208:211], v[128:131]
    ds_read_b64_tr_b16 a[188:189], v252 offset:49856
    s_add_u32 s40, s48, 707328
    s_waitcnt vmcnt(28)
    v_mfma_f32_16x16x32_bf16 v[132:135], a[164:167], v[212:215], v[132:135]
    ds_read_b64_tr_b16 a[190:191], v252 offset:50112
    buffer_load_dwordx4 v247, s[52:55], s40 offen lds
    v_mfma_f32_16x16x32_bf16 v[136:139], a[168:171], v[208:211], v[136:139]
    ds_read_b64_tr_b16 a[192:193], v252 offset:49888
    s_add_u32 m0, s75, 7392
    v_mfma_f32_16x16x32_bf16 v[140:143], a[168:171], v[212:215], v[140:143]
    ds_read_b64_tr_b16 a[194:195], v252 offset:50144
    s_add_u32 s41, s48, 708480
    v_mfma_f32_16x16x32_bf16 v[144:147], a[172:175], v[208:211], v[144:147]
    ds_read_b64_tr_b16 a[196:197], v253 offset:49664
    buffer_load_dwordx4 v247, s[52:55], s41 offen lds
    v_mfma_f32_16x16x32_bf16 v[148:151], a[172:175], v[212:215], v[148:151]
    ds_read_b64_tr_b16 a[198:199], v253 offset:49920
    s_waitcnt lgkmcnt(6)
    v_mfma_f32_16x16x32_bf16 v[152:155], a[176:179], v[208:211], v[152:155]
    ds_read_b64_tr_b16 a[128:129], v252 offset:59136
    s_add_u32 m0, s75, 8448
    v_mfma_f32_16x16x32_bf16 v[156:159], a[176:179], v[212:215], v[156:159]
    ds_read_b64_tr_b16 a[130:131], v252 offset:59392
    s_add_u32 s40, s50, 19456
    v_mfma_f32_16x16x32_bf16 v[160:163], a[180:183], v[208:211], v[160:163]
    ds_read_b64_tr_b16 a[132:133], v252 offset:59168
    buffer_load_dwordx4 v255, s[56:59], s40 offen sc1 lds
    v_mfma_f32_16x16x32_bf16 v[164:167], a[180:183], v[212:215], v[164:167]
    ds_read_b64_tr_b16 a[134:135], v252 offset:59424
    s_add_u32 s46, s77, 64
    v_mfma_f32_16x16x32_bf16 v[168:171], a[184:187], v[208:211], v[168:171]
    ds_read_b64_tr_b16 a[136:137], v252 offset:59200
    buffer_load_dword v236, v250, s[56:59], s46 offen sc1
    v_mfma_f32_16x16x32_bf16 v[172:175], a[184:187], v[212:215], v[172:175]
    ds_read_b64_tr_b16 a[138:139], v252 offset:59456
    s_waitcnt lgkmcnt(6)
    v_mfma_f32_16x16x32_bf16 v[176:179], a[188:191], v[208:211], v[176:179]
    ds_read_b64_tr_b16 a[140:141], v252 offset:59232
    v_mfma_f32_16x16x32_bf16 v[180:183], a[188:191], v[212:215], v[180:183]
    ds_read_b64_tr_b16 a[142:143], v252 offset:59488
    v_mfma_f32_16x16x32_bf16 v[184:187], a[192:195], v[208:211], v[184:187]
    ds_read_b64_tr_b16 a[144:145], v252 offset:59264
    v_mfma_f32_16x16x32_bf16 v[188:191], a[192:195], v[212:215], v[188:191]
    ds_read_b64_tr_b16 a[146:147], v252 offset:59520
    v_mfma_f32_16x16x32_bf16 v[192:195], a[196:199], v[208:211], v[192:195]
    ds_read_b64_tr_b16 a[148:149], v252 offset:59296
    v_mfma_f32_16x16x32_bf16 v[196:199], a[196:199], v[212:215], v[196:199]
    ds_read_b64_tr_b16 a[150:151], v252 offset:59552
    s_waitcnt lgkmcnt(6)
    s_waitcnt vmcnt(29)
    v_mfma_f32_16x16x32_bf16 v[128:131], a[128:131], v[216:219], v[128:131]
    ds_read_b64_tr_b16 a[152:153], v252 offset:59328
    s_waitcnt vmcnt(28)
    v_mfma_f32_16x16x32_bf16 v[132:135], a[128:131], v[220:223], v[132:135]
    ds_read_b64_tr_b16 a[154:155], v252 offset:59584
    v_mfma_f32_16x16x32_bf16 v[136:139], a[132:135], v[216:219], v[136:139]
    ds_read_b64_tr_b16 a[156:157], v252 offset:59360
    v_mfma_f32_16x16x32_bf16 v[140:143], a[132:135], v[220:223], v[140:143]
    ds_read_b64_tr_b16 a[158:159], v252 offset:59616
    v_mfma_f32_16x16x32_bf16 v[144:147], a[136:139], v[216:219], v[144:147]
    ds_read_b64_tr_b16 a[160:161], v253 offset:59136
    v_mfma_f32_16x16x32_bf16 v[148:151], a[136:139], v[220:223], v[148:151]
    ds_read_b64_tr_b16 a[162:163], v253 offset:59392
    s_waitcnt lgkmcnt(6)
    v_mfma_f32_16x16x32_bf16 v[152:155], a[140:143], v[216:219], v[152:155]
    ds_read_b64_tr_b16 a[164:165], v232 offset:3072
    v_mfma_f32_16x16x32_bf16 v[156:159], a[140:143], v[220:223], v[156:159]
    ds_read_b64_tr_b16 a[166:167], v232 offset:3328
    v_mfma_f32_16x16x32_bf16 v[160:163], a[144:147], v[216:219], v[160:163]
    ds_read_b64_tr_b16 a[168:169], v232 offset:3104
    v_mfma_f32_16x16x32_bf16 v[164:167], a[144:147], v[220:223], v[164:167]
    ds_read_b64_tr_b16 a[170:171], v232 offset:3360
    v_mfma_f32_16x16x32_bf16 v[168:171], a[148:151], v[216:219], v[168:171]
    ds_read_b64_tr_b16 a[172:173], v232 offset:3136
    v_mfma_f32_16x16x32_bf16 v[172:175], a[148:151], v[220:223], v[172:175]
    ds_read_b64_tr_b16 a[174:175], v232 offset:3392
    s_waitcnt lgkmcnt(6)
    v_mfma_f32_16x16x32_bf16 v[176:179], a[152:155], v[216:219], v[176:179]
    ds_read_b64_tr_b16 a[176:177], v232 offset:3168
    v_mfma_f32_16x16x32_bf16 v[180:183], a[152:155], v[220:223], v[180:183]
    ds_read_b64_tr_b16 a[178:179], v232 offset:3424
    v_mfma_f32_16x16x32_bf16 v[184:187], a[156:159], v[216:219], v[184:187]
    ds_read_b64_tr_b16 a[180:181], v232 offset:3200
    v_mfma_f32_16x16x32_bf16 v[188:191], a[156:159], v[220:223], v[188:191]
    ds_read_b64_tr_b16 a[182:183], v232 offset:3456
    v_mfma_f32_16x16x32_bf16 v[192:195], a[160:163], v[216:219], v[192:195]
    ds_read_b64_tr_b16 a[184:185], v232 offset:3232
    v_mfma_f32_16x16x32_bf16 v[196:199], a[160:163], v[220:223], v[196:199]
    ds_read_b64_tr_b16 a[186:187], v232 offset:3488
    s_waitcnt lgkmcnt(6)
    s_waitcnt vmcnt(24)
    v_mfma_f32_16x16x32_bf16 v[128:131], a[164:167], v[224:227], v[128:131]
    ds_read_b64_tr_b16 a[188:189], v232 offset:3264
    s_barrier
    s_waitcnt vmcnt(22)
    v_mfma_f32_16x16x32_bf16 v[132:135], a[164:167], v[228:231], v[132:135]
    ds_read_b64_tr_b16 a[190:191], v232 offset:3520
    v_mfma_f32_16x16x32_bf16 v[136:139], a[168:171], v[224:227], v[136:139]
    ds_read_b64_tr_b16 a[192:193], v232 offset:3296
    s_mov_b32 s75, s74
    v_mfma_f32_16x16x32_bf16 v[140:143], a[168:171], v[228:231], v[140:143]
    ds_read_b64_tr_b16 a[194:195], v232 offset:3552
    s_add_u32 m0, s75, 0
    v_mfma_f32_16x16x32_bf16 v[144:147], a[172:175], v[224:227], v[144:147]
    ds_read_b64_tr_b16 a[196:197], v234 offset:3072
    s_add_u32 s40, s49, 1179648
    v_mfma_f32_16x16x32_bf16 v[148:151], a[172:175], v[228:231], v[148:151]
    ds_read_b64_tr_b16 a[198:199], v234 offset:3328
    s_waitcnt lgkmcnt(6)
    v_mfma_f32_16x16x32_bf16 v[152:155], a[176:179], v[224:227], v[152:155]
    ds_read_b64_tr_b16 a[128:129], v232 offset:12544
    buffer_load_dwordx4 v247, s[52:55], s40 offen lds
    v_mfma_f32_16x16x32_bf16 v[156:159], a[176:179], v[228:231], v[156:159]
    ds_read_b64_tr_b16 a[130:131], v232 offset:12800
    s_add_u32 m0, s75, 1056
    v_mfma_f32_16x16x32_bf16 v[160:163], a[180:183], v[224:227], v[160:163]
    ds_read_b64_tr_b16 a[132:133], v232 offset:12576
    s_add_u32 s41, s49, 1180800
    v_mfma_f32_16x16x32_bf16 v[164:167], a[180:183], v[228:231], v[164:167]
    ds_read_b64_tr_b16 a[134:135], v232 offset:12832
    buffer_load_dwordx4 v247, s[52:55], s41 offen lds
    v_mfma_f32_16x16x32_bf16 v[168:171], a[184:187], v[224:227], v[168:171]
    ds_read_b64_tr_b16 a[136:137], v232 offset:12608
    v_mfma_f32_16x16x32_bf16 v[172:175], a[184:187], v[228:231], v[172:175]
    ds_read_b64_tr_b16 a[138:139], v232 offset:12864
    s_waitcnt lgkmcnt(6)
    v_mfma_f32_16x16x32_bf16 v[176:179], a[188:191], v[224:227], v[176:179]
    ds_read_b64_tr_b16 a[140:141], v232 offset:12640
    s_add_u32 m0, s75, 2112
    v_mfma_f32_16x16x32_bf16 v[180:183], a[188:191], v[228:231], v[180:183]
    ds_read_b64_tr_b16 a[142:143], v232 offset:12896
    s_add_u32 s40, s49, 1181952
    v_mfma_f32_16x16x32_bf16 v[184:187], a[192:195], v[224:227], v[184:187]
    ds_read_b64_tr_b16 a[144:145], v232 offset:12672
    buffer_load_dwordx4 v247, s[52:55], s40 offen lds
    v_mfma_f32_16x16x32_bf16 v[188:191], a[192:195], v[228:231], v[188:191]
    ds_read_b64_tr_b16 a[146:147], v232 offset:12928
    v_mfma_f32_16x16x32_bf16 v[192:195], a[196:199], v[224:227], v[192:195]
    ds_read_b64_tr_b16 a[148:149], v232 offset:12704
    v_mfma_f32_16x16x32_bf16 v[196:199], a[196:199], v[228:231], v[196:199]
    ds_read_b64_tr_b16 a[150:151], v232 offset:12960
    s_waitcnt lgkmcnt(6)
    s_waitcnt vmcnt(21)
    v_mfma_f32_16x16x32_bf16 v[128:131], a[128:131], v[0:3], v[128:131]
    ds_read_b64_tr_b16 a[152:153], v232 offset:12736
    s_add_u32 m0, s75, 3168
    s_cmp_eq_u32 s3, 0
    s_cselect_b32 s85, 2146435072, 0
    s_waitcnt vmcnt(19)
    v_mfma_f32_16x16x32_bf16 v[132:135], a[128:131], v[4:7], v[132:135]
    ds_read_b64_tr_b16 a[154:155], v232 offset:12992
    s_waitcnt vmcnt(3)
    v_cmp_ne_u32 vcc, v236, v249
    s_cbranch_vccz L_ok5
s_branch L_spin5
L_ok5:
    v_mfma_f32_16x16x32_bf16 v[136:139], a[132:135], v[0:3], v[136:139]
    ds_read_b64_tr_b16 a[156:157], v232 offset:12768
    s_add_u32 s41, s49, 1183104
    s_cmp_eq_u32 s3, 1
    s_cselect_b32 s86, 2146435072, 0
    v_mfma_f32_16x16x32_bf16 v[140:143], a[132:135], v[4:7], v[140:143]
    ds_read_b64_tr_b16 a[158:159], v232 offset:13024
    buffer_load_dwordx4 v247, s[52:55], s41 offen lds
    s_cmp_eq_u32 s3, 2
    s_cselect_b32 s87, 2146435072, 0
    v_mfma_f32_16x16x32_bf16 v[144:147], a[136:139], v[0:3], v[144:147]
    ds_read_b64_tr_b16 a[160:161], v234 offset:12544
    s_add_u32 s42, s7, 3072
    s_cmp_eq_u32 s3, 3
    s_cselect_b32 s88, 2146435072, 0
    v_mfma_f32_16x16x32_bf16 v[148:151], a[136:139], v[4:7], v[148:151]
    ds_read_b64_tr_b16 a[162:163], v234 offset:12800
    s_waitcnt lgkmcnt(6)
    v_mfma_f32_16x16x32_bf16 v[152:155], a[140:143], v[0:3], v[152:155]
    ds_read_b64_tr_b16 a[164:165], v232 offset:22016
    buffer_load_dwordx4 v[32:35], v255, s[24:27], s42 offen sc1
    v_mfma_f32_16x16x32_bf16 v[156:159], a[140:143], v[4:7], v[156:159]
    ds_read_b64_tr_b16 a[166:167], v232 offset:22272
    s_add_u32 m0, s75, 4224
    v_mfma_f32_16x16x32_bf16 v[160:163], a[144:147], v[0:3], v[160:163]
    ds_read_b64_tr_b16 a[168:169], v232 offset:22048
    s_add_u32 s40, s49, 1184256
    v_mfma_f32_16x16x32_bf16 v[164:167], a[144:147], v[4:7], v[164:167]
    ds_read_b64_tr_b16 a[170:171], v232 offset:22304
    buffer_load_dwordx4 v247, s[52:55], s40 offen lds
    v_mfma_f32_16x16x32_bf16 v[168:171], a[148:151], v[0:3], v[168:171]
    ds_read_b64_tr_b16 a[172:173], v232 offset:22080
    s_add_u32 s43, s7, 150528
    v_mfma_f32_16x16x32_bf16 v[172:175], a[148:151], v[4:7], v[172:175]
    ds_read_b64_tr_b16 a[174:175], v232 offset:22336
    s_waitcnt lgkmcnt(6)
    v_mfma_f32_16x16x32_bf16 v[176:179], a[152:155], v[0:3], v[176:179]
    ds_read_b64_tr_b16 a[176:177], v232 offset:22112
    buffer_load_dwordx4 v[36:39], v255, s[24:27], s43 offen sc1
    v_mfma_f32_16x16x32_bf16 v[180:183], a[152:155], v[4:7], v[180:183]
    ds_read_b64_tr_b16 a[178:179], v232 offset:22368
    s_add_u32 m0, s75, 5280
    v_mfma_f32_16x16x32_bf16 v[184:187], a[156:159], v[0:3], v[184:187]
    ds_read_b64_tr_b16 a[180:181], v232 offset:22144
    s_add_u32 s41, s49, 1185408
    v_mfma_f32_16x16x32_bf16 v[188:191], a[156:159], v[4:7], v[188:191]
    ds_read_b64_tr_b16 a[182:183], v232 offset:22400
    buffer_load_dwordx4 v247, s[52:55], s41 offen lds
    v_mfma_f32_16x16x32_bf16 v[192:195], a[160:163], v[0:3], v[192:195]
    ds_read_b64_tr_b16 a[184:185], v232 offset:22176
    s_add_u32 s42, s7, 7168
    v_mfma_f32_16x16x32_bf16 v[196:199], a[160:163], v[4:7], v[196:199]
    ds_read_b64_tr_b16 a[186:187], v232 offset:22432
    s_waitcnt lgkmcnt(6)
    v_mfma_f32_16x16x32_bf16 v[128:131], a[164:167], v[8:11], v[128:131]
    ds_read_b64_tr_b16 a[188:189], v232 offset:22208
    buffer_load_dwordx4 v[40:43], v255, s[24:27], s42 offen sc1
    v_mfma_f32_16x16x32_bf16 v[132:135], a[164:167], v[12:15], v[132:135]
    ds_read_b64_tr_b16 a[190:191], v232 offset:22464
    s_add_u32 m0, s75, 6336
    v_mfma_f32_16x16x32_bf16 v[136:139], a[168:171], v[8:11], v[136:139]
    ds_read_b64_tr_b16 a[192:193], v232 offset:22240
    s_add_u32 s40, s49, 1186560
    v_mfma_f32_16x16x32_bf16 v[140:143], a[168:171], v[12:15], v[140:143]
    ds_read_b64_tr_b16 a[194:195], v232 offset:22496
    buffer_load_dwordx4 v247, s[52:55], s40 offen lds
    v_mfma_f32_16x16x32_bf16 v[144:147], a[172:175], v[8:11], v[144:147]
    ds_read_b64_tr_b16 a[196:197], v234 offset:22016
    s_add_u32 s43, s7, 154624
    v_mfma_f32_16x16x32_bf16 v[148:151], a[172:175], v[12:15], v[148:151]
    ds_read_b64_tr_b16 a[198:199], v234 offset:22272
    s_waitcnt lgkmcnt(6)
    v_mfma_f32_16x16x32_bf16 v[152:155], a[176:179], v[8:11], v[152:155]
    ds_read_b64_tr_b16 a[128:129], v232 offset:31488
    buffer_load_dwordx4 v[44:47], v255, s[24:27], s43 offen sc1
    v_mfma_f32_16x16x32_bf16 v[156:159], a[176:179], v[12:15], v[156:159]
    ds_read_b64_tr_b16 a[130:131], v232 offset:31744
    s_add_u32 m0, s75, 7392
    v_mfma_f32_16x16x32_bf16 v[160:163], a[180:183], v[8:11], v[160:163]
    ds_read_b64_tr_b16 a[132:133], v232 offset:31520
    s_add_u32 s41, s49, 1187712
    v_mfma_f32_16x16x32_bf16 v[164:167], a[180:183], v[12:15], v[164:167]
    ds_read_b64_tr_b16 a[134:135], v232 offset:31776
    buffer_load_dwordx4 v247, s[52:55], s41 offen lds
    v_mfma_f32_16x16x32_bf16 v[168:171], a[184:187], v[8:11], v[168:171]
    ds_read_b64_tr_b16 a[136:137], v232 offset:31552
    s_add_u32 s42, s7, 11264
    v_mfma_f32_16x16x32_bf16 v[172:175], a[184:187], v[12:15], v[172:175]
    ds_read_b64_tr_b16 a[138:139], v232 offset:31808
    s_waitcnt lgkmcnt(6)
    v_mfma_f32_16x16x32_bf16 v[176:179], a[188:191], v[8:11], v[176:179]
    ds_read_b64_tr_b16 a[140:141], v232 offset:31584
    buffer_load_dwordx4 v[48:51], v255, s[24:27], s42 offen sc1
    v_mfma_f32_16x16x32_bf16 v[180:183], a[188:191], v[12:15], v[180:183]
    ds_read_b64_tr_b16 a[142:143], v232 offset:31840
    s_add_u32 m0, s75, 8448
    v_mfma_f32_16x16x32_bf16 v[184:187], a[192:195], v[8:11], v[184:187]
    ds_read_b64_tr_b16 a[144:145], v232 offset:31616
    s_add_u32 s40, s51, 32768
    v_mfma_f32_16x16x32_bf16 v[188:191], a[192:195], v[12:15], v[188:191]
    ds_read_b64_tr_b16 a[146:147], v232 offset:31872
    buffer_load_dwordx4 v255, s[56:59], s40 offen sc1 lds
    v_mfma_f32_16x16x32_bf16 v[192:195], a[196:199], v[8:11], v[192:195]
    ds_read_b64_tr_b16 a[148:149], v232 offset:31648
    s_add_u32 s43, s7, 158720
    v_mfma_f32_16x16x32_bf16 v[196:199], a[196:199], v[12:15], v[196:199]
    ds_read_b64_tr_b16 a[150:151], v232 offset:31904
    s_waitcnt lgkmcnt(6)
    v_mfma_f32_16x16x32_bf16 v[128:131], a[128:131], v[16:19], v[128:131]
    ds_read_b64_tr_b16 a[152:153], v232 offset:31680
    buffer_load_dwordx4 v[52:55], v255, s[24:27], s43 offen sc1
    v_mfma_f32_16x16x32_bf16 v[132:135], a[128:131], v[20:23], v[132:135]
    ds_read_b64_tr_b16 a[154:155], v232 offset:31936
    s_add_u32 s42, s7, 15360
    v_mfma_f32_16x16x32_bf16 v[136:139], a[132:135], v[16:19], v[136:139]
    ds_read_b64_tr_b16 a[156:157], v232 offset:31712
    buffer_load_dwordx4 v[56:59], v255, s[24:27], s42 offen sc1
    v_mfma_f32_16x16x32_bf16 v[140:143], a[132:135], v[20:23], v[140:143]
    ds_read_b64_tr_b16 a[158:159], v232 offset:31968
    s_add_u32 s43, s7, 162816
    v_mfma_f32_16x16x32_bf16 v[144:147], a[136:139], v[16:19], v[144:147]
    ds_read_b64_tr_b16 a[160:161], v234 offset:31488
    buffer_load_dwordx4 v[60:63], v255, s[24:27], s43 offen sc1
    v_mfma_f32_16x16x32_bf16 v[148:151], a[136:139], v[20:23], v[148:151]
    ds_read_b64_tr_b16 a[162:163], v234 offset:31744
    s_waitcnt lgkmcnt(6)
    v_mfma_f32_16x16x32_bf16 v[152:155], a[140:143], v[16:19], v[152:155]
    ds_read_b64_tr_b16 a[164:165], v232 offset:40960
    s_add_u32 s42, s7, 19456
    v_mfma_f32_16x16x32_bf16 v[156:159], a[140:143], v[20:23], v[156:159]
    ds_read_b64_tr_b16 a[166:167], v232 offset:41216
    buffer_load_dwordx4 v[200:203], v255, s[24:27], s42 offen sc1
    v_mfma_f32_16x16x32_bf16 v[160:163], a[144:147], v[16:19], v[160:163]
    ds_read_b64_tr_b16 a[168:169], v232 offset:40992
    s_add_u32 s43, s7, 166912
    v_mfma_f32_16x16x32_bf16 v[164:167], a[144:147], v[20:23], v[164:167]
    ds_read_b64_tr_b16 a[170:171], v232 offset:41248
    buffer_load_dwordx4 v[204:207], v255, s[24:27], s43 offen sc1
    v_mfma_f32_16x16x32_bf16 v[168:171], a[148:151], v[16:19], v[168:171]
    ds_read_b64_tr_b16 a[172:173], v232 offset:41024
    v_mfma_f32_16x16x32_bf16 v[172:175], a[148:151], v[20:23], v[172:175]
    ds_read_b64_tr_b16 a[174:175], v232 offset:41280
    s_waitcnt lgkmcnt(6)
    v_mfma_f32_16x16x32_bf16 v[176:179], a[152:155], v[16:19], v[176:179]
    ds_read_b64_tr_b16 a[176:177], v232 offset:41056
    s_add_u32 s42, s7, 23552
    v_mfma_f32_16x16x32_bf16 v[180:183], a[152:155], v[20:23], v[180:183]
    ds_read_b64_tr_b16 a[178:179], v232 offset:41312
    buffer_load_dwordx4 v[208:211], v255, s[24:27], s42 offen sc1
    v_mfma_f32_16x16x32_bf16 v[184:187], a[156:159], v[16:19], v[184:187]
    ds_read_b64_tr_b16 a[180:181], v232 offset:41088
    v_mfma_f32_16x16x32_bf16 v[188:191], a[156:159], v[20:23], v[188:191]
    ds_read_b64_tr_b16 a[182:183], v232 offset:41344
    s_add_u32 s43, s7, 171008
    v_mfma_f32_16x16x32_bf16 v[192:195], a[160:163], v[16:19], v[192:195]
    ds_read_b64_tr_b16 a[184:185], v232 offset:41120
    buffer_load_dwordx4 v[212:215], v255, s[24:27], s43 offen sc1
    v_mfma_f32_16x16x32_bf16 v[196:199], a[160:163], v[20:23], v[196:199]
    ds_read_b64_tr_b16 a[186:187], v232 offset:41376
    s_waitcnt lgkmcnt(6)
    v_mfma_f32_16x16x32_bf16 v[128:131], a[164:167], v[24:27], v[128:131]
    ds_read_b64_tr_b16 a[188:189], v232 offset:41152
    s_barrier
    v_mfma_f32_16x16x32_bf16 v[132:135], a[164:167], v[28:31], v[132:135]
    ds_read_b64_tr_b16 a[190:191], v232 offset:41408
    v_mfma_f32_16x16x32_bf16 v[136:139], a[168:171], v[24:27], v[136:139]
    ds_read_b64_tr_b16 a[192:193], v232 offset:41184
    v_mfma_f32_16x16x32_bf16 v[140:143], a[168:171], v[28:31], v[140:143]
    ds_read_b64_tr_b16 a[194:195], v232 offset:41440
    s_add_u32 s42, s7, 27648
    v_mfma_f32_16x16x32_bf16 v[144:147], a[172:175], v[24:27], v[144:147]
    ds_read_b64_tr_b16 a[196:197], v234 offset:40960
    buffer_load_dwordx4 v[216:219], v255, s[24:27], s42 offen sc1
    v_mfma_f32_16x16x32_bf16 v[148:151], a[172:175], v[28:31], v[148:151]
    ds_read_b64_tr_b16 a[198:199], v234 offset:41216
    s_waitcnt lgkmcnt(6)
    v_mfma_f32_16x16x32_bf16 v[152:155], a[176:179], v[24:27], v[152:155]
    ds_read_b64_tr_b16 a[128:129], v232 offset:50432
    v_mfma_f32_16x16x32_bf16 v[156:159], a[176:179], v[28:31], v[156:159]
    ds_read_b64_tr_b16 a[130:131], v232 offset:50688
    s_add_u32 s43, s7, 175104
    v_mfma_f32_16x16x32_bf16 v[160:163], a[180:183], v[24:27], v[160:163]
    ds_read_b64_tr_b16 a[132:133], v232 offset:50464
    buffer_load_dwordx4 v[220:223], v255, s[24:27], s43 offen sc1
    v_mfma_f32_16x16x32_bf16 v[164:167], a[180:183], v[28:31], v[164:167]
    ds_read_b64_tr_b16 a[134:135], v232 offset:50720
    v_mfma_f32_16x16x32_bf16 v[168:171], a[184:187], v[24:27], v[168:171]
    ds_read_b64_tr_b16 a[136:137], v232 offset:50496
    v_mfma_f32_16x16x32_bf16 v[172:175], a[184:187], v[28:31], v[172:175]
    ds_read_b64_tr_b16 a[138:139], v232 offset:50752
    s_waitcnt lgkmcnt(6)
    v_mfma_f32_16x16x32_bf16 v[176:179], a[188:191], v[24:27], v[176:179]
    ds_read_b64_tr_b16 a[140:141], v232 offset:50528
    s_add_u32 s42, s7, 31744
    v_mfma_f32_16x16x32_bf16 v[180:183], a[188:191], v[28:31], v[180:183]
    ds_read_b64_tr_b16 a[142:143], v232 offset:50784
    buffer_load_dwordx4 v[224:227], v255, s[24:27], s42 offen sc1
    v_mfma_f32_16x16x32_bf16 v[184:187], a[192:195], v[24:27], v[184:187]
    ds_read_b64_tr_b16 a[144:145], v232 offset:50560
    v_mfma_f32_16x16x32_bf16 v[188:191], a[192:195], v[28:31], v[188:191]
    ds_read_b64_tr_b16 a[146:147], v232 offset:50816
    s_add_u32 s43, s7, 179200
    v_mfma_f32_16x16x32_bf16 v[192:195], a[196:199], v[24:27], v[192:195]
    ds_read_b64_tr_b16 a[148:149], v232 offset:50592
    buffer_load_dwordx4 v[228:231], v255, s[24:27], s43 offen sc1
    v_mfma_f32_16x16x32_bf16 v[196:199], a[196:199], v[28:31], v[196:199]
    ds_read_b64_tr_b16 a[150:151], v232 offset:50848
    s_waitcnt lgkmcnt(6)
    s_waitcnt vmcnt(20)
    v_mfma_f32_16x16x32_bf16 v[128:131], a[128:131], v[32:35], v[128:131]
    ds_read_b64_tr_b16 a[152:153], v232 offset:50624
    s_waitcnt vmcnt(18)
    v_mfma_f32_16x16x32_bf16 v[132:135], a[128:131], v[36:39], v[132:135]
    ds_read_b64_tr_b16 a[154:155], v232 offset:50880
    v_mfma_f32_16x16x32_bf16 v[136:139], a[132:135], v[32:35], v[136:139]
    ds_read_b64_tr_b16 a[156:157], v232 offset:50656
    v_mfma_f32_16x16x32_bf16 v[140:143], a[132:135], v[36:39], v[140:143]
    ds_read_b64_tr_b16 a[158:159], v232 offset:50912
    s_add_u32 s42, s7, 32768
    v_mfma_f32_16x16x32_bf16 v[144:147], a[136:139], v[32:35], v[144:147]
    ds_read_b64_tr_b16 a[160:161], v234 offset:50432
    buffer_load_dwordx4 v[0:3], v255, s[24:27], s42 offen sc1
    v_mfma_f32_16x16x32_bf16 v[148:151], a[136:139], v[36:39], v[148:151]
    ds_read_b64_tr_b16 a[162:163], v234 offset:50688
    s_waitcnt lgkmcnt(6)
    v_mfma_f32_16x16x32_bf16 v[152:155], a[140:143], v[32:35], v[152:155]
    ds_read_b64_tr_b16 a[164:165], v232 offset:59904
    v_mfma_f32_16x16x32_bf16 v[156:159], a[140:143], v[36:39], v[156:159]
    ds_read_b64_tr_b16 a[166:167], v232 offset:60160
    s_add_u32 s43, s7, 180224
    v_mfma_f32_16x16x32_bf16 v[160:163], a[144:147], v[32:35], v[160:163]
    ds_read_b64_tr_b16 a[168:169], v232 offset:59936
    buffer_load_dwordx4 v[4:7], v255, s[24:27], s43 offen sc1
    v_mfma_f32_16x16x32_bf16 v[164:167], a[144:147], v[36:39], v[164:167]
    ds_read_b64_tr_b16 a[170:171], v232 offset:60192
    v_mfma_f32_16x16x32_bf16 v[168:171], a[148:151], v[32:35], v[168:171]
    ds_read_b64_tr_b16 a[172:173], v232 offset:59968
    v_mfma_f32_16x16x32_bf16 v[172:175], a[148:151], v[36:39], v[172:175]
    ds_read_b64_tr_b16 a[174:175], v232 offset:60224
    s_waitcnt lgkmcnt(6)
    v_mfma_f32_16x16x32_bf16 v[176:179], a[152:155], v[32:35], v[176:179]
    ds_read_b64_tr_b16 a[176:177], v232 offset:60000
    s_add_u32 s42, s7, 33792
    v_mfma_f32_16x16x32_bf16 v[180:183], a[152:155], v[36:39], v[180:183]
    ds_read_b64_tr_b16 a[178:179], v232 offset:60256
    buffer_load_dwordx4 v[8:11], v255, s[24:27], s42 offen sc1
    v_mfma_f32_16x16x32_bf16 v[184:187], a[156:159], v[32:35], v[184:187]
    ds_read_b64_tr_b16 a[180:181], v232 offset:60032
    v_mfma_f32_16x16x32_bf16 v[188:191], a[156:159], v[36:39], v[188:191]
    ds_read_b64_tr_b16 a[182:183], v232 offset:60288
    s_add_u32 s43, s7, 181248
    v_mfma_f32_16x16x32_bf16 v[192:195], a[160:163], v[32:35], v[192:195]
    ds_read_b64_tr_b16 a[184:185], v232 offset:60064
    buffer_load_dwordx4 v[12:15], v255, s[24:27], s43 offen sc1
    v_mfma_f32_16x16x32_bf16 v[196:199], a[160:163], v[36:39], v[196:199]
    ds_read_b64_tr_b16 a[186:187], v232 offset:60320
    s_waitcnt lgkmcnt(6)
    s_waitcnt vmcnt(20)
    v_mfma_f32_16x16x32_bf16 v[128:131], a[164:167], v[40:43], v[128:131]
    ds_read_b64_tr_b16 a[188:189], v232 offset:60096
    s_waitcnt vmcnt(18)
    v_mfma_f32_16x16x32_bf16 v[132:135], a[164:167], v[44:47], v[132:135]
    ds_read_b64_tr_b16 a[190:191], v232 offset:60352
    v_mfma_f32_16x16x32_bf16 v[136:139], a[168:171], v[40:43], v[136:139]
    ds_read_b64_tr_b16 a[192:193], v232 offset:60128
    v_mfma_f32_16x16x32_bf16 v[140:143], a[168:171], v[44:47], v[140:143]
    ds_read_b64_tr_b16 a[194:195], v232 offset:60384
    s_add_u32 s42, s7, 34816
    v_mfma_f32_16x16x32_bf16 v[144:147], a[172:175], v[40:43], v[144:147]
    ds_read_b64_tr_b16 a[196:197], v234 offset:59904
    buffer_load_dwordx4 v[16:19], v255, s[24:27], s42 offen sc1
    v_mfma_f32_16x16x32_bf16 v[148:151], a[172:175], v[44:47], v[148:151]
    ds_read_b64_tr_b16 a[198:199], v234 offset:60160
    s_waitcnt lgkmcnt(6)
    v_mfma_f32_16x16x32_bf16 v[152:155], a[176:179], v[40:43], v[152:155]
    ds_read_b64_tr_b16 a[128:129], v233 offset:3840
    v_mfma_f32_16x16x32_bf16 v[156:159], a[176:179], v[44:47], v[156:159]
    ds_read_b64_tr_b16 a[130:131], v233 offset:4096
    s_add_u32 s43, s7, 182272
    v_mfma_f32_16x16x32_bf16 v[160:163], a[180:183], v[40:43], v[160:163]
    ds_read_b64_tr_b16 a[132:133], v233 offset:3872
    buffer_load_dwordx4 v[20:23], v255, s[24:27], s43 offen sc1
    v_mfma_f32_16x16x32_bf16 v[164:167], a[180:183], v[44:47], v[164:167]
    ds_read_b64_tr_b16 a[134:135], v233 offset:4128
    v_mfma_f32_16x16x32_bf16 v[168:171], a[184:187], v[40:43], v[168:171]
    ds_read_b64_tr_b16 a[136:137], v233 offset:3904
    v_mfma_f32_16x16x32_bf16 v[172:175], a[184:187], v[44:47], v[172:175]
    ds_read_b64_tr_b16 a[138:139], v233 offset:4160
    s_waitcnt lgkmcnt(6)
    v_mfma_f32_16x16x32_bf16 v[176:179], a[188:191], v[40:43], v[176:179]
    ds_read_b64_tr_b16 a[140:141], v233 offset:3936
    v_mfma_f32_16x16x32_bf16 v[180:183], a[188:191], v[44:47], v[180:183]
    ds_read_b64_tr_b16 a[142:143], v233 offset:4192
    v_mfma_f32_16x16x32_bf16 v[184:187], a[192:195], v[40:43], v[184:187]
    ds_read_b64_tr_b16 a[144:145], v233 offset:3968
    v_mfma_f32_16x16x32_bf16 v[188:191], a[192:195], v[44:47], v[188:191]
    ds_read_b64_tr_b16 a[146:147], v233 offset:4224
    v_mfma_f32_16x16x32_bf16 v[192:195], a[196:199], v[40:43], v[192:195]
    ds_read_b64_tr_b16 a[148:149], v233 offset:4000
    v_mfma_f32_16x16x32_bf16 v[196:199], a[196:199], v[44:47], v[196:199]
    ds_read_b64_tr_b16 a[150:151], v233 offset:4256
    s_waitcnt lgkmcnt(6)
    s_waitcnt vmcnt(18)
    v_mfma_f32_16x16x32_bf16 v[128:131], a[128:131], v[48:51], v[128:131]
    ds_read_b64_tr_b16 a[152:153], v233 offset:4032
    s_waitcnt vmcnt(16)
    v_mfma_f32_16x16x32_bf16 v[132:135], a[128:131], v[52:55], v[132:135]
    ds_read_b64_tr_b16 a[154:155], v233 offset:4288
    v_mfma_f32_16x16x32_bf16 v[136:139], a[132:135], v[48:51], v[136:139]
    ds_read_b64_tr_b16 a[156:157], v233 offset:4064
    v_mfma_f32_16x16x32_bf16 v[140:143], a[132:135], v[52:55], v[140:143]
    ds_read_b64_tr_b16 a[158:159], v233 offset:4320
    s_add_u32 s42, s7, 35840
    v_mfma_f32_16x16x32_bf16 v[144:147], a[136:139], v[48:51], v[144:147]
    ds_read_b64_tr_b16 a[160:161], v235 offset:3840
    buffer_load_dwordx4 v[24:27], v255, s[24:27], s42 offen sc1
    v_mfma_f32_16x16x32_bf16 v[148:151], a[136:139], v[52:55], v[148:151]
    ds_read_b64_tr_b16 a[162:163], v235 offset:4096
    s_waitcnt lgkmcnt(6)
    v_mfma_f32_16x16x32_bf16 v[152:155], a[140:143], v[48:51], v[152:155]
    ds_read_b64_tr_b16 a[164:165], v233 offset:13312
    v_mfma_f32_16x16x32_bf16 v[156:159], a[140:143], v[52:55], v[156:159]
    ds_read_b64_tr_b16 a[166:167], v233 offset:13568
    s_add_u32 s43, s7, 183296
    v_mfma_f32_16x16x32_bf16 v[160:163], a[144:147], v[48:51], v[160:163]
    ds_read_b64_tr_b16 a[168:169], v233 offset:13344
    buffer_load_dwordx4 v[28:31], v255, s[24:27], s43 offen sc1
    v_mfma_f32_16x16x32_bf16 v[164:167], a[144:147], v[52:55], v[164:167]
    ds_read_b64_tr_b16 a[170:171], v233 offset:13600
    v_mfma_f32_16x16x32_bf16 v[168:171], a[148:151], v[48:51], v[168:171]
    ds_read_b64_tr_b16 a[172:173], v233 offset:13376
    v_mfma_f32_16x16x32_bf16 v[172:175], a[148:151], v[52:55], v[172:175]
    ds_read_b64_tr_b16 a[174:175], v233 offset:13632
    s_waitcnt lgkmcnt(6)
    v_mfma_f32_16x16x32_bf16 v[176:179], a[152:155], v[48:51], v[176:179]
    ds_read_b64_tr_b16 a[176:177], v233 offset:13408
    v_mfma_f32_16x16x32_bf16 v[180:183], a[152:155], v[52:55], v[180:183]
    ds_read_b64_tr_b16 a[178:179], v233 offset:13664
    v_mfma_f32_16x16x32_bf16 v[184:187], a[156:159], v[48:51], v[184:187]
    ds_read_b64_tr_b16 a[180:181], v233 offset:13440
    v_mfma_f32_16x16x32_bf16 v[188:191], a[156:159], v[52:55], v[188:191]
    ds_read_b64_tr_b16 a[182:183], v233 offset:13696
    v_mfma_f32_16x16x32_bf16 v[192:195], a[160:163], v[48:51], v[192:195]
    ds_read_b64_tr_b16 a[184:185], v233 offset:13472
    v_mfma_f32_16x16x32_bf16 v[196:199], a[160:163], v[52:55], v[196:199]
    ds_read_b64_tr_b16 a[186:187], v233 offset:13728
    s_waitcnt lgkmcnt(6)
    s_waitcnt vmcnt(17)
    v_mfma_f32_16x16x32_bf16 v[128:131], a[164:167], v[56:59], v[128:131]
    ds_read_b64_tr_b16 a[188:189], v233 offset:13504
    s_barrier
    s_waitcnt vmcnt(16)
    v_mfma_f32_16x16x32_bf16 v[132:135], a[164:167], v[60:63], v[132:135]
    ds_read_b64_tr_b16 a[190:191], v233 offset:13760
    v_mfma_f32_16x16x32_bf16 v[136:139], a[168:171], v[56:59], v[136:139]
    ds_read_b64_tr_b16 a[192:193], v233 offset:13536
    v_mfma_f32_16x16x32_bf16 v[140:143], a[168:171], v[60:63], v[140:143]
    ds_read_b64_tr_b16 a[194:195], v233 offset:13792
    v_mfma_f32_16x16x32_bf16 v[144:147], a[172:175], v[56:59], v[144:147]
    ds_read_b64_tr_b16 a[196:197], v235 offset:13312
    v_mfma_f32_16x16x32_bf16 v[148:151], a[172:175], v[60:63], v[148:151]
    ds_read_b64_tr_b16 a[198:199], v235 offset:13568
    s_waitcnt lgkmcnt(6)
    v_mfma_f32_16x16x32_bf16 v[152:155], a[176:179], v[56:59], v[152:155]
    ds_read_b64_tr_b16 a[128:129], v233 offset:22784
    v_mfma_f32_16x16x32_bf16 v[156:159], a[176:179], v[60:63], v[156:159]
    ds_read_b64_tr_b16 a[130:131], v233 offset:23040
    v_mfma_f32_16x16x32_bf16 v[160:163], a[180:183], v[56:59], v[160:163]
    ds_read_b64_tr_b16 a[132:133], v252
    v_mfma_f32_16x16x32_bf16 v[164:167], a[180:183], v[60:63], v[164:167]
    ds_read_b64_tr_b16 a[134:135], v252 offset:256
    v_mfma_f32_16x16x32_bf16 v[168:171], a[184:187], v[56:59], v[168:171]
    ds_read_b64_tr_b16 a[136:137], v252 offset:9472
    v_mfma_f32_16x16x32_bf16 v[172:175], a[184:187], v[60:63], v[172:175]
    ds_read_b64_tr_b16 a[138:139], v252 offset:9728
    s_waitcnt lgkmcnt(6)
    v_mfma_f32_16x16x32_bf16 v[176:179], a[188:191], v[56:59], v[176:179]
    ds_read_b64_tr_b16 a[140:141], v252 offset:18944
    v_mfma_f32_16x16x32_bf16 v[180:183], a[188:191], v[60:63], v[180:183]
    ds_read_b64_tr_b16 a[142:143], v252 offset:19200
    v_mfma_f32_16x16x32_bf16 v[184:187], a[192:195], v[56:59], v[184:187]
    ds_read_b64_tr_b16 a[144:145], v252 offset:28416
    v_mfma_f32_16x16x32_bf16 v[188:191], a[192:195], v[60:63], v[188:191]
    ds_read_b64_tr_b16 a[146:147], v252 offset:28672
    v_mfma_f32_16x16x32_bf16 v[192:195], a[196:199], v[56:59], v[192:195]
    ds_read_b64_tr_b16 a[148:149], v252 offset:37888
    v_mfma_f32_16x16x32_bf16 v[196:199], a[196:199], v[60:63], v[196:199]
    ds_read_b64_tr_b16 a[150:151], v252 offset:38144
    s_waitcnt lgkmcnt(6)
    s_waitcnt vmcnt(15)
    v_mfma_f32_16x16x32_bf16 v[128:131], a[128:131], v[200:203], v[128:131]
    ds_read_b64_tr_b16 a[152:153], v252 offset:49664
    s_waitcnt vmcnt(14)
    v_mfma_f32_16x16x32_bf16 v[132:135], a[128:131], v[204:207], v[132:135]
    ds_read_b64_tr_b16 a[154:155], v252 offset:49920
    s_waitcnt vmcnt(13)
    v_mfma_f32_16x16x32_bf16 v[128:131], a[132:135], v[208:211], v[128:131]
    ds_read_b64_tr_b16 a[156:157], v252 offset:59136
    s_waitcnt vmcnt(12)
    v_mfma_f32_16x16x32_bf16 v[132:135], a[132:135], v[212:215], v[132:135]
    ds_read_b64_tr_b16 a[158:159], v252 offset:59392
    s_waitcnt vmcnt(11)
    v_mfma_f32_16x16x32_bf16 v[128:131], a[136:139], v[216:219], v[128:131]
    ds_read_b64_tr_b16 a[160:161], v233 offset:22816
    s_waitcnt vmcnt(10)
    v_mfma_f32_16x16x32_bf16 v[132:135], a[136:139], v[220:223], v[132:135]
    ds_read_b64_tr_b16 a[162:163], v233 offset:23072
    s_waitcnt lgkmcnt(6)
    s_waitcnt vmcnt(9)
    v_mfma_f32_16x16x32_bf16 v[128:131], a[140:143], v[224:227], v[128:131]
    ds_read_b64_tr_b16 a[164:165], v252 offset:32
    s_waitcnt vmcnt(8)
    v_mfma_f32_16x16x32_bf16 v[132:135], a[140:143], v[228:231], v[132:135]
    ds_read_b64_tr_b16 a[166:167], v252 offset:288
    s_waitcnt vmcnt(7)
    v_mfma_f32_16x16x32_bf16 v[128:131], a[144:147], v[0:3], v[128:131]
    ds_read_b64_tr_b16 a[168:169], v252 offset:9504
    s_waitcnt vmcnt(6)
    v_mfma_f32_16x16x32_bf16 v[132:135], a[144:147], v[4:7], v[132:135]
    ds_read_b64_tr_b16 a[170:171], v252 offset:9760
    s_waitcnt vmcnt(5)
    v_mfma_f32_16x16x32_bf16 v[128:131], a[148:151], v[8:11], v[128:131]
    ds_read_b64_tr_b16 a[172:173], v252 offset:18976
    s_waitcnt vmcnt(4)
    v_mfma_f32_16x16x32_bf16 v[132:135], a[148:151], v[12:15], v[132:135]
    ds_read_b64_tr_b16 a[174:175], v252 offset:19232
    s_waitcnt lgkmcnt(6)
    s_waitcnt vmcnt(3)
    v_mfma_f32_16x16x32_bf16 v[128:131], a[152:155], v[16:19], v[128:131]
    ds_read_b64_tr_b16 a[176:177], v252 offset:28448
    s_waitcnt vmcnt(2)
    v_mfma_f32_16x16x32_bf16 v[132:135], a[152:155], v[20:23], v[132:135]
    ds_read_b64_tr_b16 a[178:179], v252 offset:28704
    s_waitcnt vmcnt(1)
    v_mfma_f32_16x16x32_bf16 v[128:131], a[156:159], v[24:27], v[128:131]
    ds_read_b64_tr_b16 a[180:181], v252 offset:37920
    s_waitcnt vmcnt(0)
    v_mfma_f32_16x16x32_bf16 v[132:135], a[156:159], v[28:31], v[132:135]
    ds_read_b64_tr_b16 a[182:183], v252 offset:38176
    v_mfma_f32_16x16x32_bf16 v[136:139], a[160:163], v[200:203], v[136:139]
    ds_read_b64_tr_b16 a[184:185], v252 offset:49696
    v_mfma_f32_16x16x32_bf16 v[140:143], a[160:163], v[204:207], v[140:143]
    ds_read_b64_tr_b16 a[186:187], v252 offset:49952
    s_waitcnt lgkmcnt(6)
    v_mfma_f32_16x16x32_bf16 v[136:139], a[164:167], v[208:211], v[136:139]
    ds_read_b64_tr_b16 a[188:189], v252 offset:59168
    v_mfma_f32_16x16x32_bf16 v[140:143], a[164:167], v[212:215], v[140:143]
    ds_read_b64_tr_b16 a[190:191], v252 offset:59424
    v_mfma_f32_16x16x32_bf16 v[136:139], a[168:171], v[216:219], v[136:139]
    ds_read_b64_tr_b16 a[192:193], v233 offset:22848
    v_mfma_f32_16x16x32_bf16 v[140:143], a[168:171], v[220:223], v[140:143]
    ds_read_b64_tr_b16 a[194:195], v233 offset:23104
    s_add_u32 s45, s85, s79
    s_add_u32 s45, s45, 0
    v_cvt_pk_bf16_f32 v64, v128, v129
    v_mfma_f32_16x16x32_bf16 v[136:139], a[172:175], v[224:227], v[136:139]
    ds_read_b64_tr_b16 a[196:197], v252 offset:64
    v_cvt_pk_bf16_f32 v65, v130, v131
    v_cvt_pk_bf16_f32 v66, v132, v133
    v_cvt_pk_bf16_f32 v67, v134, v135
    v_mfma_f32_16x16x32_bf16 v[140:143], a[172:175], v[228:231], v[140:143]
    ds_read_b64_tr_b16 a[198:199], v252 offset:320
    buffer_store_dwordx4 v[64:67], v255, s[56:59], s45 offen sc1
    s_waitcnt lgkmcnt(6)
    v_mfma_f32_16x16x32_bf16 v[136:139], a[176:179], v[0:3], v[136:139]
    ds_read_b64_tr_b16 a[128:129], v252 offset:9536
    v_mfma_f32_16x16x32_bf16 v[140:143], a[176:179], v[4:7], v[140:143]
    ds_read_b64_tr_b16 a[130:131], v252 offset:9792
    v_mfma_f32_16x16x32_bf16 v[136:139], a[180:183], v[8:11], v[136:139]
    ds_read_b64_tr_b16 a[132:133], v252 offset:19008
    v_mfma_f32_16x16x32_bf16 v[140:143], a[180:183], v[12:15], v[140:143]
    ds_read_b64_tr_b16 a[134:135], v252 offset:19264
    v_mfma_f32_16x16x32_bf16 v[136:139], a[184:187], v[16:19], v[136:139]
    ds_read_b64_tr_b16 a[136:137], v252 offset:28480
    v_mfma_f32_16x16x32_bf16 v[140:143], a[184:187], v[20:23], v[140:143]
    ds_read_b64_tr_b16 a[138:139], v252 offset:28736
    s_waitcnt lgkmcnt(6)
    v_mfma_f32_16x16x32_bf16 v[136:139], a[188:191], v[24:27], v[136:139]
    ds_read_b64_tr_b16 a[140:141], v252 offset:37952
    v_mfma_f32_16x16x32_bf16 v[140:143], a[188:191], v[28:31], v[140:143]
    ds_read_b64_tr_b16 a[142:143], v252 offset:38208
    v_mfma_f32_16x16x32_bf16 v[144:147], a[192:195], v[200:203], v[144:147]
    ds_read_b64_tr_b16 a[144:145], v252 offset:49728
    v_mfma_f32_16x16x32_bf16 v[148:151], a[192:195], v[204:207], v[148:151]
    ds_read_b64_tr_b16 a[146:147], v252 offset:49984
    v_mfma_f32_16x16x32_bf16 v[144:147], a[196:199], v[208:211], v[144:147]
    ds_read_b64_tr_b16 a[148:149], v252 offset:59200
    v_mfma_f32_16x16x32_bf16 v[148:151], a[196:199], v[212:215], v[148:151]
    ds_read_b64_tr_b16 a[150:151], v252 offset:59456
    s_waitcnt lgkmcnt(6)
    v_mfma_f32_16x16x32_bf16 v[144:147], a[128:131], v[216:219], v[144:147]
    ds_read_b64_tr_b16 a[152:153], v233 offset:22880
    v_mfma_f32_16x16x32_bf16 v[148:151], a[128:131], v[220:223], v[148:151]
    ds_read_b64_tr_b16 a[154:155], v233 offset:23136
    s_add_u32 s45, s86, s79
    s_add_u32 s45, s45, 1024
    v_cvt_pk_bf16_f32 v68, v136, v137
    v_mfma_f32_16x16x32_bf16 v[144:147], a[132:135], v[224:227], v[144:147]
    ds_read_b64_tr_b16 a[156:157], v252 offset:96
    v_cvt_pk_bf16_f32 v69, v138, v139
    v_cvt_pk_bf16_f32 v70, v140, v141
    v_cvt_pk_bf16_f32 v71, v142, v143
    v_mfma_f32_16x16x32_bf16 v[148:151], a[132:135], v[228:231], v[148:151]
    ds_read_b64_tr_b16 a[158:159], v252 offset:352
    buffer_store_dwordx4 v[68:71], v255, s[56:59], s45 offen sc1
    v_mfma_f32_16x16x32_bf16 v[144:147], a[136:139], v[0:3], v[144:147]
    ds_read_b64_tr_b16 a[160:161], v252 offset:9568
    v_mfma_f32_16x16x32_bf16 v[148:151], a[136:139], v[4:7], v[148:151]
    ds_read_b64_tr_b16 a[162:163], v252 offset:9824
    s_waitcnt lgkmcnt(6)
    v_mfma_f32_16x16x32_bf16 v[144:147], a[140:143], v[8:11], v[144:147]
    ds_read_b64_tr_b16 a[164:165], v252 offset:19040
    v_mfma_f32_16x16x32_bf16 v[148:151], a[140:143], v[12:15], v[148:151]
    ds_read_b64_tr_b16 a[166:167], v252 offset:19296
    v_mfma_f32_16x16x32_bf16 v[144:147], a[144:147], v[16:19], v[144:147]
    ds_read_b64_tr_b16 a[168:169], v252 offset:28512
    v_mfma_f32_16x16x32_bf16 v[148:151], a[144:147], v[20:23], v[148:151]
    ds_read_b64_tr_b16 a[170:171], v252 offset:28768
    v_mfma_f32_16x16x32_bf16 v[144:147], a[148:151], v[24:27], v[144:147]
    ds_read_b64_tr_b16 a[172:173], v252 offset:37984
    v_mfma_f32_16x16x32_bf16 v[148:151], a[148:151], v[28:31], v[148:151]
    ds_read_b64_tr_b16 a[174:175], v252 offset:38240
    s_waitcnt lgkmcnt(6)
    v_mfma_f32_16x16x32_bf16 v[152:155], a[152:155], v[200:203], v[152:155]
    ds_read_b64_tr_b16 a[176:177], v252 offset:49760
    v_mfma_f32_16x16x32_bf16 v[156:159], a[152:155], v[204:207], v[156:159]
    ds_read_b64_tr_b16 a[178:179], v252 offset:50016
    v_mfma_f32_16x16x32_bf16 v[152:155], a[156:159], v[208:211], v[152:155]
    ds_read_b64_tr_b16 a[180:181], v252 offset:59232
    v_mfma_f32_16x16x32_bf16 v[156:159], a[156:159], v[212:215], v[156:159]
    ds_read_b64_tr_b16 a[182:183], v252 offset:59488
    v_mfma_f32_16x16x32_bf16 v[152:155], a[160:163], v[216:219], v[152:155]
    ds_read_b64_tr_b16 a[184:185], v233 offset:22912
    v_mfma_f32_16x16x32_bf16 v[156:159], a[160:163], v[220:223], v[156:159]
    ds_read_b64_tr_b16 a[186:187], v233 offset:23168
    s_add_u32 s45, s87, s79
    s_add_u32 s45, s45, 2048
    s_waitcnt lgkmcnt(6)
    v_mfma_f32_16x16x32_bf16 v[152:155], a[164:167], v[224:227], v[152:155]
    ds_read_b64_tr_b16 a[188:189], v252 offset:128
    v_cvt_pk_bf16_f32 v72, v144, v145
    v_cvt_pk_bf16_f32 v73, v146, v147
    v_cvt_pk_bf16_f32 v74, v148, v149
    v_mfma_f32_16x16x32_bf16 v[156:159], a[164:167], v[228:231], v[156:159]
    ds_read_b64_tr_b16 a[190:191], v252 offset:384
    v_cvt_pk_bf16_f32 v75, v150, v151
    buffer_store_dwordx4 v[72:75], v255, s[56:59], s45 offen sc1
    v_mfma_f32_16x16x32_bf16 v[152:155], a[168:171], v[0:3], v[152:155]
    ds_read_b64_tr_b16 a[192:193], v252 offset:9600
    v_mfma_f32_16x16x32_bf16 v[156:159], a[168:171], v[4:7], v[156:159]
    ds_read_b64_tr_b16 a[194:195], v252 offset:9856
    v_mfma_f32_16x16x32_bf16 v[152:155], a[172:175], v[8:11], v[152:155]
    ds_read_b64_tr_b16 a[196:197], v252 offset:19072
    v_mfma_f32_16x16x32_bf16 v[156:159], a[172:175], v[12:15], v[156:159]
    ds_read_b64_tr_b16 a[198:199], v252 offset:19328
    s_waitcnt lgkmcnt(6)
    v_mfma_f32_16x16x32_bf16 v[152:155], a[176:179], v[16:19], v[152:155]
    ds_read_b64_tr_b16 a[128:129], v252 offset:28544
    v_mfma_f32_16x16x32_bf16 v[156:159], a[176:179], v[20:23], v[156:159]
    ds_read_b64_tr_b16 a[130:131], v252 offset:28800
    v_mfma_f32_16x16x32_bf16 v[152:155], a[180:183], v[24:27], v[152:155]
    ds_read_b64_tr_b16 a[132:133], v252 offset:38016
    v_mfma_f32_16x16x32_bf16 v[156:159], a[180:183], v[28:31], v[156:159]
    ds_read_b64_tr_b16 a[134:135], v252 offset:38272
    v_mfma_f32_16x16x32_bf16 v[160:163], a[184:187], v[200:203], v[160:163]
    ds_read_b64_tr_b16 a[136:137], v252 offset:49792
    v_mfma_f32_16x16x32_bf16 v[164:167], a[184:187], v[204:207], v[164:167]
    ds_read_b64_tr_b16 a[138:139], v252 offset:50048
    s_waitcnt lgkmcnt(6)
    v_mfma_f32_16x16x32_bf16 v[160:163], a[188:191], v[208:211], v[160:163]
    ds_read_b64_tr_b16 a[140:141], v252 offset:59264
    v_mfma_f32_16x16x32_bf16 v[164:167], a[188:191], v[212:215], v[164:167]
    ds_read_b64_tr_b16 a[142:143], v252 offset:59520
    v_mfma_f32_16x16x32_bf16 v[160:163], a[192:195], v[216:219], v[160:163]
    ds_read_b64_tr_b16 a[144:145], v233 offset:22944
    v_mfma_f32_16x16x32_bf16 v[164:167], a[192:195], v[220:223], v[164:167]
    ds_read_b64_tr_b16 a[146:147], v233 offset:23200
    s_add_u32 s45, s88, s79
    s_add_u32 s45, s45, 3072
    v_cvt_pk_bf16_f32 v76, v152, v153
    v_mfma_f32_16x16x32_bf16 v[160:163], a[196:199], v[224:227], v[160:163]
    ds_read_b64_tr_b16 a[148:149], v252 offset:160
    v_cvt_pk_bf16_f32 v77, v154, v155
    v_cvt_pk_bf16_f32 v78, v156, v157
    v_cvt_pk_bf16_f32 v79, v158, v159
    v_mfma_f32_16x16x32_bf16 v[164:167], a[196:199], v[228:231], v[164:167]
    ds_read_b64_tr_b16 a[150:151], v252 offset:416
    buffer_store_dwordx4 v[76:79], v255, s[56:59], s45 offen sc1
    s_waitcnt lgkmcnt(6)
    v_mfma_f32_16x16x32_bf16 v[160:163], a[128:131], v[0:3], v[160:163]
    ds_read_b64_tr_b16 a[152:153], v252 offset:9632
    v_mfma_f32_16x16x32_bf16 v[164:167], a[128:131], v[4:7], v[164:167]
    ds_read_b64_tr_b16 a[154:155], v252 offset:9888
    v_mfma_f32_16x16x32_bf16 v[160:163], a[132:135], v[8:11], v[160:163]
    ds_read_b64_tr_b16 a[156:157], v252 offset:19104
    v_mfma_f32_16x16x32_bf16 v[164:167], a[132:135], v[12:15], v[164:167]
    ds_read_b64_tr_b16 a[158:159], v252 offset:19360
    v_mfma_f32_16x16x32_bf16 v[160:163], a[136:139], v[16:19], v[160:163]
    ds_read_b64_tr_b16 a[160:161], v252 offset:28576
    v_mfma_f32_16x16x32_bf16 v[164:167], a[136:139], v[20:23], v[164:167]
    ds_read_b64_tr_b16 a[162:163], v252 offset:28832
    s_waitcnt lgkmcnt(6)
    v_mfma_f32_16x16x32_bf16 v[160:163], a[140:143], v[24:27], v[160:163]
    ds_read_b64_tr_b16 a[164:165], v252 offset:38048
    v_mfma_f32_16x16x32_bf16 v[164:167], a[140:143], v[28:31], v[164:167]
    ds_read_b64_tr_b16 a[166:167], v252 offset:38304
    v_mfma_f32_16x16x32_bf16 v[168:171], a[144:147], v[200:203], v[168:171]
    ds_read_b64_tr_b16 a[168:169], v252 offset:49824
    v_mfma_f32_16x16x32_bf16 v[172:175], a[144:147], v[204:207], v[172:175]
    ds_read_b64_tr_b16 a[170:171], v252 offset:50080
    v_mfma_f32_16x16x32_bf16 v[168:171], a[148:151], v[208:211], v[168:171]
    ds_read_b64_tr_b16 a[172:173], v252 offset:59296
    v_mfma_f32_16x16x32_bf16 v[172:175], a[148:151], v[212:215], v[172:175]
    ds_read_b64_tr_b16 a[174:175], v252 offset:59552
    s_waitcnt lgkmcnt(6)
    v_mfma_f32_16x16x32_bf16 v[168:171], a[152:155], v[216:219], v[168:171]
    ds_read_b64_tr_b16 a[176:177], v233 offset:22976
    v_mfma_f32_16x16x32_bf16 v[172:175], a[152:155], v[220:223], v[172:175]
    ds_read_b64_tr_b16 a[178:179], v233 offset:23232
    s_add_u32 s45, s85, s79
    s_add_u32 s45, s45, 4096
    v_cvt_pk_bf16_f32 v80, v160, v161
    v_mfma_f32_16x16x32_bf16 v[168:171], a[156:159], v[224:227], v[168:171]
    ds_read_b64_tr_b16 a[180:181], v252 offset:192
    v_cvt_pk_bf16_f32 v81, v162, v163
    v_cvt_pk_bf16_f32 v82, v164, v165
    v_cvt_pk_bf16_f32 v83, v166, v167
    v_mfma_f32_16x16x32_bf16 v[172:175], a[156:159], v[228:231], v[172:175]
    ds_read_b64_tr_b16 a[182:183], v252 offset:448
    buffer_store_dwordx4 v[80:83], v255, s[56:59], s45 offen sc1
    v_mfma_f32_16x16x32_bf16 v[168:171], a[160:163], v[0:3], v[168:171]
    ds_read_b64_tr_b16 a[184:185], v252 offset:9664
    v_mfma_f32_16x16x32_bf16 v[172:175], a[160:163], v[4:7], v[172:175]
    ds_read_b64_tr_b16 a[186:187], v252 offset:9920
    s_waitcnt lgkmcnt(6)
    v_mfma_f32_16x16x32_bf16 v[168:171], a[164:167], v[8:11], v[168:171]
    ds_read_b64_tr_b16 a[188:189], v252 offset:19136
    v_mfma_f32_16x16x32_bf16 v[172:175], a[164:167], v[12:15], v[172:175]
    ds_read_b64_tr_b16 a[190:191], v252 offset:19392
    v_mfma_f32_16x16x32_bf16 v[168:171], a[168:171], v[16:19], v[168:171]
    ds_read_b64_tr_b16 a[192:193], v252 offset:28608
    v_mfma_f32_16x16x32_bf16 v[172:175], a[168:171], v[20:23], v[172:175]
    ds_read_b64_tr_b16 a[194:195], v252 offset:28864
    v_mfma_f32_16x16x32_bf16 v[168:171], a[172:175], v[24:27], v[168:171]
    ds_read_b64_tr_b16 a[196:197], v252 offset:38080
    v_mfma_f32_16x16x32_bf16 v[172:175], a[172:175], v[28:31], v[172:175]
    ds_read_b64_tr_b16 a[198:199], v252 offset:38336
    s_waitcnt lgkmcnt(6)
    v_mfma_f32_16x16x32_bf16 v[176:179], a[176:179], v[200:203], v[176:179]
    ds_read_b64_tr_b16 a[128:129], v252 offset:49856
    v_mfma_f32_16x16x32_bf16 v[180:183], a[176:179], v[204:207], v[180:183]
    ds_read_b64_tr_b16 a[130:131], v252 offset:50112
    v_mfma_f32_16x16x32_bf16 v[176:179], a[180:183], v[208:211], v[176:179]
    ds_read_b64_tr_b16 a[132:133], v252 offset:59328
    v_mfma_f32_16x16x32_bf16 v[180:183], a[180:183], v[212:215], v[180:183]
    ds_read_b64_tr_b16 a[134:135], v252 offset:59584
    v_mfma_f32_16x16x32_bf16 v[176:179], a[184:187], v[216:219], v[176:179]
    ds_read_b64_tr_b16 a[136:137], v233 offset:23008
    v_mfma_f32_16x16x32_bf16 v[180:183], a[184:187], v[220:223], v[180:183]
    ds_read_b64_tr_b16 a[138:139], v233 offset:23264
    s_add_u32 s45, s86, s79
    s_add_u32 s45, s45, 5120
    s_waitcnt lgkmcnt(6)
    v_mfma_f32_16x16x32_bf16 v[176:179], a[188:191], v[224:227], v[176:179]
    ds_read_b64_tr_b16 a[140:141], v252 offset:224
    v_cvt_pk_bf16_f32 v84, v168, v169
    v_cvt_pk_bf16_f32 v85, v170, v171
    v_cvt_pk_bf16_f32 v86, v172, v173
    v_mfma_f32_16x16x32_bf16 v[180:183], a[188:191], v[228:231], v[180:183]
    ds_read_b64_tr_b16 a[142:143], v252 offset:480
    v_cvt_pk_bf16_f32 v87, v174, v175
    buffer_store_dwordx4 v[84:87], v255, s[56:59], s45 offen sc1
    v_mfma_f32_16x16x32_bf16 v[176:179], a[192:195], v[0:3], v[176:179]
    ds_read_b64_tr_b16 a[144:145], v252 offset:9696
    v_mfma_f32_16x16x32_bf16 v[180:183], a[192:195], v[4:7], v[180:183]
    ds_read_b64_tr_b16 a[146:147], v252 offset:9952
    v_mfma_f32_16x16x32_bf16 v[176:179], a[196:199], v[8:11], v[176:179]
    ds_read_b64_tr_b16 a[148:149], v252 offset:19168
    v_mfma_f32_16x16x32_bf16 v[180:183], a[196:199], v[12:15], v[180:183]
    ds_read_b64_tr_b16 a[150:151], v252 offset:19424
    s_waitcnt lgkmcnt(6)
    v_mfma_f32_16x16x32_bf16 v[176:179], a[128:131], v[16:19], v[176:179]
    ds_read_b64_tr_b16 a[152:153], v252 offset:28640
    v_mfma_f32_16x16x32_bf16 v[180:183], a[128:131], v[20:23], v[180:183]
    ds_read_b64_tr_b16 a[154:155], v252 offset:28896
    v_mfma_f32_16x16x32_bf16 v[176:179], a[132:135], v[24:27], v[176:179]
    ds_read_b64_tr_b16 a[156:157], v252 offset:38112
    v_mfma_f32_16x16x32_bf16 v[180:183], a[132:135], v[28:31], v[180:183]
    ds_read_b64_tr_b16 a[158:159], v252 offset:38368
    v_mfma_f32_16x16x32_bf16 v[184:187], a[136:139], v[200:203], v[184:187]
    ds_read_b64_tr_b16 a[160:161], v252 offset:49888
    v_mfma_f32_16x16x32_bf16 v[188:191], a[136:139], v[204:207], v[188:191]
    ds_read_b64_tr_b16 a[162:163], v252 offset:50144
    s_waitcnt lgkmcnt(6)
    v_mfma_f32_16x16x32_bf16 v[184:187], a[140:143], v[208:211], v[184:187]
    ds_read_b64_tr_b16 a[164:165], v252 offset:59360
    v_mfma_f32_16x16x32_bf16 v[188:191], a[140:143], v[212:215], v[188:191]
    ds_read_b64_tr_b16 a[166:167], v252 offset:59616
    v_mfma_f32_16x16x32_bf16 v[184:187], a[144:147], v[216:219], v[184:187]
    ds_read_b64_tr_b16 a[168:169], v235 offset:22784
    v_mfma_f32_16x16x32_bf16 v[188:191], a[144:147], v[220:223], v[188:191]
    ds_read_b64_tr_b16 a[170:171], v235 offset:23040
    s_add_u32 s45, s87, s79
    s_add_u32 s45, s45, 6144
    v_cvt_pk_bf16_f32 v88, v176, v177
    v_mfma_f32_16x16x32_bf16 v[184:187], a[148:151], v[224:227], v[184:187]
    ds_read_b64_tr_b16 a[172:173], v253
    v_cvt_pk_bf16_f32 v89, v178, v179
    v_cvt_pk_bf16_f32 v90, v180, v181
    v_cvt_pk_bf16_f32 v91, v182, v183
    v_mfma_f32_16x16x32_bf16 v[188:191], a[148:151], v[228:231], v[188:191]
    ds_read_b64_tr_b16 a[174:175], v253 offset:256
    buffer_store_dwordx4 v[88:91], v255, s[56:59], s45 offen sc1
    s_waitcnt lgkmcnt(6)
    v_mfma_f32_16x16x32_bf16 v[184:187], a[152:155], v[0:3], v[184:187]
    ds_read_b64_tr_b16 a[176:177], v253 offset:9472
    v_mfma_f32_16x16x32_bf16 v[188:191], a[152:155], v[4:7], v[188:191]
    ds_read_b64_tr_b16 a[178:179], v253 offset:9728
    v_mfma_f32_16x16x32_bf16 v[184:187], a[156:159], v[8:11], v[184:187]
    ds_read_b64_tr_b16 a[180:181], v253 offset:18944
    v_mfma_f32_16x16x32_bf16 v[188:191], a[156:159], v[12:15], v[188:191]
    ds_read_b64_tr_b16 a[182:183], v253 offset:19200
    v_mfma_f32_16x16x32_bf16 v[184:187], a[160:163], v[16:19], v[184:187]
    ds_read_b64_tr_b16 a[184:185], v253 offset:28416
    v_mfma_f32_16x16x32_bf16 v[188:191], a[160:163], v[20:23], v[188:191]
    ds_read_b64_tr_b16 a[186:187], v253 offset:28672
    s_waitcnt lgkmcnt(6)
    v_mfma_f32_16x16x32_bf16 v[184:187], a[164:167], v[24:27], v[184:187]
    ds_read_b64_tr_b16 a[188:189], v253 offset:37888
    v_mfma_f32_16x16x32_bf16 v[188:191], a[164:167], v[28:31], v[188:191]
    ds_read_b64_tr_b16 a[190:191], v253 offset:38144
    v_mfma_f32_16x16x32_bf16 v[192:195], a[168:171], v[200:203], v[192:195]
    ds_read_b64_tr_b16 a[192:193], v253 offset:49664
    v_mfma_f32_16x16x32_bf16 v[196:199], a[168:171], v[204:207], v[196:199]
    ds_read_b64_tr_b16 a[194:195], v253 offset:49920
    v_mfma_f32_16x16x32_bf16 v[192:195], a[172:175], v[208:211], v[192:195]
    ds_read_b64_tr_b16 a[196:197], v253 offset:59136
    v_mfma_f32_16x16x32_bf16 v[196:199], a[172:175], v[212:215], v[196:199]
    ds_read_b64_tr_b16 a[198:199], v253 offset:59392
    s_waitcnt lgkmcnt(6)
    v_mfma_f32_16x16x32_bf16 v[192:195], a[176:179], v[216:219], v[192:195]
    v_mfma_f32_16x16x32_bf16 v[196:199], a[176:179], v[220:223], v[196:199]
    s_add_u32 s45, s88, s79
    s_add_u32 s45, s45, 7168
    v_cvt_pk_bf16_f32 v92, v184, v185
    v_cvt_pk_bf16_f32 v93, v186, v187
    v_mfma_f32_16x16x32_bf16 v[192:195], a[180:183], v[224:227], v[192:195]
    v_cvt_pk_bf16_f32 v94, v188, v189
    v_cvt_pk_bf16_f32 v95, v190, v191
    buffer_store_dwordx4 v[92:95], v255, s[56:59], s45 offen sc1
    v_mfma_f32_16x16x32_bf16 v[196:199], a[180:183], v[228:231], v[196:199]
    v_mfma_f32_16x16x32_bf16 v[192:195], a[184:187], v[0:3], v[192:195]
    v_mfma_f32_16x16x32_bf16 v[196:199], a[184:187], v[4:7], v[196:199]
    s_waitcnt lgkmcnt(0)
    v_mfma_f32_16x16x32_bf16 v[192:195], a[188:191], v[8:11], v[192:195]
    v_mfma_f32_16x16x32_bf16 v[196:199], a[188:191], v[12:15], v[196:199]
    v_mfma_f32_16x16x32_bf16 v[192:195], a[192:195], v[16:19], v[192:195]
    v_mfma_f32_16x16x32_bf16 v[196:199], a[192:195], v[20:23], v[196:199]
    v_mfma_f32_16x16x32_bf16 v[192:195], a[196:199], v[24:27], v[192:195]
    v_mfma_f32_16x16x32_bf16 v[196:199], a[196:199], v[28:31], v[196:199]
    s_add_u32 s45, s85, s79
    s_add_u32 s45, s45, 8192
    s_nop 4
    v_cvt_pk_bf16_f32 v96, v192, v193
    v_cvt_pk_bf16_f32 v97, v194, v195
    v_cvt_pk_bf16_f32 v98, v196, v197
    v_cvt_pk_bf16_f32 v99, v198, v199
    buffer_store_dwordx4 v[96:99], v255, s[56:59], s45 offen sc1
    v_lshrrev_b32 v102, 4, v255
    v_and_b32 v100, 15, v102
    v_mul_u32_u24 v100, 1152, v100
    v_lshrrev_b32 v103, 4, v102
    v_lshl_add_u32 v100, v103, 3, v100
    s_mul_i32 s46, s82, 1152
    s_lshr_b32 s47, s5, 1
    s_lshl_b32 s44, s47, 8
    s_lshl_b32 s45, s3, 5
    s_add_u32 s44, s44, s45
    s_add_u32 s44, s44, s46
    s_lshl_b32 s45, s47, 5
    s_add_u32 s45, s45, 1024
    s_add_u32 s45, s45, s46
    s_cmp_eq_u32 s3, 0
    s_cselect_b32 s43, 0, 2146435072
    s_add_u32 s43, s43, s81
    v_and_b32 v101, 3, v102
    v_lshlrev_b32 v101, 2, v101
    s_waitcnt vmcnt(0)
    s_mov_b64 exec, 1
    s_lshl_b32 s40, s3, 2
    s_add_u32 s40, s40, s78
    buffer_store_dword v249, v250, s[56:59], s40 offen sc1
    s_mov_b64 exec, -1
    s_cmp_eq_u32 s3, 0
    s_cselect_b32 s46, -1, 0
    v_bfi_b32 v104, s46, v128, v104
    v_bfi_b32 v105, s46, v129, v105
    v_bfi_b32 v106, s46, v130, v106
    v_bfi_b32 v107, s46, v131, v107
    v_bfi_b32 v108, s46, v132, v108
    v_bfi_b32 v109, s46, v133, v109
    v_bfi_b32 v110, s46, v134, v110
    v_bfi_b32 v111, s46, v135, v111
    v_bfi_b32 v112, s46, v160, v112
    v_bfi_b32 v113, s46, v161, v113
    v_bfi_b32 v114, s46, v162, v114
    v_bfi_b32 v115, s46, v163, v115
    v_bfi_b32 v116, s46, v164, v116
    v_bfi_b32 v117, s46, v165, v117
    v_bfi_b32 v118, s46, v166, v118
    v_bfi_b32 v119, s46, v167, v119
    v_bfi_b32 v120, s46, v192, v120
    v_bfi_b32 v121, s46, v193, v121
    v_bfi_b32 v122, s46, v194, v122
    v_bfi_b32 v123, s46, v195, v123
    v_bfi_b32 v124, s46, v196, v124
    v_bfi_b32 v125, s46, v197, v125
    v_bfi_b32 v126, s46, v198, v126
    v_bfi_b32 v127, s46, v199, v127
    s_cmp_eq_u32 s3, 1
    s_cselect_b32 s46, -1, 0
    v_bfi_b32 v104, s46, v136, v104
    v_bfi_b32 v105, s46, v137, v105
    v_bfi_b32 v106, s46, v138, v106
    v_bfi_b32 v107, s46, v139, v107
    v_bfi_b32 v108, s46, v140, v108
    v_bfi_b32 v109, s46, v141, v109
    v_bfi_b32 v110, s46, v142, v110
    v_bfi_b32 v111, s46, v143, v111
    v_bfi_b32 v112, s46, v168, v112
    v_bfi_b32 v113, s46, v169, v113
    v_bfi_b32 v114, s46, v170, v114
    v_bfi_b32 v115, s46, v171, v115
    v_bfi_b32 v116, s46, v172, v116
    v_bfi_b32 v117, s46, v173, v117
    v_bfi_b32 v118, s46, v174, v118
    v_bfi_b32 v119, s46, v175, v119
    s_cmp_eq_u32 s3, 2
    s_cselect_b32 s46, -1, 0
    v_bfi_b32 v104, s46, v144, v104
    v_bfi_b32 v105, s46, v145, v105
    v_bfi_b32 v106, s46, v146, v106
    v_bfi_b32 v107, s46, v147, v107
    v_bfi_b32 v108, s46, v148, v108
    v_bfi_b32 v109, s46, v149, v109
    v_bfi_b32 v110, s46, v150, v110
    v_bfi_b32 v111, s46, v151, v111
    v_bfi_b32 v112, s46, v176, v112
    v_bfi_b32 v113, s46, v177, v113
    v_bfi_b32 v114, s46, v178, v114
    v_bfi_b32 v115, s46, v179, v115
    v_bfi_b32 v116, s46, v180, v116
    v_bfi_b32 v117, s46, v181, v117
    v_bfi_b32 v118, s46, v182, v118
    v_bfi_b32 v119, s46, v183, v119
    s_cmp_eq_u32 s3, 3
    s_cselect_b32 s46, -1, 0
    v_bfi_b32 v104, s46, v152, v104
    v_bfi_b32 v105, s46, v153, v105
    v_bfi_b32 v106, s46, v154, v106
    v_bfi_b32 v107, s46, v155, v107
    v_bfi_b32 v108, s46, v156, v108
    v_bfi_b32 v109, s46, v157, v109
    v_bfi_b32 v110, s46, v158, v110
    v_bfi_b32 v111, s46, v159, v111
    v_bfi_b32 v112, s46, v184, v112
    v_bfi_b32 v113, s46, v185, v113
    v_bfi_b32 v114, s46, v186, v114
    v_bfi_b32 v115, s46, v187, v115
    v_bfi_b32 v116, s46, v188, v116
    v_bfi_b32 v117, s46, v189, v117
    v_bfi_b32 v118, s46, v190, v118
    v_bfi_b32 v119, s46, v191, v119
    s_mov_b32 s47, 100000
L_xspin:
    buffer_load_dword v236, v101, s[56:59], s78 offen sc1
    s_waitcnt vmcnt(0)
    v_cmp_ne_u32 vcc, v236, v249
    s_cbranch_vccz L_xok
    s_sub_u32 s47, s47, 1
    s_cbranch_scc0 L_xspin
L_xok:
    s_cmp_eq_u32 s3, 0
    s_cselect_b32 s42, 2146435072, 0
    s_add_u32 s40, s81, 0
    s_or_b32 s40, s40, s42
    buffer_load_dwordx4 v[0:3], v255, s[56:59], s40 offen sc1
    s_add_u32 s41, s81, 4096
    s_or_b32 s41, s41, s42
    buffer_load_dwordx4 v[16:19], v255, s[56:59], s41 offen sc1
    s_add_u32 s40, s43, 8192
    s_or_b32 s40, s40, s42
    buffer_load_dwordx4 v[32:35], v255, s[56:59], s40 offen sc1
    s_cmp_eq_u32 s3, 1
    s_cselect_b32 s42, 2146435072, 0
    s_add_u32 s40, s81, 9216
    s_or_b32 s40, s40, s42
    buffer_load_dwordx4 v[4:7], v255, s[56:59], s40 offen sc1
    s_add_u32 s41, s81, 13312
    s_or_b32 s41, s41, s42
    buffer_load_dwordx4 v[20:23], v255, s[56:59], s41 offen sc1
    s_add_u32 s40, s43, 17408
    s_or_b32 s40, s40, s42
    buffer_load_dwordx4 v[36:39], v255, s[56:59], s40 offen sc1
    s_cmp_eq_u32 s3, 2
    s_cselect_b32 s42, 2146435072, 0
    s_add_u32 s40, s81, 18432
    s_or_b32 s40, s40, s42
    buffer_load_dwordx4 v[8:11], v255, s[56:59], s40 offen sc1
    s_add_u32 s41, s81, 22528
    s_or_b32 s41, s41, s42
    buffer_load_dwordx4 v[24:27], v255, s[56:59], s41 offen sc1
    s_add_u32 s40, s43, 26624
    s_or_b32 s40, s40, s42
    buffer_load_dwordx4 v[40:43], v255, s[56:59], s40 offen sc1
    s_cmp_eq_u32 s3, 3
    s_cselect_b32 s42, 2146435072, 0
    s_add_u32 s40, s81, 27648
    s_or_b32 s40, s40, s42
    buffer_load_dwordx4 v[12:15], v255, s[56:59], s40 offen sc1
    s_add_u32 s41, s81, 31744
    s_or_b32 s41, s41, s42
    buffer_load_dwordx4 v[28:31], v255, s[56:59], s41 offen sc1
    s_add_u32 s40, s43, 35840
    s_or_b32 s40, s40, s42
    buffer_load_dwordx4 v[44:47], v255, s[56:59], s40 offen sc1
    s_waitcnt vmcnt(0)
    v_lshlrev_b32 v48, 16, v0
    v_and_b32 v49, 0xffff0000, v0
    v_add_f32 v104, v104, v48
    v_add_f32 v105, v105, v49
    v_lshlrev_b32 v48, 16, v4
    v_and_b32 v49, 0xffff0000, v4
    v_add_f32 v104, v104, v48
    v_add_f32 v105, v105, v49
    v_lshlrev_b32 v48, 16, v8
    v_and_b32 v49, 0xffff0000, v8
    v_add_f32 v104, v104, v48
    v_add_f32 v105, v105, v49
    v_lshlrev_b32 v48, 16, v12
    v_and_b32 v49, 0xffff0000, v12
    v_add_f32 v104, v104, v48
    v_add_f32 v105, v105, v49
    v_lshlrev_b32 v48, 16, v1
    v_and_b32 v49, 0xffff0000, v1
    v_add_f32 v106, v106, v48
    v_add_f32 v107, v107, v49
    v_lshlrev_b32 v48, 16, v5
    v_and_b32 v49, 0xffff0000, v5
    v_add_f32 v106, v106, v48
    v_add_f32 v107, v107, v49
    v_lshlrev_b32 v48, 16, v9
    v_and_b32 v49, 0xffff0000, v9
    v_add_f32 v106, v106, v48
    v_add_f32 v107, v107, v49
    v_lshlrev_b32 v48, 16, v13
    v_and_b32 v49, 0xffff0000, v13
    v_add_f32 v106, v106, v48
    v_add_f32 v107, v107, v49
    v_lshlrev_b32 v48, 16, v2
    v_and_b32 v49, 0xffff0000, v2
    v_add_f32 v108, v108, v48
    v_add_f32 v109, v109, v49
    v_lshlrev_b32 v48, 16, v6
    v_and_b32 v49, 0xffff0000, v6
    v_add_f32 v108, v108, v48
    v_add_f32 v109, v109, v49
    v_lshlrev_b32 v48, 16, v10
    v_and_b32 v49, 0xffff0000, v10
    v_add_f32 v108, v108, v48
    v_add_f32 v109, v109, v49
    v_lshlrev_b32 v48, 16, v14
    v_and_b32 v49, 0xffff0000, v14
    v_add_f32 v108, v108, v48
    v_add_f32 v109, v109, v49
    v_lshlrev_b32 v48, 16, v3
    v_and_b32 v49, 0xffff0000, v3
    v_add_f32 v110, v110, v48
    v_add_f32 v111, v111, v49
    v_lshlrev_b32 v48, 16, v7
    v_and_b32 v49, 0xffff0000, v7
    v_add_f32 v110, v110, v48
    v_add_f32 v111, v111, v49
    v_lshlrev_b32 v48, 16, v11
    v_and_b32 v49, 0xffff0000, v11
    v_add_f32 v110, v110, v48
    v_add_f32 v111, v111, v49
    v_lshlrev_b32 v48, 16, v15
    v_and_b32 v49, 0xffff0000, v15
    v_add_f32 v110, v110, v48
    v_add_f32 v111, v111, v49
    v_cvt_pk_bf16_f32 v52, v104, v105
    v_cvt_pk_bf16_f32 v53, v106, v107
    v_cvt_pk_bf16_f32 v54, v108, v109
    v_cvt_pk_bf16_f32 v55, v110, v111
    s_add_u32 s40, s44, 0
    buffer_store_dwordx2 v[52:53], v100, s[60:63], s40 offen sc1
    s_add_u32 s41, s44, 18432
    buffer_store_dwordx2 v[54:55], v100, s[60:63], s41 offen sc1
    v_lshlrev_b32 v48, 16, v16
    v_and_b32 v49, 0xffff0000, v16
    v_add_f32 v112, v112, v48
    v_add_f32 v113, v113, v49
    v_lshlrev_b32 v48, 16, v20
    v_and_b32 v49, 0xffff0000, v20
    v_add_f32 v112, v112, v48
    v_add_f32 v113, v113, v49
    v_lshlrev_b32 v48, 16, v24
    v_and_b32 v49, 0xffff0000, v24
    v_add_f32 v112, v112, v48
    v_add_f32 v113, v113, v49
    v_lshlrev_b32 v48, 16, v28
    v_and_b32 v49, 0xffff0000, v28
    v_add_f32 v112, v112, v48
    v_add_f32 v113, v113, v49
    v_lshlrev_b32 v48, 16, v17
    v_and_b32 v49, 0xffff0000, v17
    v_add_f32 v114, v114, v48
    v_add_f32 v115, v115, v49
    v_lshlrev_b32 v48, 16, v21
    v_and_b32 v49, 0xffff0000, v21
    v_add_f32 v114, v114, v48
    v_add_f32 v115, v115, v49
    v_lshlrev_b32 v48, 16, v25
    v_and_b32 v49, 0xffff0000, v25
    v_add_f32 v114, v114, v48
    v_add_f32 v115, v115, v49
    v_lshlrev_b32 v48, 16, v29
    v_and_b32 v49, 0xffff0000, v29
    v_add_f32 v114, v114, v48
    v_add_f32 v115, v115, v49
    v_lshlrev_b32 v48, 16, v18
    v_and_b32 v49, 0xffff0000, v18
    v_add_f32 v116, v116, v48
    v_add_f32 v117, v117, v49
    v_lshlrev_b32 v48, 16, v22
    v_and_b32 v49, 0xffff0000, v22
    v_add_f32 v116, v116, v48
    v_add_f32 v117, v117, v49
    v_lshlrev_b32 v48, 16, v26
    v_and_b32 v49, 0xffff0000, v26
    v_add_f32 v116, v116, v48
    v_add_f32 v117, v117, v49
    v_lshlrev_b32 v48, 16, v30
    v_and_b32 v49, 0xffff0000, v30
    v_add_f32 v116, v116, v48
    v_add_f32 v117, v117, v49
    v_lshlrev_b32 v48, 16, v19
    v_and_b32 v49, 0xffff0000, v19
    v_add_f32 v118, v118, v48
    v_add_f32 v119, v119, v49
    v_lshlrev_b32 v48, 16, v23
    v_and_b32 v49, 0xffff0000, v23
    v_add_f32 v118, v118, v48
    v_add_f32 v119, v119, v49
    v_lshlrev_b32 v48, 16, v27
    v_and_b32 v49, 0xffff0000, v27
    v_add_f32 v118, v118, v48
    v_add_f32 v119, v119, v49
    v_lshlrev_b32 v48, 16, v31
    v_and_b32 v49, 0xffff0000, v31
    v_add_f32 v118, v118, v48
    v_add_f32 v119, v119, v49
    v_cvt_pk_bf16_f32 v56, v112, v113
    v_cvt_pk_bf16_f32 v57, v114, v115
    v_cvt_pk_bf16_f32 v58, v116, v117
    v_cvt_pk_bf16_f32 v59, v118, v119
    s_add_u32 s40, s44, 128
    buffer_store_dwordx2 v[56:57], v100, s[60:63], s40 offen sc1
    s_add_u32 s41, s44, 18560
    buffer_store_dwordx2 v[58:59], v100, s[60:63], s41 offen sc1
    s_cmp_eq_u32 s3, 0
    s_cbranch_scc0 L_no3b
    v_lshlrev_b32 v48, 16, v32
    v_and_b32 v49, 0xffff0000, v32
    v_add_f32 v120, v120, v48
    v_add_f32 v121, v121, v49
    v_lshlrev_b32 v48, 16, v36
    v_and_b32 v49, 0xffff0000, v36
    v_add_f32 v120, v120, v48
    v_add_f32 v121, v121, v49
    v_lshlrev_b32 v48, 16, v40
    v_and_b32 v49, 0xffff0000, v40
    v_add_f32 v120, v120, v48
    v_add_f32 v121, v121, v49
    v_lshlrev_b32 v48, 16, v44
    v_and_b32 v49, 0xffff0000, v44
    v_add_f32 v120, v120, v48
    v_add_f32 v121, v121, v49
    v_lshlrev_b32 v48, 16, v33
    v_and_b32 v49, 0xffff0000, v33
    v_add_f32 v122, v122, v48
    v_add_f32 v123, v123, v49
    v_lshlrev_b32 v48, 16, v37
    v_and_b32 v49, 0xffff0000, v37
    v_add_f32 v122, v122, v48
    v_add_f32 v123, v123, v49
    v_lshlrev_b32 v48, 16, v41
    v_and_b32 v49, 0xffff0000, v41
    v_add_f32 v122, v122, v48
    v_add_f32 v123, v123, v49
    v_lshlrev_b32 v48, 16, v45
    v_and_b32 v49, 0xffff0000, v45
    v_add_f32 v122, v122, v48
    v_add_f32 v123, v123, v49
    v_lshlrev_b32 v48, 16, v34
    v_and_b32 v49, 0xffff0000, v34
    v_add_f32 v124, v124, v48
    v_add_f32 v125, v125, v49
    v_lshlrev_b32 v48, 16, v38
    v_and_b32 v49, 0xffff0000, v38
    v_add_f32 v124, v124, v48
    v_add_f32 v125, v125, v49
    v_lshlrev_b32 v48, 16, v42
    v_and_b32 v49, 0xffff0000, v42
    v_add_f32 v124, v124, v48
    v_add_f32 v125, v125, v49
    v_lshlrev_b32 v48, 16, v46
    v_and_b32 v49, 0xffff0000, v46
    v_add_f32 v124, v124, v48
    v_add_f32 v125, v125, v49
    v_lshlrev_b32 v48, 16, v35
    v_and_b32 v49, 0xffff0000, v35
    v_add_f32 v126, v126, v48
    v_add_f32 v127, v127, v49
    v_lshlrev_b32 v48, 16, v39
    v_and_b32 v49, 0xffff0000, v39
    v_add_f32 v126, v126, v48
    v_add_f32 v127, v127, v49
    v_lshlrev_b32 v48, 16, v43
    v_and_b32 v49, 0xffff0000, v43
    v_add_f32 v126, v126, v48
    v_add_f32 v127, v127, v49
    v_lshlrev_b32 v48, 16, v47
    v_and_b32 v49, 0xffff0000, v47
    v_add_f32 v126, v126, v48
    v_add_f32 v127, v127, v49
    v_cvt_pk_bf16_f32 v60, v120, v121
    v_cvt_pk_bf16_f32 v61, v122, v123
    v_cvt_pk_bf16_f32 v62, v124, v125
    v_cvt_pk_bf16_f32 v63, v126, v127
    s_add_u32 s40, s45, 0
    buffer_store_dwordx2 v[60:61], v100, s[60:63], s40 offen sc1
    s_add_u32 s41, s45, 18432
    buffer_store_dwordx2 v[62:63], v100, s[60:63], s41 offen sc1
    s_or_b32 s40, s2, s28
    s_cmp_eq_u32 s40, 0
    s_cbranch_scc0 L_no3b
    s_mov_b64 exec, 1
    v_mov_b32 v196, 0
    s_mov_b32 s40, 16908288
    buffer_store_dword v249, v196, s[56:59], s40 offen
    s_mov_b64 exec, -1
L_no3b:
L_end:
    s_endpgm
L_spin2:
    s_mov_b32 s47, 100000
L_spinl2:
    s_sub_u32 s47, s47, 1
    s_cbranch_scc1 L_ok2
    s_add_u32 s46, s84, 0
    buffer_load_dword v214, v213, s[56:59], s46 offen sc1
    s_waitcnt vmcnt(0)
    v_cmp_ne_u32 vcc, v214, v249
    s_cbranch_vccnz L_spinl2
    s_branch L_ok2
L_spin3:
    s_mov_b32 s47, 100000
L_spinl3:
    s_sub_u32 s47, s47, 1
    s_cbranch_scc1 L_ok3
    s_add_u32 s46, s77, 0
    buffer_load_dword v236, v250, s[56:59], s46 offen sc1
    s_waitcnt vmcnt(0)
    v_cmp_ne_u32 vcc, v236, v249
    s_cbranch_vccnz L_spinl3
    s_branch L_ok3
L_spin4:
    s_mov_b32 s47, 100000
L_spinl4:
    s_sub_u32 s47, s47, 1
    s_cbranch_scc1 L_ok4
    s_add_u32 s46, s77, 32
    buffer_load_dword v236, v250, s[56:59], s46 offen sc1
    s_waitcnt vmcnt(0)
    v_cmp_ne_u32 vcc, v236, v249
    s_cbranch_vccnz L_spinl4
    s_branch L_ok4
L_spin5:
    s_mov_b32 s47, 100000
L_spinl5:
    s_sub_u32 s47, s47, 1
    s_cbranch_scc1 L_ok5
    s_add_u32 s46, s77, 64
    buffer_load_dword v236, v250, s[56:59], s46 offen sc1
    s_waitcnt vmcnt(0)
    v_cmp_ne_u32 vcc, v236, v249
    s_cbranch_vccnz L_spinl5
    s_branch L_ok5
L_code_end:
    s_endpgm

.section .rodata,"a"
.p2align 6
.amdhsa_kernel standalone__geglu_ffn__prompt_kernel
  .amdhsa_next_free_vgpr 512
  .amdhsa_next_free_sgpr 102
  .amdhsa_accum_offset 256
  .amdhsa_group_segment_fixed_size 0
  .amdhsa_kernarg_size 56
  .amdhsa_user_sgpr_count 2
  .amdhsa_user_sgpr_kernarg_segment_ptr 1
  .amdhsa_system_sgpr_workgroup_id_x 1
.end_amdhsa_kernel
```
